```python
import torch

def _softmax(x, axis=-1):
    return torch.softmax(x, dim=axis)
def _gelu(x):
    return torch.nn.functional.gelu(x, approximate="tanh")
def _silu(x):
    return torch.nn.functional.silu(x)
def _sigmoid(x):
    return torch.sigmoid(x)
def _layernorm(x, axis=-1, eps=1e-5):
    m = x.mean(dim=axis, keepdim=True)
    v = x.var(dim=axis, keepdim=True, unbiased=False)
    return (x - m) / torch.sqrt(v + eps)
def _scatter_add(tgt, idx, src, axis=0):
    return tgt.clone().index_add_(axis, idx, src)
def _segment_sum(src, seg, n):
    out = torch.zeros((n,) + src.shape[1:], dtype=src.dtype)
    return out.index_add_(0, seg, src)
def _pad(x, pw):
    flat = tuple(v for pair in reversed(pw) for v in pair)
    return torch.nn.functional.pad(x, flat)

kernel_name = 'concat_heads__gqa_block_cached__mha_block_cached__near_ridge'

def setup_inputs():

    _w = (lambda a: (lambda t: t.to(torch.bfloat16) if t.is_floating_point() else t)(torch.as_tensor(a)))
    def _A_setup():
        B, Sq, D = 16, 32, 512
        Hq, Hkv, Sk, Dh = 32, 8, 512, 128
        assert Hq % Hkv == 0, (Hq, Hkv)
        return {
            "x": _w((lambda *s: torch.randn(*s, dtype=torch.bfloat16) * 0.8)(B, Sq, D)),
            "k_cache": _w((lambda *s: torch.randn(*s, dtype=torch.bfloat16) * 0.8)(B, Hkv, Sk, Dh)),
            "v_cache": _w((lambda *s: torch.randn(*s, dtype=torch.bfloat16) * 0.05)(B, Hkv, Sk, Dh)),
            "wq": _w((lambda *s: torch.randn(*s, dtype=torch.bfloat16) * 0.8)(D, Hq * Dh) * (D ** -0.5)),
            "wo": _w((lambda *s: torch.randn(*s, dtype=torch.bfloat16) * 0.05)(Hq * Dh, D) * ((Hq * Dh) ** -0.5)),
        }
    _A_in = _A_setup()

    def _B_setup():
        B, Sq, D = 16, 32, 512
        H, Sk, Dh = 32, 512, 128
        return {
            "x": _w((lambda *s: torch.randn(*s, dtype=torch.bfloat16) * 0.8)(B, Sq, D)),
            "k_cache": _w((lambda *s: torch.randn(*s, dtype=torch.bfloat16) * 0.8)(B, H, Sk, Dh)),
            "v_cache": _w((lambda *s: torch.randn(*s, dtype=torch.bfloat16) * 0.05)(B, H, Sk, Dh)),
            "wq": _w((lambda *s: torch.randn(*s, dtype=torch.bfloat16) * 0.8)(D, H * Dh) * (D ** -0.5)),
            "wo": _w((lambda *s: torch.randn(*s, dtype=torch.bfloat16) * 0.05)(H * Dh, D) * ((H * Dh) ** -0.5)),
        }
    _B_in = _B_setup()

    return {
        "A_x": _A_in["x"],
        "A_k_cache": _A_in["k_cache"],
        "A_v_cache": _A_in["v_cache"],
        "A_wq": _A_in["wq"],
        "A_wo": _A_in["wo"],
        "B_x": _B_in["x"],
        "B_k_cache": _B_in["k_cache"],
        "B_v_cache": _B_in["v_cache"],
        "B_wq": _B_in["wq"],
        "B_wo": _B_in["wo"],
    }

def reference(A_x, A_k_cache, A_v_cache, A_wq, A_wo, B_x, B_k_cache, B_v_cache, B_wq, B_wo):
    def _A_ref(x, k_cache, v_cache, wq, wo):
        B, Sq, D = x.shape
        Hq, Dh = 32, 128
        Hkv = k_cache.shape[1]
        rep = Hq // Hkv
        q = (lambda x, *d: x.permute(*d))((x @ wq).reshape(B, Sq, Hq, Dh), 0, 2, 1, 3)
        k = (lambda x, n, axis: torch.repeat_interleave(x, n, dim=axis))(k_cache, rep, axis=1)
        v = (lambda x, n, axis: torch.repeat_interleave(x, n, dim=axis))(v_cache, rep, axis=1)
        scores = torch.einsum("bhqd,bhkd->bhqk", q, k) * (Dh ** -0.5)
        p = _softmax(scores, axis=-1)
        o = torch.einsum("bhqk,bhkd->bhqd", p, v)
        return (lambda x, *d: x.permute(*d))(o, 0, 2, 1, 3).reshape(B, Sq, Hq * Dh) @ wo

    def _B_ref(x, k_cache, v_cache, wq, wo):
        B, Sq, D = x.shape
        H, Dh = 32, 128
        q = (lambda x, *d: x.permute(*d))((x @ wq).reshape(B, Sq, H, Dh), 0, 2, 1, 3)
        scores = torch.einsum("bhqd,bhkd->bhqk", q, k_cache) * (Dh ** -0.5)
        p = _softmax(scores, axis=-1)
        o = torch.einsum("bhqk,bhkd->bhqd", p, v_cache)
        return (lambda x, *d: x.permute(*d))(o, 0, 2, 1, 3).reshape(B, Sq, H * Dh) @ wo

    a = _A_ref(A_x, A_k_cache, A_v_cache, A_wq, A_wo)
    b = _B_ref(B_x, B_k_cache, B_v_cache, B_wq, B_wo)
    return torch.concatenate([a, b], axis=-1)
```

```asm
; @launch grid=(256,1,1) block=(256,1,1) lds=163840
.amdgcn_target "amdgcn-amd-amdhsa--gfx950"
.text
.globl concat_heads__gqa_block_cached__mha_block_cached__near_ridge_kernel
.p2align 8
.type concat_heads__gqa_block_cached__mha_block_cached__near_ridge_kernel,@function
concat_heads__gqa_block_cached__mha_block_cached__near_ridge_kernel:
s_cmp_lt_u32 s2, 256
s_cbranch_scc1 L_go
s_endpgm
L_go:
s_memrealtime s[100:101]
s_load_dwordx16 s[4:19], s[0:1], 0
s_load_dwordx4 s[20:23], s[0:1], 64
s_load_dwordx2 s[24:25], s[0:1], 96
s_load_dwordx2 s[32:33], s[0:1], 88
s_load_dwordx2 s[98:99], s[0:1], 80
v_lshrrev_b32 v1, 6, v0
v_and_b32 v0, 63, v0
v_readfirstlane_b32 s26, v1
s_and_b32 s27, s2, 7
s_lshr_b32 s28, s2, 4
s_lshr_b32 s29, s26, 1
s_and_b32 s30, s26, 1
v_lshlrev_b32 v1, 4, v0
s_getpc_b64 s[96:97]
s_lshr_b32 s92, s2, 3
s_lshl_b32 s92, s92, 12
s_lshl_b32 s93, s26, 10
s_add_u32 s92, s92, s93
s_min_u32 s92, s92, L_code_end-L_go-2048
v_add_u32 v42, s92, v1
global_load_dwordx4 a[252:255], v42, s[96:97]
v_lshrrev_b32 v32, 5, v0
v_and_b32 v33, 15, v0
v_xor_b32 v40, v32, v33
v_and_b32 v41, 31, v0
v_lshlrev_b32 v41, 8, v41
v_lshl_or_b32 v2, v40, 4, v41
v_bfe_u32 v34, v0, 2, 2
v_and_b32 v35, 3, v0
v_bfe_u32 v36, v0, 4, 1
v_and_b32 v40, 1, v35
v_lshrrev_b32 v41, 1, v35
v_lshl_or_b32 v37, v40, 1, v41
v_lshl_add_u32 v40, v32, 2, v34
v_lshlrev_b32 v40, 8, v40
v_lshl_add_u32 v40, v34, 6, v40
v_lshl_add_u32 v40, v36, 5, v40
v_lshl_add_u32 v3, v35, 3, v40
v_lshl_add_u32 v4, v37, 3, v40
v_lshrrev_b32 v38, 4, v0
v_xor_b32 v40, v33, v38
v_lshlrev_b32 v41, 8, v38
v_lshl_or_b32 v6, v40, 4, v41
v_lshlrev_b32 v40, 2, v38
v_xor_b32 v39, v33, v40
v_lshl_or_b32 v10, v39, 4, v41
v_lshlrev_b32 v41, 10, v38
v_lshl_or_b32 v11, v39, 4, v41
v_add_u32 v12, 3072, v11
v_add_u32 v13, 6144, v11
v_add_u32 v14, 9216, v11
s_lshl_b32 s92, s26, 13
s_add_u32 s86, s92, 114688
s_xor_b32 s87, s26, 2
s_lshl_b32 s87, s87, 13
s_add_u32 s87, s87, 114688
s_mul_i32 s85, s26, 12288
s_add_u32 s85, s85, 65536
s_mov_b32 s91, 0x3e0293ee
s_mul_i32 s3, s28, 3
s_mul_i32 s92, s27, 5
s_add_u32 s3, s3, s92
s_bitcmp1_b32 s2, 3
s_lshr_b32 s92, s28, 1
s_lshl_b32 s92, s92, 16
s_lshl_b32 s93, s28, 15
s_bitcmp1_b32 s2, 3
s_cselect_b32 s80, s92, s93
s_lshl_b32 s92, s26, 13
s_add_u32 s80, s80, s92
s_lshl_b32 s31, s26, 14
s_lshl_b32 s92, s28, 5
s_lshl_b32 s93, s26, 3
s_add_u32 s92, s92, s93
s_lshl_b32 s89, s92, 13
s_lshl_b32 s93, s27, 10
s_add_u32 s89, s89, s93
s_lshl_b32 s92, s30, 7
v_xor_b32 v48, s92, v1
v_xor_b32 v49, 16, v48
v_xor_b32 v50, 32, v48
v_xor_b32 v51, 48, v48
v_xor_b32 v52, 64, v48
v_xor_b32 v53, 80, v48
v_xor_b32 v54, 96, v48
v_xor_b32 v55, 112, v48
s_waitcnt lgkmcnt(0)
s_and_b32 s33, s33, 0xffff
s_mov_b32 s34, 256
s_mov_b32 s35, 0x20000
s_or_b32 s92, s2, s26
s_cmp_eq_u32 s92, 0
s_cselect_b32 s92, 0, 0x1000
s_or_b32 s100, s100, 1
v_mov_b32 v44, s100
v_mov_b32 v45, s101
v_mov_b32 v46, 0
s_mov_b64 exec, 1
buffer_store_dwordx2 v[44:45], v46, s[32:35], s92 offen sc1
s_mov_b64 exec, -1
s_mov_b32 s56, s14
s_and_b32 s57, s15, 0xffff
s_mov_b32 s58, 524288
s_mov_b32 s59, 0x20000
s_mov_b32 s68, s20
s_and_b32 s69, s21, 0xffff
s_mov_b32 s70, 4194304
s_mov_b32 s71, 0x20000
s_bitcmp0_b32 s2, 3
s_cbranch_scc1 L_firstA
s_add_u32 s92, s80, 0
s_add_u32 m0, s86, 0
s_nop 0
buffer_load_dwordx4 v48, s[56:59], s92 offen offset:0 lds
buffer_load_dwordx4 v49, s[56:59], s92 offen offset:1024 lds
buffer_load_dwordx4 v50, s[56:59], s92 offen offset:2048 lds
buffer_load_dwordx4 v51, s[56:59], s92 offen offset:3072 lds
s_add_u32 s92, s80, 4096
s_add_u32 m0, s86, 4096
s_nop 0
buffer_load_dwordx4 v52, s[56:59], s92 offen offset:0 lds
buffer_load_dwordx4 v53, s[56:59], s92 offen offset:1024 lds
buffer_load_dwordx4 v54, s[56:59], s92 offen offset:2048 lds
buffer_load_dwordx4 v55, s[56:59], s92 offen offset:3072 lds
s_branch L_firstdone
L_firstA:
s_add_u32 s92, s89, 0
buffer_load_dwordx4 a[252:255], v1, s[68:71], s92 offen
s_add_u32 s92, s89, 8192
buffer_load_dwordx4 a[252:255], v1, s[68:71], s92 offen
s_add_u32 s92, s89, 16384
buffer_load_dwordx4 a[252:255], v1, s[68:71], s92 offen
s_add_u32 s92, s89, 24576
buffer_load_dwordx4 a[252:255], v1, s[68:71], s92 offen
s_add_u32 s92, s89, 32768
buffer_load_dwordx4 a[252:255], v1, s[68:71], s92 offen
s_add_u32 s92, s89, 40960
buffer_load_dwordx4 a[252:255], v1, s[68:71], s92 offen
s_add_u32 s92, s89, 49152
buffer_load_dwordx4 a[252:255], v1, s[68:71], s92 offen
s_add_u32 s92, s89, 57344
buffer_load_dwordx4 a[252:255], v1, s[68:71], s92 offen
L_firstdone:
s_mov_b32 s36, s4
s_and_b32 s37, s5, 0xffff
s_mov_b32 s38, 524288
s_mov_b32 s39, 0x20000
s_mov_b32 s40, s6
s_and_b32 s41, s7, 0xffff
s_mov_b32 s42, 16777216
s_mov_b32 s43, 0x20000
s_mov_b32 s44, s8
s_and_b32 s45, s9, 0xffff
s_mov_b32 s46, 16777216
s_mov_b32 s47, 0x20000
s_mov_b32 s48, s10
s_and_b32 s49, s11, 0xffff
s_mov_b32 s50, 4194304
s_mov_b32 s51, 0x20000
s_mov_b32 s52, s12
s_and_b32 s53, s13, 0xffff
s_mov_b32 s54, 4194304
s_mov_b32 s55, 0x20000
s_mov_b32 s60, s16
s_and_b32 s61, s17, 0xffff
s_mov_b32 s62, 67108864
s_mov_b32 s63, 0x20000
s_mov_b32 s64, s18
s_and_b32 s65, s19, 0xffff
s_mov_b32 s66, 67108864
s_mov_b32 s67, 0x20000
s_mov_b32 s72, s22
s_and_b32 s73, s23, 0xffff
s_mov_b32 s74, 4194304
s_mov_b32 s75, 0x20000
s_mov_b32 s76, s24
s_and_b32 s77, s25, 0xffff
s_mov_b32 s78, 268435456
s_mov_b32 s79, 0x20000
s_mov_b32 s20, s98
s_and_b32 s21, s99, 0xffff
s_mov_b32 s22, 1048576
s_mov_b32 s23, 0x20000
s_bitcmp0_b32 s2, 3
s_cbranch_scc1 L_progA
s_lshr_b32 s92, s28, 1
s_and_b32 s93, s28, 1
s_lshl_b32 s96, s92, 6
s_lshl_b32 s92, s27, 2
s_add_u32 s96, s96, s92
s_lshl_b32 s93, s93, 1
s_add_u32 s96, s96, s93
s_add_u32 s96, s96, s30
s_lshl_b32 s96, s96, 17
s_lshl_b32 s92, s29, 13
s_add_u32 s96, s96, s92
s_lshl_b32 s31, s26, 14
s_lshl_b32 s97, s28, 3
s_add_u32 s97, s97, s27
s_lshl_b32 s99, s97, 8
s_add_u32 s99, s99, 29360128
v_lshlrev_b32 v40, 10, v32
v_lshl_add_u32 v40, v34, 7, v40
v_lshrrev_b32 v41, 1, v34
v_lshl_add_u32 v40, v41, 6, v40
v_lshl_add_u32 v40, v36, 5, v40
v_lshl_add_u32 v5, v37, 3, v40
v_and_b32 v40, 7, v0
v_lshlrev_b32 v41, 2, v36
v_xor_b32 v40, v40, v41
v_lshrrev_b32 v41, 3, v0
v_lshlrev_b32 v41, 13, v41
v_lshl_or_b32 v15, v40, 4, v41
v_add_u32 v16, 64512, v15
v_add_u32 v17, 129024, v15
v_add_u32 v18, 193536, v15
v_xor_b32 v7, 64, v6
v_xor_b32 v8, 128, v6
v_xor_b32 v9, 192, v6
s_lshr_b32 s89, s28, 1
s_and_b32 s90, s28, 1
s_lshl_b32 s94, s27, 2
s_lshl_b32 s92, s90, 1
s_add_u32 s94, s94, s92
s_lshl_b32 s81, s94, 8
s_lshl_b32 s92, s26, 7
s_add_u32 s81, s81, s92
s_lshl_b32 s82, s94, 17
s_lshl_b32 s92, s26, 8
s_add_u32 s82, s82, s92
s_lshl_b32 s84, s26, 14
s_lshl_b32 s88, s89, 5
s_lshl_b32 s92, s90, 3
s_add_u32 s88, s88, s92
s_add_u32 s88, s88, s27
s_lshl_b32 s88, s88, 16
s_lshl_b32 s92, s26, 13
s_add_u32 s88, s88, s92
s_add_u32 s88, s88, 32768
s_lshl_b32 s83, s90, 3
s_add_u32 s83, s83, s27
s_lshl_b32 s24, s89, 4
s_add_u32 s24, s24, s26
s_add_u32 s24, s24, 4
s_lshl_b32 s24, s24, 7
s_add_u32 s24, s24, 30408704
s_lshl_b32 s25, s89, 21
s_lshl_b32 s92, s26, 13
s_add_u32 s25, s25, s92
s_lshl_b32 s92, s83, 9
s_add_u32 s25, s25, s92
s_add_u32 s25, s25, 32768
s_lshl_b32 s98, s89, 17
s_lshl_b32 s92, s26, 8
s_add_u32 s98, s98, s92
s_lshl_b32 s92, s83, 4
s_add_u32 s98, s98, s92
s_add_u32 s98, s98, 1024
s_lshl_b32 s92, s28, 5
s_lshl_b32 s93, s26, 3
s_add_u32 s92, s92, s93
s_lshl_b32 s90, s92, 10
s_lshl_b32 s93, s27, 19
s_add_u32 s90, s90, s93
s_add_u32 s95, s81, 0
s_add_u32 m0, s85, 0
s_nop 0
buffer_load_dwordx4 v15, s[68:71], s95 offen offset:0 lds
buffer_load_dwordx4 v16, s[68:71], s95 offen offset:1024 lds
buffer_load_dwordx4 v17, s[68:71], s95 offen offset:2048 lds
buffer_load_dwordx4 v18, s[68:71], s95 offen offset:3072 lds
s_add_u32 s95, s81, 262144
s_add_u32 m0, s85, 4096
s_nop 0
buffer_load_dwordx4 v15, s[68:71], s95 offen offset:0 lds
buffer_load_dwordx4 v16, s[68:71], s95 offen offset:1024 lds
buffer_load_dwordx4 v17, s[68:71], s95 offen offset:2048 lds
buffer_load_dwordx4 v18, s[68:71], s95 offen offset:3072 lds
s_add_u32 s95, s81, 524288
s_add_u32 m0, s85, 8192
s_nop 0
buffer_load_dwordx4 v15, s[68:71], s95 offen offset:0 lds
buffer_load_dwordx4 v16, s[68:71], s95 offen offset:1024 lds
buffer_load_dwordx4 v17, s[68:71], s95 offen offset:2048 lds
buffer_load_dwordx4 v18, s[68:71], s95 offen offset:3072 lds
v_xor_b32 v224, 0, v5
v_add_u32 v224, s85, v224
v_xor_b32 v225, 64, v5
v_add_u32 v225, s85, v225
v_and_b32 v31, 31, v0
v_mul_u32_u24 v31, 768, v31
v_add_u32 v31, v31, v2
v_add_u32 v226, 114688, v31
v_xor_b32 v227, 32, v226
v_xor_b32 v228, 64, v226
v_xor_b32 v229, 96, v226
v_xor_b32 v230, 128, v226
v_xor_b32 v231, 160, v226
v_xor_b32 v232, 192, v226
v_xor_b32 v233, 224, v226
s_waitcnt vmcnt(12)
s_barrier
v_mov_b32 v102, 0
buffer_load_dwordx2 v[100:101], v102, s[32:35], 0 offen
s_waitcnt vmcnt(9)
ds_read_b64_tr_b16 a[0:1], v224 offset:0
ds_read_b64_tr_b16 a[2:3], v224 offset:512
ds_read_b64_tr_b16 a[4:5], v225 offset:0
ds_read_b64_tr_b16 a[6:7], v225 offset:512
ds_read_b64_tr_b16 a[8:9], v224 offset:2048
ds_read_b64_tr_b16 a[10:11], v224 offset:2560
ds_read_b64_tr_b16 a[12:13], v225 offset:2048
ds_read_b64_tr_b16 a[14:15], v225 offset:2560
ds_read_b128 v[64:67], v226 offset:0
ds_read_b128 v[68:71], v227 offset:0
s_waitcnt lgkmcnt(0)
s_add_u32 s95, s81, 786432
s_add_u32 m0, s85, 0
s_nop 0
buffer_load_dwordx4 v15, s[68:71], s95 offen offset:0 lds
buffer_load_dwordx4 v16, s[68:71], s95 offen offset:1024 lds
buffer_load_dwordx4 v17, s[68:71], s95 offen offset:2048 lds
buffer_load_dwordx4 v18, s[68:71], s95 offen offset:3072 lds
s_waitcnt vmcnt(9)
ds_read_b64_tr_b16 a[16:17], v224 offset:4096
ds_read_b64_tr_b16 a[18:19], v224 offset:4608
ds_read_b64_tr_b16 a[20:21], v225 offset:4096
ds_read_b64_tr_b16 a[22:23], v225 offset:4608
ds_read_b64_tr_b16 a[24:25], v224 offset:6144
ds_read_b64_tr_b16 a[26:27], v224 offset:6656
ds_read_b64_tr_b16 a[28:29], v225 offset:6144
ds_read_b64_tr_b16 a[30:31], v225 offset:6656
ds_read_b128 v[72:75], v228 offset:0
ds_read_b128 v[76:79], v229 offset:0
v_mfma_f32_32x32x16_bf16 v[160:175], a[0:3], v[64:67], 0
v_mfma_f32_32x32x16_bf16 v[176:191], a[4:7], v[64:67], 0
v_mfma_f32_32x32x16_bf16 v[160:175], a[8:11], v[68:71], v[160:175]
s_waitcnt lgkmcnt(0)
s_add_u32 s95, s81, 1048576
s_add_u32 m0, s85, 4096
s_nop 0
buffer_load_dwordx4 v15, s[68:71], s95 offen offset:0 lds
buffer_load_dwordx4 v16, s[68:71], s95 offen offset:1024 lds
v_mfma_f32_32x32x16_bf16 v[176:191], a[12:15], v[68:71], v[176:191]
buffer_load_dwordx4 v17, s[68:71], s95 offen offset:2048 lds
buffer_load_dwordx4 v18, s[68:71], s95 offen offset:3072 lds
s_waitcnt vmcnt(9)
ds_read_b64_tr_b16 a[32:33], v224 offset:8192
ds_read_b64_tr_b16 a[34:35], v224 offset:8704
ds_read_b64_tr_b16 a[36:37], v225 offset:8192
ds_read_b64_tr_b16 a[38:39], v225 offset:8704
ds_read_b64_tr_b16 a[40:41], v224 offset:10240
ds_read_b64_tr_b16 a[42:43], v224 offset:10752
ds_read_b64_tr_b16 a[44:45], v225 offset:10240
ds_read_b64_tr_b16 a[46:47], v225 offset:10752
ds_read_b128 v[64:67], v230 offset:0
ds_read_b128 v[68:71], v231 offset:0
v_mfma_f32_32x32x16_bf16 v[160:175], a[16:19], v[72:75], v[160:175]
v_mfma_f32_32x32x16_bf16 v[176:191], a[20:23], v[72:75], v[176:191]
v_mfma_f32_32x32x16_bf16 v[160:175], a[24:27], v[76:79], v[160:175]
s_waitcnt lgkmcnt(0)
s_add_u32 s95, s81, 1310720
s_add_u32 m0, s85, 8192
s_nop 0
buffer_load_dwordx4 v15, s[68:71], s95 offen offset:0 lds
buffer_load_dwordx4 v16, s[68:71], s95 offen offset:1024 lds
v_mfma_f32_32x32x16_bf16 v[176:191], a[28:31], v[76:79], v[176:191]
buffer_load_dwordx4 v17, s[68:71], s95 offen offset:2048 lds
buffer_load_dwordx4 v18, s[68:71], s95 offen offset:3072 lds
s_waitcnt vmcnt(8)
ds_read_b64_tr_b16 a[48:49], v224 offset:0
ds_read_b64_tr_b16 a[50:51], v224 offset:512
ds_read_b64_tr_b16 a[52:53], v225 offset:0
ds_read_b64_tr_b16 a[54:55], v225 offset:512
ds_read_b64_tr_b16 a[56:57], v224 offset:2048
ds_read_b64_tr_b16 a[58:59], v224 offset:2560
ds_read_b64_tr_b16 a[60:61], v225 offset:2048
ds_read_b64_tr_b16 a[62:63], v225 offset:2560
ds_read_b128 v[72:75], v232 offset:0
ds_read_b128 v[76:79], v233 offset:0
v_mfma_f32_32x32x16_bf16 v[160:175], a[32:35], v[64:67], v[160:175]
v_mfma_f32_32x32x16_bf16 v[176:191], a[36:39], v[64:67], v[176:191]
v_mfma_f32_32x32x16_bf16 v[160:175], a[40:43], v[68:71], v[160:175]
s_waitcnt lgkmcnt(0)
s_add_u32 s95, s81, 1572864
s_add_u32 m0, s85, 0
s_nop 0
buffer_load_dwordx4 v15, s[68:71], s95 offen offset:0 lds
buffer_load_dwordx4 v16, s[68:71], s95 offen offset:1024 lds
v_mfma_f32_32x32x16_bf16 v[176:191], a[44:47], v[68:71], v[176:191]
buffer_load_dwordx4 v17, s[68:71], s95 offen offset:2048 lds
buffer_load_dwordx4 v18, s[68:71], s95 offen offset:3072 lds
s_waitcnt vmcnt(8)
ds_read_b64_tr_b16 a[64:65], v224 offset:4096
ds_read_b64_tr_b16 a[66:67], v224 offset:4608
ds_read_b64_tr_b16 a[68:69], v225 offset:4096
ds_read_b64_tr_b16 a[70:71], v225 offset:4608
ds_read_b64_tr_b16 a[72:73], v224 offset:6144
ds_read_b64_tr_b16 a[74:75], v224 offset:6656
ds_read_b64_tr_b16 a[76:77], v225 offset:6144
ds_read_b64_tr_b16 a[78:79], v225 offset:6656
ds_read_b128 v[64:67], v226 offset:256
ds_read_b128 v[68:71], v227 offset:256
v_mfma_f32_32x32x16_bf16 v[160:175], a[48:51], v[72:75], v[160:175]
v_mfma_f32_32x32x16_bf16 v[176:191], a[52:55], v[72:75], v[176:191]
v_mfma_f32_32x32x16_bf16 v[160:175], a[56:59], v[76:79], v[160:175]
s_waitcnt lgkmcnt(0)
s_add_u32 s95, s81, 1835008
s_add_u32 m0, s85, 4096
s_nop 0
buffer_load_dwordx4 v15, s[68:71], s95 offen offset:0 lds
buffer_load_dwordx4 v16, s[68:71], s95 offen offset:1024 lds
v_mfma_f32_32x32x16_bf16 v[176:191], a[60:63], v[76:79], v[176:191]
buffer_load_dwordx4 v17, s[68:71], s95 offen offset:2048 lds
buffer_load_dwordx4 v18, s[68:71], s95 offen offset:3072 lds
s_waitcnt vmcnt(8)
ds_read_b64_tr_b16 a[80:81], v224 offset:8192
ds_read_b64_tr_b16 a[82:83], v224 offset:8704
ds_read_b64_tr_b16 a[84:85], v225 offset:8192
ds_read_b64_tr_b16 a[86:87], v225 offset:8704
ds_read_b64_tr_b16 a[88:89], v224 offset:10240
ds_read_b64_tr_b16 a[90:91], v224 offset:10752
ds_read_b64_tr_b16 a[92:93], v225 offset:10240
ds_read_b64_tr_b16 a[94:95], v225 offset:10752
ds_read_b128 v[72:75], v228 offset:256
ds_read_b128 v[76:79], v229 offset:256
v_mfma_f32_32x32x16_bf16 v[160:175], a[64:67], v[64:67], v[160:175]
v_mfma_f32_32x32x16_bf16 v[176:191], a[68:71], v[64:67], v[176:191]
v_mfma_f32_32x32x16_bf16 v[160:175], a[72:75], v[68:71], v[160:175]
s_waitcnt lgkmcnt(0)
s_add_u32 s95, s81, 2097152
s_add_u32 m0, s85, 8192
s_nop 0
buffer_load_dwordx4 v15, s[68:71], s95 offen offset:0 lds
buffer_load_dwordx4 v16, s[68:71], s95 offen offset:1024 lds
v_mfma_f32_32x32x16_bf16 v[176:191], a[76:79], v[68:71], v[176:191]
buffer_load_dwordx4 v17, s[68:71], s95 offen offset:2048 lds
buffer_load_dwordx4 v18, s[68:71], s95 offen offset:3072 lds
s_waitcnt vmcnt(8)
ds_read_b64_tr_b16 a[96:97], v224 offset:0
ds_read_b64_tr_b16 a[98:99], v224 offset:512
ds_read_b64_tr_b16 a[100:101], v225 offset:0
ds_read_b64_tr_b16 a[102:103], v225 offset:512
ds_read_b64_tr_b16 a[104:105], v224 offset:2048
ds_read_b64_tr_b16 a[106:107], v224 offset:2560
ds_read_b64_tr_b16 a[108:109], v225 offset:2048
ds_read_b64_tr_b16 a[110:111], v225 offset:2560
ds_read_b128 v[64:67], v230 offset:256
ds_read_b128 v[68:71], v231 offset:256
v_mfma_f32_32x32x16_bf16 v[160:175], a[80:83], v[72:75], v[160:175]
v_mfma_f32_32x32x16_bf16 v[176:191], a[84:87], v[72:75], v[176:191]
v_mfma_f32_32x32x16_bf16 v[160:175], a[88:91], v[76:79], v[160:175]
s_waitcnt lgkmcnt(0)
s_add_u32 s95, s81, 2359296
s_add_u32 m0, s85, 0
s_nop 0
buffer_load_dwordx4 v15, s[68:71], s95 offen offset:0 lds
buffer_load_dwordx4 v16, s[68:71], s95 offen offset:1024 lds
v_mfma_f32_32x32x16_bf16 v[176:191], a[92:95], v[76:79], v[176:191]
buffer_load_dwordx4 v17, s[68:71], s95 offen offset:2048 lds
buffer_load_dwordx4 v18, s[68:71], s95 offen offset:3072 lds
s_waitcnt vmcnt(8)
ds_read_b64_tr_b16 a[112:113], v224 offset:4096
ds_read_b64_tr_b16 a[114:115], v224 offset:4608
ds_read_b64_tr_b16 a[116:117], v225 offset:4096
ds_read_b64_tr_b16 a[118:119], v225 offset:4608
ds_read_b64_tr_b16 a[120:121], v224 offset:6144
ds_read_b64_tr_b16 a[122:123], v224 offset:6656
ds_read_b64_tr_b16 a[124:125], v225 offset:6144
ds_read_b64_tr_b16 a[126:127], v225 offset:6656
ds_read_b128 v[72:75], v232 offset:256
ds_read_b128 v[76:79], v233 offset:256
v_mfma_f32_32x32x16_bf16 v[160:175], a[96:99], v[64:67], v[160:175]
v_mfma_f32_32x32x16_bf16 v[176:191], a[100:103], v[64:67], v[176:191]
v_mfma_f32_32x32x16_bf16 v[160:175], a[104:107], v[68:71], v[160:175]
s_waitcnt lgkmcnt(0)
s_add_u32 s95, s81, 2621440
s_add_u32 m0, s85, 4096
s_nop 0
buffer_load_dwordx4 v15, s[68:71], s95 offen offset:0 lds
buffer_load_dwordx4 v16, s[68:71], s95 offen offset:1024 lds
v_mfma_f32_32x32x16_bf16 v[176:191], a[108:111], v[68:71], v[176:191]
buffer_load_dwordx4 v17, s[68:71], s95 offen offset:2048 lds
buffer_load_dwordx4 v18, s[68:71], s95 offen offset:3072 lds
s_waitcnt vmcnt(8)
ds_read_b64_tr_b16 a[128:129], v224 offset:8192
ds_read_b64_tr_b16 a[130:131], v224 offset:8704
ds_read_b64_tr_b16 a[132:133], v225 offset:8192
ds_read_b64_tr_b16 a[134:135], v225 offset:8704
ds_read_b64_tr_b16 a[136:137], v224 offset:10240
ds_read_b64_tr_b16 a[138:139], v224 offset:10752
ds_read_b64_tr_b16 a[140:141], v225 offset:10240
ds_read_b64_tr_b16 a[142:143], v225 offset:10752
ds_read_b128 v[64:67], v226 offset:512
ds_read_b128 v[68:71], v227 offset:512
v_mfma_f32_32x32x16_bf16 v[160:175], a[112:115], v[72:75], v[160:175]
v_mfma_f32_32x32x16_bf16 v[176:191], a[116:119], v[72:75], v[176:191]
v_mfma_f32_32x32x16_bf16 v[160:175], a[120:123], v[76:79], v[160:175]
s_waitcnt lgkmcnt(0)
s_add_u32 s95, s81, 2883584
s_add_u32 m0, s85, 8192
s_nop 0
buffer_load_dwordx4 v15, s[68:71], s95 offen offset:0 lds
buffer_load_dwordx4 v16, s[68:71], s95 offen offset:1024 lds
v_mfma_f32_32x32x16_bf16 v[176:191], a[124:127], v[76:79], v[176:191]
buffer_load_dwordx4 v17, s[68:71], s95 offen offset:2048 lds
buffer_load_dwordx4 v18, s[68:71], s95 offen offset:3072 lds
s_waitcnt vmcnt(8)
ds_read_b64_tr_b16 a[144:145], v224 offset:0
ds_read_b64_tr_b16 a[146:147], v224 offset:512
ds_read_b64_tr_b16 a[148:149], v225 offset:0
ds_read_b64_tr_b16 a[150:151], v225 offset:512
ds_read_b64_tr_b16 a[152:153], v224 offset:2048
ds_read_b64_tr_b16 a[154:155], v224 offset:2560
ds_read_b64_tr_b16 a[156:157], v225 offset:2048
ds_read_b64_tr_b16 a[158:159], v225 offset:2560
ds_read_b128 v[72:75], v228 offset:512
ds_read_b128 v[76:79], v229 offset:512
v_mfma_f32_32x32x16_bf16 v[160:175], a[128:131], v[64:67], v[160:175]
v_mfma_f32_32x32x16_bf16 v[176:191], a[132:135], v[64:67], v[176:191]
v_mfma_f32_32x32x16_bf16 v[160:175], a[136:139], v[68:71], v[160:175]
s_waitcnt lgkmcnt(0)
s_add_u32 s95, s81, 3145728
s_add_u32 m0, s85, 0
s_nop 0
buffer_load_dwordx4 v15, s[68:71], s95 offen offset:0 lds
buffer_load_dwordx4 v16, s[68:71], s95 offen offset:1024 lds
v_mfma_f32_32x32x16_bf16 v[176:191], a[140:143], v[68:71], v[176:191]
buffer_load_dwordx4 v17, s[68:71], s95 offen offset:2048 lds
buffer_load_dwordx4 v18, s[68:71], s95 offen offset:3072 lds
s_waitcnt vmcnt(8)
ds_read_b64_tr_b16 a[160:161], v224 offset:4096
ds_read_b64_tr_b16 a[162:163], v224 offset:4608
ds_read_b64_tr_b16 a[164:165], v225 offset:4096
ds_read_b64_tr_b16 a[166:167], v225 offset:4608
ds_read_b64_tr_b16 a[168:169], v224 offset:6144
ds_read_b64_tr_b16 a[170:171], v224 offset:6656
ds_read_b64_tr_b16 a[172:173], v225 offset:6144
ds_read_b64_tr_b16 a[174:175], v225 offset:6656
ds_read_b128 v[64:67], v230 offset:512
ds_read_b128 v[68:71], v231 offset:512
v_mfma_f32_32x32x16_bf16 v[160:175], a[144:147], v[72:75], v[160:175]
v_mfma_f32_32x32x16_bf16 v[176:191], a[148:151], v[72:75], v[176:191]
v_mfma_f32_32x32x16_bf16 v[160:175], a[152:155], v[76:79], v[160:175]
s_waitcnt lgkmcnt(0)
s_add_u32 s95, s81, 3407872
s_add_u32 m0, s85, 4096
s_nop 0
buffer_load_dwordx4 v15, s[68:71], s95 offen offset:0 lds
buffer_load_dwordx4 v16, s[68:71], s95 offen offset:1024 lds
v_mfma_f32_32x32x16_bf16 v[176:191], a[156:159], v[76:79], v[176:191]
buffer_load_dwordx4 v17, s[68:71], s95 offen offset:2048 lds
buffer_load_dwordx4 v18, s[68:71], s95 offen offset:3072 lds
s_waitcnt vmcnt(8)
ds_read_b64_tr_b16 a[176:177], v224 offset:8192
ds_read_b64_tr_b16 a[178:179], v224 offset:8704
ds_read_b64_tr_b16 a[180:181], v225 offset:8192
ds_read_b64_tr_b16 a[182:183], v225 offset:8704
ds_read_b64_tr_b16 a[184:185], v224 offset:10240
ds_read_b64_tr_b16 a[186:187], v224 offset:10752
ds_read_b64_tr_b16 a[188:189], v225 offset:10240
ds_read_b64_tr_b16 a[190:191], v225 offset:10752
ds_read_b128 v[72:75], v232 offset:512
ds_read_b128 v[76:79], v233 offset:512
v_mfma_f32_32x32x16_bf16 v[160:175], a[160:163], v[64:67], v[160:175]
v_mfma_f32_32x32x16_bf16 v[176:191], a[164:167], v[64:67], v[176:191]
v_mfma_f32_32x32x16_bf16 v[160:175], a[168:171], v[68:71], v[160:175]
s_waitcnt lgkmcnt(0)
s_add_u32 s95, s81, 3670016
s_add_u32 m0, s85, 8192
s_nop 0
buffer_load_dwordx4 v15, s[68:71], s95 offen offset:0 lds
buffer_load_dwordx4 v16, s[68:71], s95 offen offset:1024 lds
v_mfma_f32_32x32x16_bf16 v[176:191], a[172:175], v[68:71], v[176:191]
buffer_load_dwordx4 v17, s[68:71], s95 offen offset:2048 lds
buffer_load_dwordx4 v18, s[68:71], s95 offen offset:3072 lds
s_waitcnt vmcnt(8)
ds_read_b64_tr_b16 a[192:193], v224 offset:0
ds_read_b64_tr_b16 a[194:195], v224 offset:512
ds_read_b64_tr_b16 a[196:197], v225 offset:0
ds_read_b64_tr_b16 a[198:199], v225 offset:512
ds_read_b64_tr_b16 a[200:201], v224 offset:2048
ds_read_b64_tr_b16 a[202:203], v224 offset:2560
ds_read_b64_tr_b16 a[204:205], v225 offset:2048
ds_read_b64_tr_b16 a[206:207], v225 offset:2560
ds_read_b128 v[64:67], v226 offset:768
ds_read_b128 v[68:71], v227 offset:768
v_mfma_f32_32x32x16_bf16 v[160:175], a[176:179], v[72:75], v[160:175]
v_mfma_f32_32x32x16_bf16 v[176:191], a[180:183], v[72:75], v[176:191]
v_mfma_f32_32x32x16_bf16 v[160:175], a[184:187], v[76:79], v[160:175]
s_waitcnt lgkmcnt(0)
s_add_u32 s95, s81, 3932160
s_add_u32 m0, s85, 0
s_nop 0
buffer_load_dwordx4 v15, s[68:71], s95 offen offset:0 lds
buffer_load_dwordx4 v16, s[68:71], s95 offen offset:1024 lds
v_mfma_f32_32x32x16_bf16 v[176:191], a[188:191], v[76:79], v[176:191]
buffer_load_dwordx4 v17, s[68:71], s95 offen offset:2048 lds
buffer_load_dwordx4 v18, s[68:71], s95 offen offset:3072 lds
s_waitcnt vmcnt(8)
ds_read_b64_tr_b16 a[208:209], v224 offset:4096
ds_read_b64_tr_b16 a[210:211], v224 offset:4608
ds_read_b64_tr_b16 a[212:213], v225 offset:4096
ds_read_b64_tr_b16 a[214:215], v225 offset:4608
ds_read_b64_tr_b16 a[216:217], v224 offset:6144
ds_read_b64_tr_b16 a[218:219], v224 offset:6656
ds_read_b64_tr_b16 a[220:221], v225 offset:6144
ds_read_b64_tr_b16 a[222:223], v225 offset:6656
ds_read_b128 v[72:75], v228 offset:768
ds_read_b128 v[76:79], v229 offset:768
v_mfma_f32_32x32x16_bf16 v[160:175], a[192:195], v[64:67], v[160:175]
v_mfma_f32_32x32x16_bf16 v[176:191], a[196:199], v[64:67], v[176:191]
v_mfma_f32_32x32x16_bf16 v[160:175], a[200:203], v[68:71], v[160:175]
s_waitcnt lgkmcnt(0)
s_add_u32 s95, s3, 0
s_and_b32 s95, s95, 7
s_lshl_b32 s95, s95, 14
s_add_u32 s95, s95, s96
s_add_u32 m0, s31, 0
s_nop 0
buffer_load_dwordx4 v6, s[60:63], s95 offen offset:0 nt lds
buffer_load_dwordx4 v7, s[60:63], s95 offen offset:1024 nt lds
v_mfma_f32_32x32x16_bf16 v[176:191], a[204:207], v[68:71], v[176:191]
buffer_load_dwordx4 v8, s[60:63], s95 offen offset:2048 nt lds
buffer_load_dwordx4 v9, s[60:63], s95 offen offset:3072 nt lds
s_waitcnt vmcnt(8)
ds_read_b64_tr_b16 a[224:225], v224 offset:8192
ds_read_b64_tr_b16 a[226:227], v224 offset:8704
ds_read_b64_tr_b16 a[228:229], v225 offset:8192
ds_read_b64_tr_b16 a[230:231], v225 offset:8704
ds_read_b64_tr_b16 a[232:233], v224 offset:10240
ds_read_b64_tr_b16 a[234:235], v224 offset:10752
ds_read_b64_tr_b16 a[236:237], v225 offset:10240
ds_read_b64_tr_b16 a[238:239], v225 offset:10752
ds_read_b128 v[64:67], v230 offset:768
ds_read_b128 v[68:71], v231 offset:768
v_mfma_f32_32x32x16_bf16 v[160:175], a[208:211], v[72:75], v[160:175]
v_mfma_f32_32x32x16_bf16 v[176:191], a[212:215], v[72:75], v[176:191]
v_mfma_f32_32x32x16_bf16 v[160:175], a[216:219], v[76:79], v[160:175]
s_waitcnt lgkmcnt(0)
s_add_u32 s95, s95, 4096
s_add_u32 m0, s31, 4096
s_nop 0
buffer_load_dwordx4 v6, s[60:63], s95 offen offset:0 nt lds
buffer_load_dwordx4 v7, s[60:63], s95 offen offset:1024 nt lds
v_mfma_f32_32x32x16_bf16 v[176:191], a[220:223], v[76:79], v[176:191]
buffer_load_dwordx4 v8, s[60:63], s95 offen offset:2048 nt lds
buffer_load_dwordx4 v9, s[60:63], s95 offen offset:3072 nt lds
s_waitcnt vmcnt(8)
ds_read_b64_tr_b16 a[240:241], v224 offset:0
ds_read_b64_tr_b16 a[242:243], v224 offset:512
ds_read_b64_tr_b16 a[244:245], v225 offset:0
ds_read_b64_tr_b16 a[246:247], v225 offset:512
ds_read_b64_tr_b16 a[248:249], v224 offset:2048
ds_read_b64_tr_b16 a[250:251], v224 offset:2560
ds_read_b64_tr_b16 a[252:253], v225 offset:2048
ds_read_b64_tr_b16 a[254:255], v225 offset:2560
ds_read_b128 v[72:75], v232 offset:768
ds_read_b128 v[76:79], v233 offset:768
v_mfma_f32_32x32x16_bf16 v[160:175], a[224:227], v[64:67], v[160:175]
v_mfma_f32_32x32x16_bf16 v[176:191], a[228:231], v[64:67], v[176:191]
v_mfma_f32_32x32x16_bf16 v[160:175], a[232:235], v[68:71], v[160:175]
s_waitcnt lgkmcnt(0)
s_add_u32 s95, s3, 1
s_and_b32 s95, s95, 7
s_lshl_b32 s95, s95, 14
s_add_u32 s95, s95, s96
s_add_u32 m0, s31, 8192
s_nop 0
buffer_load_dwordx4 v6, s[60:63], s95 offen offset:0 nt lds
buffer_load_dwordx4 v7, s[60:63], s95 offen offset:1024 nt lds
v_mfma_f32_32x32x16_bf16 v[176:191], a[236:239], v[68:71], v[176:191]
buffer_load_dwordx4 v8, s[60:63], s95 offen offset:2048 nt lds
buffer_load_dwordx4 v9, s[60:63], s95 offen offset:3072 nt lds
s_add_u32 s95, s95, 4096
s_add_u32 m0, s31, 12288
s_nop 0
buffer_load_dwordx4 v6, s[60:63], s95 offen offset:0 nt lds
buffer_load_dwordx4 v7, s[60:63], s95 offen offset:1024 nt lds
v_mfma_f32_32x32x16_bf16 v[160:175], a[240:243], v[72:75], v[160:175]
buffer_load_dwordx4 v8, s[60:63], s95 offen offset:2048 nt lds
buffer_load_dwordx4 v9, s[60:63], s95 offen offset:3072 nt lds
v_mfma_f32_32x32x16_bf16 v[176:191], a[244:247], v[72:75], v[176:191]
v_mfma_f32_32x32x16_bf16 v[160:175], a[248:251], v[76:79], v[160:175]
v_mfma_f32_32x32x16_bf16 v[176:191], a[252:255], v[76:79], v[176:191]
s_nop 10
v_cvt_pk_bf16_f32 v80, v160, v161
v_cvt_pk_bf16_f32 v81, v162, v163
v_cvt_pk_bf16_f32 v82, v164, v165
v_cvt_pk_bf16_f32 v83, v166, v167
v_cvt_pk_bf16_f32 v84, v168, v169
v_cvt_pk_bf16_f32 v85, v170, v171
v_cvt_pk_bf16_f32 v86, v172, v173
v_cvt_pk_bf16_f32 v87, v174, v175
v_cvt_pk_bf16_f32 v88, v176, v177
v_cvt_pk_bf16_f32 v89, v178, v179
v_cvt_pk_bf16_f32 v90, v180, v181
v_cvt_pk_bf16_f32 v91, v182, v183
v_cvt_pk_bf16_f32 v92, v184, v185
v_cvt_pk_bf16_f32 v93, v186, v187
v_cvt_pk_bf16_f32 v94, v188, v189
v_cvt_pk_bf16_f32 v95, v190, v191
s_lshl_b32 s93, s26, 12
s_add_u32 s93, s93, 147456
v_add_u32 v31, s93, v1
ds_write_b128 v31, v[80:83] offset:0
ds_write_b128 v31, v[84:87] offset:1024
ds_write_b128 v31, v[88:91] offset:2048
ds_write_b128 v31, v[92:95] offset:3072
s_mov_b32 s93, 0
L_pollE1:
v_readfirstlane_b32 s100, v100
v_readfirstlane_b32 s101, v101
s_nop 0
s_cmp_lg_u32 s100, 0
s_cbranch_scc1 L_polledE1
s_add_u32 s93, s93, 1
s_cmp_ge_u32 s93, 400000
s_cbranch_scc1 L_polledE1
s_sleep 8
buffer_load_dwordx2 v[100:101], v102, s[32:35], 0 offen sc1
s_waitcnt vmcnt(0)
s_branch L_pollE1
L_polledE1:
s_waitcnt lgkmcnt(0)
s_barrier
s_add_u32 s92, s80, 32768
s_add_u32 m0, s86, 0
s_nop 0
buffer_load_dwordx4 v48, s[56:59], s92 offen offset:0 lds
buffer_load_dwordx4 v49, s[56:59], s92 offen offset:1024 lds
buffer_load_dwordx4 v50, s[56:59], s92 offen offset:2048 lds
buffer_load_dwordx4 v51, s[56:59], s92 offen offset:3072 lds
s_add_u32 s92, s80, 36864
s_add_u32 m0, s86, 4096
s_nop 0
buffer_load_dwordx4 v52, s[56:59], s92 offen offset:0 lds
buffer_load_dwordx4 v53, s[56:59], s92 offen offset:1024 lds
buffer_load_dwordx4 v54, s[56:59], s92 offen offset:2048 lds
buffer_load_dwordx4 v55, s[56:59], s92 offen offset:3072 lds
s_lshl_b32 s93, s30, 13
s_add_u32 s93, s93, 147456
v_add_u32 v31, s93, v1
ds_read_b128 v[192:195], v31 offset:0
ds_read_b128 v[196:199], v31 offset:1024
ds_read_b128 v[200:203], v31 offset:2048
ds_read_b128 v[204:207], v31 offset:3072
ds_read_b128 v[208:211], v31 offset:4096
ds_read_b128 v[212:215], v31 offset:5120
ds_read_b128 v[216:219], v31 offset:6144
ds_read_b128 v[220:223], v31 offset:7168
v_add_u32 v19, s31, v2
v_xor_b32 v20, 32, v19
v_xor_b32 v21, 64, v19
v_xor_b32 v22, 96, v19
v_xor_b32 v23, 128, v19
v_xor_b32 v24, 160, v19
v_xor_b32 v25, 192, v19
v_xor_b32 v26, 224, v19
s_waitcnt lgkmcnt(0)
s_waitcnt vmcnt(16)
ds_read_b128 v[224:227], v19 offset:0
ds_read_b128 v[228:231], v20 offset:0
ds_read_b128 v[232:235], v21 offset:0
ds_read_b128 v[236:239], v22 offset:0
ds_read_b128 v[240:243], v23 offset:0
ds_read_b128 v[244:247], v24 offset:0
ds_read_b128 v[248:251], v25 offset:0
ds_read_b128 v[252:255], v26 offset:0
s_waitcnt lgkmcnt(0)
s_add_u32 s95, s3, 2
s_and_b32 s95, s95, 7
s_lshl_b32 s95, s95, 14
s_add_u32 s95, s95, s96
s_add_u32 m0, s31, 0
s_nop 0
buffer_load_dwordx4 v6, s[60:63], s95 offen offset:0 nt lds
v_mfma_f32_32x32x16_bf16 v[32:47], v[224:227], v[192:195], 0
buffer_load_dwordx4 v7, s[60:63], s95 offen offset:1024 nt lds
v_mfma_f32_32x32x16_bf16 v[32:47], v[228:231], v[196:199], v[32:47]
buffer_load_dwordx4 v8, s[60:63], s95 offen offset:2048 nt lds
v_mfma_f32_32x32x16_bf16 v[32:47], v[232:235], v[200:203], v[32:47]
buffer_load_dwordx4 v9, s[60:63], s95 offen offset:3072 nt lds
v_mfma_f32_32x32x16_bf16 v[32:47], v[236:239], v[204:207], v[32:47]
s_add_u32 s95, s95, 4096
s_add_u32 m0, s31, 4096
s_nop 0
buffer_load_dwordx4 v6, s[60:63], s95 offen offset:0 nt lds
v_mfma_f32_32x32x16_bf16 v[32:47], v[240:243], v[208:211], v[32:47]
buffer_load_dwordx4 v7, s[60:63], s95 offen offset:1024 nt lds
v_mfma_f32_32x32x16_bf16 v[32:47], v[244:247], v[212:215], v[32:47]
buffer_load_dwordx4 v8, s[60:63], s95 offen offset:2048 nt lds
v_mfma_f32_32x32x16_bf16 v[32:47], v[248:251], v[216:219], v[32:47]
buffer_load_dwordx4 v9, s[60:63], s95 offen offset:3072 nt lds
v_mfma_f32_32x32x16_bf16 v[32:47], v[252:255], v[220:223], v[32:47]
s_waitcnt vmcnt(16)
ds_read_b128 v[224:227], v19 offset:8192
ds_read_b128 v[228:231], v20 offset:8192
ds_read_b128 v[232:235], v21 offset:8192
ds_read_b128 v[236:239], v22 offset:8192
ds_read_b128 v[240:243], v23 offset:8192
ds_read_b128 v[244:247], v24 offset:8192
ds_read_b128 v[248:251], v25 offset:8192
ds_read_b128 v[252:255], v26 offset:8192
s_nop 2
v_max_f32 v27, v32, v33
v_max3_f32 v27, v27, v34, v35
v_max3_f32 v27, v27, v36, v37
v_max3_f32 v27, v27, v38, v39
v_max3_f32 v27, v27, v40, v41
v_max3_f32 v27, v27, v42, v43
v_max3_f32 v27, v27, v44, v45
v_max3_f32 v27, v27, v46, v47
s_waitcnt lgkmcnt(0)
s_add_u32 s95, s3, 3
s_and_b32 s95, s95, 7
s_lshl_b32 s95, s95, 14
s_add_u32 s95, s95, s96
s_add_u32 m0, s31, 8192
s_nop 0
buffer_load_dwordx4 v6, s[60:63], s95 offen offset:0 nt lds
v_mfma_f32_32x32x16_bf16 v[48:63], v[224:227], v[192:195], 0
buffer_load_dwordx4 v7, s[60:63], s95 offen offset:1024 nt lds
v_mfma_f32_32x32x16_bf16 v[48:63], v[228:231], v[196:199], v[48:63]
buffer_load_dwordx4 v8, s[60:63], s95 offen offset:2048 nt lds
v_mfma_f32_32x32x16_bf16 v[48:63], v[232:235], v[200:203], v[48:63]
buffer_load_dwordx4 v9, s[60:63], s95 offen offset:3072 nt lds
v_mfma_f32_32x32x16_bf16 v[48:63], v[236:239], v[204:207], v[48:63]
s_add_u32 s95, s95, 4096
s_add_u32 m0, s31, 12288
s_nop 0
buffer_load_dwordx4 v6, s[60:63], s95 offen offset:0 nt lds
v_mfma_f32_32x32x16_bf16 v[48:63], v[240:243], v[208:211], v[48:63]
buffer_load_dwordx4 v7, s[60:63], s95 offen offset:1024 nt lds
v_mfma_f32_32x32x16_bf16 v[48:63], v[244:247], v[212:215], v[48:63]
buffer_load_dwordx4 v8, s[60:63], s95 offen offset:2048 nt lds
v_mfma_f32_32x32x16_bf16 v[48:63], v[248:251], v[216:219], v[48:63]
buffer_load_dwordx4 v9, s[60:63], s95 offen offset:3072 nt lds
v_mfma_f32_32x32x16_bf16 v[48:63], v[252:255], v[220:223], v[48:63]
v_and_b32 v31, 31, v0
v_mul_u32_u24 v31, 768, v31
v_add_u32 v31, v31, v2
v_add_u32 v240, 114688, v31
v_xor_b32 v241, 32, v240
v_xor_b32 v242, 64, v240
v_xor_b32 v243, 96, v240
v_xor_b32 v244, 128, v240
v_xor_b32 v245, 160, v240
v_xor_b32 v246, 192, v240
v_xor_b32 v247, 224, v240
s_waitcnt vmcnt(16)
s_barrier
ds_read_b128 v[224:227], v240 offset:0
ds_read_b128 v[228:231], v241 offset:0
ds_read_b128 v[232:235], v242 offset:0
ds_read_b128 v[236:239], v243 offset:0
s_waitcnt lgkmcnt(3)
v_mfma_f32_32x32x16_bf16 v[160:175], a[0:3], v[224:227], 0
v_mfma_f32_32x32x16_bf16 v[176:191], a[4:7], v[224:227], 0
ds_read_b128 v[224:227], v244 offset:0
s_waitcnt lgkmcnt(3)
v_mfma_f32_32x32x16_bf16 v[160:175], a[8:11], v[228:231], v[160:175]
v_mfma_f32_32x32x16_bf16 v[176:191], a[12:15], v[228:231], v[176:191]
ds_read_b128 v[228:231], v245 offset:0
s_waitcnt lgkmcnt(3)
v_mfma_f32_32x32x16_bf16 v[160:175], a[16:19], v[232:235], v[160:175]
v_mfma_f32_32x32x16_bf16 v[176:191], a[20:23], v[232:235], v[176:191]
ds_read_b128 v[232:235], v246 offset:0
s_waitcnt lgkmcnt(3)
v_mfma_f32_32x32x16_bf16 v[160:175], a[24:27], v[236:239], v[160:175]
v_mfma_f32_32x32x16_bf16 v[176:191], a[28:31], v[236:239], v[176:191]
ds_read_b128 v[236:239], v247 offset:0
s_waitcnt lgkmcnt(3)
v_mfma_f32_32x32x16_bf16 v[160:175], a[32:35], v[224:227], v[160:175]
v_mfma_f32_32x32x16_bf16 v[176:191], a[36:39], v[224:227], v[176:191]
ds_read_b128 v[224:227], v240 offset:256
s_waitcnt lgkmcnt(3)
v_mfma_f32_32x32x16_bf16 v[160:175], a[40:43], v[228:231], v[160:175]
v_mfma_f32_32x32x16_bf16 v[176:191], a[44:47], v[228:231], v[176:191]
ds_read_b128 v[228:231], v241 offset:256
s_waitcnt lgkmcnt(3)
v_mfma_f32_32x32x16_bf16 v[160:175], a[48:51], v[232:235], v[160:175]
v_mfma_f32_32x32x16_bf16 v[176:191], a[52:55], v[232:235], v[176:191]
ds_read_b128 v[232:235], v242 offset:256
s_waitcnt lgkmcnt(3)
v_mfma_f32_32x32x16_bf16 v[160:175], a[56:59], v[236:239], v[160:175]
v_mfma_f32_32x32x16_bf16 v[176:191], a[60:63], v[236:239], v[176:191]
s_waitcnt lgkmcnt(2)
v_mfma_f32_32x32x16_bf16 v[160:175], a[64:67], v[224:227], v[160:175]
v_mfma_f32_32x32x16_bf16 v[176:191], a[68:71], v[224:227], v[176:191]
s_waitcnt lgkmcnt(1)
v_mfma_f32_32x32x16_bf16 v[160:175], a[72:75], v[228:231], v[160:175]
v_mfma_f32_32x32x16_bf16 v[176:191], a[76:79], v[228:231], v[176:191]
s_waitcnt lgkmcnt(0)
v_mfma_f32_32x32x16_bf16 v[160:175], a[80:83], v[232:235], v[160:175]
v_mfma_f32_32x32x16_bf16 v[176:191], a[84:87], v[232:235], v[176:191]
s_waitcnt vmcnt(8)
ds_read_b128 v[224:227], v19 offset:0
ds_read_b128 v[228:231], v20 offset:0
ds_read_b128 v[232:235], v21 offset:0
ds_read_b128 v[236:239], v22 offset:0
ds_read_b128 v[240:243], v23 offset:0
ds_read_b128 v[244:247], v24 offset:0
ds_read_b128 v[248:251], v25 offset:0
ds_read_b128 v[252:255], v26 offset:0
v_max3_f32 v27, v27, v48, v49
v_max3_f32 v27, v27, v50, v51
v_max3_f32 v27, v27, v52, v53
v_max3_f32 v27, v27, v54, v55
v_max3_f32 v27, v27, v56, v57
v_max3_f32 v27, v27, v58, v59
v_max3_f32 v27, v27, v60, v61
v_max3_f32 v27, v27, v62, v63
s_waitcnt lgkmcnt(0)
s_add_u32 s95, s3, 4
s_and_b32 s95, s95, 7
s_lshl_b32 s95, s95, 14
s_add_u32 s95, s95, s96
s_add_u32 m0, s31, 0
s_nop 0
buffer_load_dwordx4 v6, s[60:63], s95 offen offset:0 nt lds
v_mfma_f32_32x32x16_bf16 v[64:79], v[224:227], v[192:195], 0
buffer_load_dwordx4 v7, s[60:63], s95 offen offset:1024 nt lds
v_mfma_f32_32x32x16_bf16 v[64:79], v[228:231], v[196:199], v[64:79]
buffer_load_dwordx4 v8, s[60:63], s95 offen offset:2048 nt lds
v_mfma_f32_32x32x16_bf16 v[64:79], v[232:235], v[200:203], v[64:79]
buffer_load_dwordx4 v9, s[60:63], s95 offen offset:3072 nt lds
v_mfma_f32_32x32x16_bf16 v[64:79], v[236:239], v[204:207], v[64:79]
s_add_u32 s95, s95, 4096
s_add_u32 m0, s31, 4096
s_nop 0
buffer_load_dwordx4 v6, s[60:63], s95 offen offset:0 nt lds
v_mfma_f32_32x32x16_bf16 v[64:79], v[240:243], v[208:211], v[64:79]
buffer_load_dwordx4 v7, s[60:63], s95 offen offset:1024 nt lds
v_mfma_f32_32x32x16_bf16 v[64:79], v[244:247], v[212:215], v[64:79]
buffer_load_dwordx4 v8, s[60:63], s95 offen offset:2048 nt lds
v_mfma_f32_32x32x16_bf16 v[64:79], v[248:251], v[216:219], v[64:79]
buffer_load_dwordx4 v9, s[60:63], s95 offen offset:3072 nt lds
v_mfma_f32_32x32x16_bf16 v[64:79], v[252:255], v[220:223], v[64:79]
v_and_b32 v31, 31, v0
v_mul_u32_u24 v31, 768, v31
v_add_u32 v31, v31, v2
v_add_u32 v240, 114688, v31
v_xor_b32 v241, 32, v240
v_xor_b32 v242, 64, v240
v_xor_b32 v243, 96, v240
v_xor_b32 v244, 128, v240
v_xor_b32 v245, 160, v240
v_xor_b32 v246, 192, v240
v_xor_b32 v247, 224, v240
ds_read_b128 v[236:239], v243 offset:256
ds_read_b128 v[224:227], v244 offset:256
ds_read_b128 v[228:231], v245 offset:256
ds_read_b128 v[232:235], v246 offset:256
s_waitcnt lgkmcnt(3)
v_mfma_f32_32x32x16_bf16 v[160:175], a[88:91], v[236:239], v[160:175]
v_mfma_f32_32x32x16_bf16 v[176:191], a[92:95], v[236:239], v[176:191]
ds_read_b128 v[236:239], v247 offset:256
s_waitcnt lgkmcnt(3)
v_mfma_f32_32x32x16_bf16 v[160:175], a[96:99], v[224:227], v[160:175]
v_mfma_f32_32x32x16_bf16 v[176:191], a[100:103], v[224:227], v[176:191]
ds_read_b128 v[224:227], v240 offset:512
s_waitcnt lgkmcnt(3)
v_mfma_f32_32x32x16_bf16 v[160:175], a[104:107], v[228:231], v[160:175]
v_mfma_f32_32x32x16_bf16 v[176:191], a[108:111], v[228:231], v[176:191]
ds_read_b128 v[228:231], v241 offset:512
s_waitcnt lgkmcnt(3)
v_mfma_f32_32x32x16_bf16 v[160:175], a[112:115], v[232:235], v[160:175]
v_mfma_f32_32x32x16_bf16 v[176:191], a[116:119], v[232:235], v[176:191]
ds_read_b128 v[232:235], v242 offset:512
s_waitcnt lgkmcnt(3)
v_mfma_f32_32x32x16_bf16 v[160:175], a[120:123], v[236:239], v[160:175]
v_mfma_f32_32x32x16_bf16 v[176:191], a[124:127], v[236:239], v[176:191]
ds_read_b128 v[236:239], v243 offset:512
s_waitcnt lgkmcnt(3)
v_mfma_f32_32x32x16_bf16 v[160:175], a[128:131], v[224:227], v[160:175]
v_mfma_f32_32x32x16_bf16 v[176:191], a[132:135], v[224:227], v[176:191]
ds_read_b128 v[224:227], v244 offset:512
s_waitcnt lgkmcnt(3)
v_mfma_f32_32x32x16_bf16 v[160:175], a[136:139], v[228:231], v[160:175]
v_mfma_f32_32x32x16_bf16 v[176:191], a[140:143], v[228:231], v[176:191]
ds_read_b128 v[228:231], v245 offset:512
s_waitcnt lgkmcnt(3)
v_mfma_f32_32x32x16_bf16 v[160:175], a[144:147], v[232:235], v[160:175]
v_mfma_f32_32x32x16_bf16 v[176:191], a[148:151], v[232:235], v[176:191]
s_waitcnt lgkmcnt(2)
v_mfma_f32_32x32x16_bf16 v[160:175], a[152:155], v[236:239], v[160:175]
v_mfma_f32_32x32x16_bf16 v[176:191], a[156:159], v[236:239], v[176:191]
s_waitcnt lgkmcnt(1)
v_mfma_f32_32x32x16_bf16 v[160:175], a[160:163], v[224:227], v[160:175]
v_mfma_f32_32x32x16_bf16 v[176:191], a[164:167], v[224:227], v[176:191]
s_waitcnt lgkmcnt(0)
v_mfma_f32_32x32x16_bf16 v[160:175], a[168:171], v[228:231], v[160:175]
v_mfma_f32_32x32x16_bf16 v[176:191], a[172:175], v[228:231], v[176:191]
s_waitcnt vmcnt(8)
ds_read_b128 v[224:227], v19 offset:8192
ds_read_b128 v[228:231], v20 offset:8192
ds_read_b128 v[232:235], v21 offset:8192
ds_read_b128 v[236:239], v22 offset:8192
ds_read_b128 v[240:243], v23 offset:8192
ds_read_b128 v[244:247], v24 offset:8192
ds_read_b128 v[248:251], v25 offset:8192
ds_read_b128 v[252:255], v26 offset:8192
v_max3_f32 v27, v27, v64, v65
v_max3_f32 v27, v27, v66, v67
v_max3_f32 v27, v27, v68, v69
v_max3_f32 v27, v27, v70, v71
v_max3_f32 v27, v27, v72, v73
v_max3_f32 v27, v27, v74, v75
v_max3_f32 v27, v27, v76, v77
v_max3_f32 v27, v27, v78, v79
s_waitcnt lgkmcnt(0)
s_add_u32 s95, s3, 5
s_and_b32 s95, s95, 7
s_lshl_b32 s95, s95, 14
s_add_u32 s95, s95, s96
s_add_u32 m0, s31, 8192
s_nop 0
buffer_load_dwordx4 v6, s[60:63], s95 offen offset:0 nt lds
v_mfma_f32_32x32x16_bf16 v[80:95], v[224:227], v[192:195], 0
buffer_load_dwordx4 v7, s[60:63], s95 offen offset:1024 nt lds
v_mfma_f32_32x32x16_bf16 v[80:95], v[228:231], v[196:199], v[80:95]
buffer_load_dwordx4 v8, s[60:63], s95 offen offset:2048 nt lds
v_mfma_f32_32x32x16_bf16 v[80:95], v[232:235], v[200:203], v[80:95]
buffer_load_dwordx4 v9, s[60:63], s95 offen offset:3072 nt lds
v_mfma_f32_32x32x16_bf16 v[80:95], v[236:239], v[204:207], v[80:95]
s_add_u32 s95, s95, 4096
s_add_u32 m0, s31, 12288
s_nop 0
buffer_load_dwordx4 v6, s[60:63], s95 offen offset:0 nt lds
v_mfma_f32_32x32x16_bf16 v[80:95], v[240:243], v[208:211], v[80:95]
buffer_load_dwordx4 v7, s[60:63], s95 offen offset:1024 nt lds
v_mfma_f32_32x32x16_bf16 v[80:95], v[244:247], v[212:215], v[80:95]
buffer_load_dwordx4 v8, s[60:63], s95 offen offset:2048 nt lds
v_mfma_f32_32x32x16_bf16 v[80:95], v[248:251], v[216:219], v[80:95]
buffer_load_dwordx4 v9, s[60:63], s95 offen offset:3072 nt lds
v_mfma_f32_32x32x16_bf16 v[80:95], v[252:255], v[220:223], v[80:95]
v_and_b32 v31, 31, v0
v_mul_u32_u24 v31, 768, v31
v_add_u32 v31, v31, v2
v_add_u32 v240, 114688, v31
v_xor_b32 v241, 32, v240
v_xor_b32 v242, 64, v240
v_xor_b32 v243, 96, v240
v_xor_b32 v244, 128, v240
v_xor_b32 v245, 160, v240
v_xor_b32 v246, 192, v240
v_xor_b32 v247, 224, v240
ds_read_b128 v[232:235], v246 offset:512
ds_read_b128 v[236:239], v247 offset:512
ds_read_b128 v[224:227], v240 offset:768
ds_read_b128 v[228:231], v241 offset:768
s_waitcnt lgkmcnt(3)
v_mfma_f32_32x32x16_bf16 v[160:175], a[176:179], v[232:235], v[160:175]
v_mfma_f32_32x32x16_bf16 v[176:191], a[180:183], v[232:235], v[176:191]
ds_read_b128 v[232:235], v242 offset:768
s_waitcnt lgkmcnt(3)
v_mfma_f32_32x32x16_bf16 v[160:175], a[184:187], v[236:239], v[160:175]
v_mfma_f32_32x32x16_bf16 v[176:191], a[188:191], v[236:239], v[176:191]
ds_read_b128 v[236:239], v243 offset:768
s_waitcnt lgkmcnt(3)
v_mfma_f32_32x32x16_bf16 v[160:175], a[192:195], v[224:227], v[160:175]
v_mfma_f32_32x32x16_bf16 v[176:191], a[196:199], v[224:227], v[176:191]
ds_read_b128 v[224:227], v244 offset:768
s_waitcnt lgkmcnt(3)
v_mfma_f32_32x32x16_bf16 v[160:175], a[200:203], v[228:231], v[160:175]
v_mfma_f32_32x32x16_bf16 v[176:191], a[204:207], v[228:231], v[176:191]
ds_read_b128 v[228:231], v245 offset:768
s_waitcnt lgkmcnt(3)
v_mfma_f32_32x32x16_bf16 v[160:175], a[208:211], v[232:235], v[160:175]
v_mfma_f32_32x32x16_bf16 v[176:191], a[212:215], v[232:235], v[176:191]
ds_read_b128 v[232:235], v246 offset:768
s_waitcnt lgkmcnt(3)
v_mfma_f32_32x32x16_bf16 v[160:175], a[216:219], v[236:239], v[160:175]
v_mfma_f32_32x32x16_bf16 v[176:191], a[220:223], v[236:239], v[176:191]
ds_read_b128 v[236:239], v247 offset:768
s_waitcnt lgkmcnt(3)
v_mfma_f32_32x32x16_bf16 v[160:175], a[224:227], v[224:227], v[160:175]
v_mfma_f32_32x32x16_bf16 v[176:191], a[228:231], v[224:227], v[176:191]
s_waitcnt lgkmcnt(2)
v_mfma_f32_32x32x16_bf16 v[160:175], a[232:235], v[228:231], v[160:175]
v_mfma_f32_32x32x16_bf16 v[176:191], a[236:239], v[228:231], v[176:191]
s_waitcnt lgkmcnt(1)
v_mfma_f32_32x32x16_bf16 v[160:175], a[240:243], v[232:235], v[160:175]
v_mfma_f32_32x32x16_bf16 v[176:191], a[244:247], v[232:235], v[176:191]
s_waitcnt lgkmcnt(0)
v_mfma_f32_32x32x16_bf16 v[160:175], a[248:251], v[236:239], v[160:175]
v_mfma_f32_32x32x16_bf16 v[176:191], a[252:255], v[236:239], v[176:191]
s_nop 10
v_cvt_pk_bf16_f32 v224, v160, v161
v_cvt_pk_bf16_f32 v225, v162, v163
v_cvt_pk_bf16_f32 v226, v164, v165
v_cvt_pk_bf16_f32 v227, v166, v167
v_cvt_pk_bf16_f32 v228, v168, v169
v_cvt_pk_bf16_f32 v229, v170, v171
v_cvt_pk_bf16_f32 v230, v172, v173
v_cvt_pk_bf16_f32 v231, v174, v175
v_cvt_pk_bf16_f32 v232, v176, v177
v_cvt_pk_bf16_f32 v233, v178, v179
v_cvt_pk_bf16_f32 v234, v180, v181
v_cvt_pk_bf16_f32 v235, v182, v183
v_cvt_pk_bf16_f32 v236, v184, v185
v_cvt_pk_bf16_f32 v237, v186, v187
v_cvt_pk_bf16_f32 v238, v188, v189
v_cvt_pk_bf16_f32 v239, v190, v191
s_lshl_b32 s93, s26, 12
s_lshl_b32 s92, s97, 14
s_add_u32 s92, s92, s93
s_add_u32 s92, s92, 16777216
s_add_u32 s93, s93, 147456
v_add_u32 v31, s93, v1
ds_write_b128 v31, v[224:227] offset:0
ds_write_b128 v31, v[228:231] offset:1024
ds_write_b128 v31, v[232:235] offset:2048
ds_write_b128 v31, v[236:239] offset:3072
buffer_store_dwordx4 v[224:227], v1, s[76:79], s92 offen offset:0 sc1
buffer_store_dwordx4 v[228:231], v1, s[76:79], s92 offen offset:1024 sc1
buffer_store_dwordx4 v[232:235], v1, s[76:79], s92 offen offset:2048 sc1
buffer_store_dwordx4 v[236:239], v1, s[76:79], s92 offen offset:3072 sc1
s_waitcnt lgkmcnt(0)
s_waitcnt vmcnt(12)
s_waitcnt vmcnt(0)
v_mov_b32 v224, s100
v_mov_b32 v225, s101
s_lshl_b32 s92, s26, 3
v_mov_b32 v226, s92
s_mov_b64 exec, 1
buffer_store_dwordx2 v[224:225], v226, s[76:79], s99 offen offset:0 sc1
s_mov_b64 exec, -1
s_barrier
ds_read_b128 v[224:227], v19 offset:0
ds_read_b128 v[228:231], v20 offset:0
ds_read_b128 v[232:235], v21 offset:0
ds_read_b128 v[236:239], v22 offset:0
ds_read_b128 v[240:243], v23 offset:0
ds_read_b128 v[244:247], v24 offset:0
ds_read_b128 v[248:251], v25 offset:0
ds_read_b128 v[252:255], v26 offset:0
v_max3_f32 v27, v27, v80, v81
v_max3_f32 v27, v27, v82, v83
v_max3_f32 v27, v27, v84, v85
v_max3_f32 v27, v27, v86, v87
v_max3_f32 v27, v27, v88, v89
v_max3_f32 v27, v27, v90, v91
v_max3_f32 v27, v27, v92, v93
v_max3_f32 v27, v27, v94, v95
s_waitcnt lgkmcnt(0)
s_add_u32 s95, s3, 6
s_and_b32 s95, s95, 7
s_lshl_b32 s95, s95, 14
s_add_u32 s95, s95, s96
s_add_u32 m0, s31, 0
s_nop 0
buffer_load_dwordx4 v6, s[60:63], s95 offen offset:0 nt lds
v_mfma_f32_32x32x16_bf16 v[96:111], v[224:227], v[192:195], 0
buffer_load_dwordx4 v7, s[60:63], s95 offen offset:1024 nt lds
v_mfma_f32_32x32x16_bf16 v[96:111], v[228:231], v[196:199], v[96:111]
buffer_load_dwordx4 v8, s[60:63], s95 offen offset:2048 nt lds
v_mfma_f32_32x32x16_bf16 v[96:111], v[232:235], v[200:203], v[96:111]
buffer_load_dwordx4 v9, s[60:63], s95 offen offset:3072 nt lds
v_mfma_f32_32x32x16_bf16 v[96:111], v[236:239], v[204:207], v[96:111]
s_add_u32 s95, s95, 4096
s_add_u32 m0, s31, 4096
s_nop 0
buffer_load_dwordx4 v6, s[60:63], s95 offen offset:0 nt lds
v_mfma_f32_32x32x16_bf16 v[96:111], v[240:243], v[208:211], v[96:111]
buffer_load_dwordx4 v7, s[60:63], s95 offen offset:1024 nt lds
v_mfma_f32_32x32x16_bf16 v[96:111], v[244:247], v[212:215], v[96:111]
buffer_load_dwordx4 v8, s[60:63], s95 offen offset:2048 nt lds
v_mfma_f32_32x32x16_bf16 v[96:111], v[248:251], v[216:219], v[96:111]
buffer_load_dwordx4 v9, s[60:63], s95 offen offset:3072 nt lds
v_mfma_f32_32x32x16_bf16 v[96:111], v[252:255], v[220:223], v[96:111]
ds_read_b128 v[224:227], v19 offset:8192
ds_read_b128 v[228:231], v20 offset:8192
ds_read_b128 v[232:235], v21 offset:8192
ds_read_b128 v[236:239], v22 offset:8192
ds_read_b128 v[240:243], v23 offset:8192
ds_read_b128 v[244:247], v24 offset:8192
ds_read_b128 v[248:251], v25 offset:8192
ds_read_b128 v[252:255], v26 offset:8192
s_nop 3
v_max3_f32 v27, v27, v96, v97
v_max3_f32 v27, v27, v98, v99
v_max3_f32 v27, v27, v100, v101
v_max3_f32 v27, v27, v102, v103
v_max3_f32 v27, v27, v104, v105
v_max3_f32 v27, v27, v106, v107
v_max3_f32 v27, v27, v108, v109
v_max3_f32 v27, v27, v110, v111
s_waitcnt lgkmcnt(0)
s_add_u32 s95, s3, 7
s_and_b32 s95, s95, 7
s_lshl_b32 s95, s95, 14
s_add_u32 s95, s95, s96
s_add_u32 m0, s31, 8192
s_nop 0
buffer_load_dwordx4 v6, s[60:63], s95 offen offset:0 nt lds
v_mfma_f32_32x32x16_bf16 v[112:127], v[224:227], v[192:195], 0
buffer_load_dwordx4 v7, s[60:63], s95 offen offset:1024 nt lds
v_mfma_f32_32x32x16_bf16 v[112:127], v[228:231], v[196:199], v[112:127]
buffer_load_dwordx4 v8, s[60:63], s95 offen offset:2048 nt lds
v_mfma_f32_32x32x16_bf16 v[112:127], v[232:235], v[200:203], v[112:127]
buffer_load_dwordx4 v9, s[60:63], s95 offen offset:3072 nt lds
v_mfma_f32_32x32x16_bf16 v[112:127], v[236:239], v[204:207], v[112:127]
s_add_u32 s95, s95, 4096
s_add_u32 m0, s31, 12288
s_nop 0
buffer_load_dwordx4 v6, s[60:63], s95 offen offset:0 nt lds
v_mfma_f32_32x32x16_bf16 v[112:127], v[240:243], v[208:211], v[112:127]
buffer_load_dwordx4 v7, s[60:63], s95 offen offset:1024 nt lds
v_mfma_f32_32x32x16_bf16 v[112:127], v[244:247], v[212:215], v[112:127]
buffer_load_dwordx4 v8, s[60:63], s95 offen offset:2048 nt lds
v_mfma_f32_32x32x16_bf16 v[112:127], v[248:251], v[216:219], v[112:127]
buffer_load_dwordx4 v9, s[60:63], s95 offen offset:3072 nt lds
v_mfma_f32_32x32x16_bf16 v[112:127], v[252:255], v[220:223], v[112:127]
s_waitcnt vmcnt(8)
ds_read_b128 v[224:227], v19 offset:0
ds_read_b128 v[228:231], v20 offset:0
ds_read_b128 v[232:235], v21 offset:0
ds_read_b128 v[236:239], v22 offset:0
ds_read_b128 v[240:243], v23 offset:0
ds_read_b128 v[244:247], v24 offset:0
ds_read_b128 v[248:251], v25 offset:0
ds_read_b128 v[252:255], v26 offset:0
s_nop 2
v_max3_f32 v27, v27, v112, v113
v_max3_f32 v27, v27, v114, v115
v_max3_f32 v27, v27, v116, v117
v_max3_f32 v27, v27, v118, v119
v_max3_f32 v27, v27, v120, v121
v_max3_f32 v27, v27, v122, v123
v_max3_f32 v27, v27, v124, v125
v_max3_f32 v27, v27, v126, v127
s_waitcnt lgkmcnt(0)
s_add_u32 s95, s3, 0
s_and_b32 s95, s95, 7
s_lshl_b32 s95, s95, 14
s_add_u32 s95, s95, s96
s_add_u32 m0, s31, 0
s_nop 0
buffer_load_dwordx4 v10, s[64:67], s95 offen offset:0 nt lds
v_mfma_f32_32x32x16_bf16 v[128:143], v[224:227], v[192:195], 0
buffer_load_dwordx4 v10, s[64:67], s95 offen offset:1024 nt lds
v_mfma_f32_32x32x16_bf16 v[128:143], v[228:231], v[196:199], v[128:143]
buffer_load_dwordx4 v10, s[64:67], s95 offen offset:2048 nt lds
v_mfma_f32_32x32x16_bf16 v[128:143], v[232:235], v[200:203], v[128:143]
buffer_load_dwordx4 v10, s[64:67], s95 offen offset:3072 nt lds
v_mfma_f32_32x32x16_bf16 v[128:143], v[236:239], v[204:207], v[128:143]
s_add_u32 s95, s95, 4096
s_add_u32 m0, s31, 4096
s_nop 0
buffer_load_dwordx4 v10, s[64:67], s95 offen offset:0 nt lds
v_mfma_f32_32x32x16_bf16 v[128:143], v[240:243], v[208:211], v[128:143]
buffer_load_dwordx4 v10, s[64:67], s95 offen offset:1024 nt lds
v_mfma_f32_32x32x16_bf16 v[128:143], v[244:247], v[212:215], v[128:143]
buffer_load_dwordx4 v10, s[64:67], s95 offen offset:2048 nt lds
v_mfma_f32_32x32x16_bf16 v[128:143], v[248:251], v[216:219], v[128:143]
buffer_load_dwordx4 v10, s[64:67], s95 offen offset:3072 nt lds
v_mfma_f32_32x32x16_bf16 v[128:143], v[252:255], v[220:223], v[128:143]
s_waitcnt vmcnt(8)
ds_read_b128 v[224:227], v19 offset:8192
ds_read_b128 v[228:231], v20 offset:8192
ds_read_b128 v[232:235], v21 offset:8192
ds_read_b128 v[236:239], v22 offset:8192
ds_read_b128 v[240:243], v23 offset:8192
ds_read_b128 v[244:247], v24 offset:8192
ds_read_b128 v[248:251], v25 offset:8192
ds_read_b128 v[252:255], v26 offset:8192
s_nop 2
v_max3_f32 v27, v27, v128, v129
v_max3_f32 v27, v27, v130, v131
v_max3_f32 v27, v27, v132, v133
v_max3_f32 v27, v27, v134, v135
v_max3_f32 v27, v27, v136, v137
v_max3_f32 v27, v27, v138, v139
v_max3_f32 v27, v27, v140, v141
v_max3_f32 v27, v27, v142, v143
s_waitcnt lgkmcnt(0)
s_add_u32 s95, s3, 1
s_and_b32 s95, s95, 7
s_lshl_b32 s95, s95, 14
s_add_u32 s95, s95, s96
s_add_u32 m0, s31, 8192
s_nop 0
buffer_load_dwordx4 v10, s[64:67], s95 offen offset:0 nt lds
v_mfma_f32_32x32x16_bf16 v[144:159], v[224:227], v[192:195], 0
buffer_load_dwordx4 v10, s[64:67], s95 offen offset:1024 nt lds
v_mfma_f32_32x32x16_bf16 v[144:159], v[228:231], v[196:199], v[144:159]
buffer_load_dwordx4 v10, s[64:67], s95 offen offset:2048 nt lds
v_mfma_f32_32x32x16_bf16 v[144:159], v[232:235], v[200:203], v[144:159]
buffer_load_dwordx4 v10, s[64:67], s95 offen offset:3072 nt lds
v_mfma_f32_32x32x16_bf16 v[144:159], v[236:239], v[204:207], v[144:159]
s_add_u32 s95, s95, 4096
s_add_u32 m0, s31, 12288
s_nop 0
buffer_load_dwordx4 v10, s[64:67], s95 offen offset:0 nt lds
v_mfma_f32_32x32x16_bf16 v[144:159], v[240:243], v[208:211], v[144:159]
buffer_load_dwordx4 v10, s[64:67], s95 offen offset:1024 nt lds
v_mfma_f32_32x32x16_bf16 v[144:159], v[244:247], v[212:215], v[144:159]
buffer_load_dwordx4 v10, s[64:67], s95 offen offset:2048 nt lds
v_mfma_f32_32x32x16_bf16 v[144:159], v[248:251], v[216:219], v[144:159]
buffer_load_dwordx4 v10, s[64:67], s95 offen offset:3072 nt lds
v_mfma_f32_32x32x16_bf16 v[144:159], v[252:255], v[220:223], v[144:159]
s_lshl_b32 s93, s29, 7
v_xor_b32 v31, s93, v3
v_add_u32 v19, s31, v31
v_xor_b32 v20, 64, v19
v_xor_b32 v21, 128, v19
v_xor_b32 v22, 192, v19
s_nop 5
v_max3_f32 v27, v27, v144, v145
v_max3_f32 v27, v27, v146, v147
v_max3_f32 v27, v27, v148, v149
v_max3_f32 v27, v27, v150, v151
v_max3_f32 v27, v27, v152, v153
v_max3_f32 v27, v27, v154, v155
v_max3_f32 v27, v27, v156, v157
v_max3_f32 v27, v27, v158, v159
v_mov_b32 v31, v27
s_nop 1
v_permlane32_swap_b32 v27, v31
v_max_f32 v27, v27, v31
v_mul_f32 v28, s91, v27
v_sub_f32 v28, 0, v28
v_mov_b32 v29, 0
v_mov_b32 v30, 0
v_fma_f32 v32, v32, s91, v28
v_fma_f32 v33, v33, s91, v28
v_fma_f32 v34, v34, s91, v28
v_fma_f32 v35, v35, s91, v28
v_fma_f32 v36, v36, s91, v28
v_fma_f32 v37, v37, s91, v28
v_fma_f32 v38, v38, s91, v28
v_fma_f32 v39, v39, s91, v28
v_fma_f32 v40, v40, s91, v28
v_fma_f32 v41, v41, s91, v28
v_fma_f32 v42, v42, s91, v28
v_fma_f32 v43, v43, s91, v28
v_fma_f32 v44, v44, s91, v28
v_fma_f32 v45, v45, s91, v28
v_fma_f32 v46, v46, s91, v28
v_fma_f32 v47, v47, s91, v28
v_exp_f32 v32, v32
v_exp_f32 v33, v33
v_exp_f32 v34, v34
v_exp_f32 v35, v35
v_exp_f32 v36, v36
v_exp_f32 v37, v37
v_exp_f32 v38, v38
v_exp_f32 v39, v39
v_exp_f32 v40, v40
v_exp_f32 v41, v41
v_exp_f32 v42, v42
v_exp_f32 v43, v43
v_exp_f32 v44, v44
v_exp_f32 v45, v45
v_exp_f32 v46, v46
v_exp_f32 v47, v47
v_add_f32 v29, v29, v32
v_add_f32 v30, v30, v33
v_add_f32 v29, v29, v34
v_add_f32 v30, v30, v35
v_add_f32 v29, v29, v36
v_add_f32 v30, v30, v37
v_add_f32 v29, v29, v38
v_add_f32 v30, v30, v39
v_add_f32 v29, v29, v40
v_add_f32 v30, v30, v41
v_add_f32 v29, v29, v42
v_add_f32 v30, v30, v43
v_add_f32 v29, v29, v44
v_add_f32 v30, v30, v45
v_add_f32 v29, v29, v46
v_add_f32 v30, v30, v47
v_cvt_pk_bf16_f32 v32, v32, v33
v_cvt_pk_bf16_f32 v33, v34, v35
v_cvt_pk_bf16_f32 v34, v36, v37
v_cvt_pk_bf16_f32 v35, v38, v39
v_cvt_pk_bf16_f32 v36, v40, v41
v_cvt_pk_bf16_f32 v37, v42, v43
v_cvt_pk_bf16_f32 v38, v44, v45
v_cvt_pk_bf16_f32 v39, v46, v47
s_add_u32 s95, s82, 0
s_add_u32 m0, s85, 4096
s_nop 0
buffer_load_dwordx4 v11, s[72:75], s95 offen offset:0 lds
buffer_load_dwordx4 v12, s[72:75], s95 offen offset:1024 lds
buffer_load_dwordx4 v13, s[72:75], s95 offen offset:2048 lds
buffer_load_dwordx4 v14, s[72:75], s95 offen offset:3072 lds
s_add_u32 s95, s82, 16384
s_add_u32 m0, s85, 8192
s_nop 0
buffer_load_dwordx4 v11, s[72:75], s95 offen offset:0 lds
buffer_load_dwordx4 v12, s[72:75], s95 offen offset:1024 lds
buffer_load_dwordx4 v13, s[72:75], s95 offen offset:2048 lds
buffer_load_dwordx4 v14, s[72:75], s95 offen offset:3072 lds
s_add_u32 s95, s82, 32768
s_add_u32 m0, s85, 0
s_nop 0
buffer_load_dwordx4 v11, s[72:75], s95 offen offset:0 lds
buffer_load_dwordx4 v12, s[72:75], s95 offen offset:1024 lds
buffer_load_dwordx4 v13, s[72:75], s95 offen offset:2048 lds
buffer_load_dwordx4 v14, s[72:75], s95 offen offset:3072 lds
s_waitcnt vmcnt(20)
ds_read_b64_tr_b16 v[224:225], v19 offset:0
ds_read_b64_tr_b16 v[226:227], v19 offset:2048
ds_read_b64_tr_b16 v[228:229], v19 offset:4096
ds_read_b64_tr_b16 v[230:231], v19 offset:6144
ds_read_b64_tr_b16 v[232:233], v20 offset:0
ds_read_b64_tr_b16 v[234:235], v20 offset:2048
ds_read_b64_tr_b16 v[236:237], v20 offset:4096
ds_read_b64_tr_b16 v[238:239], v20 offset:6144
ds_read_b64_tr_b16 v[240:241], v21 offset:0
ds_read_b64_tr_b16 v[242:243], v21 offset:2048
ds_read_b64_tr_b16 v[244:245], v21 offset:4096
ds_read_b64_tr_b16 v[246:247], v21 offset:6144
ds_read_b64_tr_b16 v[248:249], v22 offset:0
ds_read_b64_tr_b16 v[250:251], v22 offset:2048
ds_read_b64_tr_b16 v[252:253], v22 offset:4096
ds_read_b64_tr_b16 v[254:255], v22 offset:6144
v_fma_f32 v48, v48, s91, v28
v_fma_f32 v49, v49, s91, v28
v_fma_f32 v50, v50, s91, v28
v_fma_f32 v51, v51, s91, v28
v_fma_f32 v52, v52, s91, v28
v_fma_f32 v53, v53, s91, v28
v_fma_f32 v54, v54, s91, v28
v_fma_f32 v55, v55, s91, v28
v_fma_f32 v56, v56, s91, v28
v_fma_f32 v57, v57, s91, v28
v_fma_f32 v58, v58, s91, v28
v_fma_f32 v59, v59, s91, v28
v_fma_f32 v60, v60, s91, v28
v_fma_f32 v61, v61, s91, v28
v_fma_f32 v62, v62, s91, v28
v_fma_f32 v63, v63, s91, v28
s_waitcnt lgkmcnt(0)
s_add_u32 s95, s3, 2
s_and_b32 s95, s95, 7
s_lshl_b32 s95, s95, 14
s_add_u32 s95, s95, s96
s_add_u32 m0, s31, 0
s_nop 0
buffer_load_dwordx4 v10, s[64:67], s95 offen offset:0 nt lds
v_mfma_f32_32x32x16_bf16 v[160:175], v[224:227], v[32:35], 0
v_exp_f32 v48, v48
v_exp_f32 v49, v49
v_exp_f32 v50, v50
v_exp_f32 v51, v51
v_exp_f32 v52, v52
buffer_load_dwordx4 v10, s[64:67], s95 offen offset:1024 nt lds
v_mfma_f32_32x32x16_bf16 v[176:191], v[232:235], v[32:35], 0
v_exp_f32 v53, v53
v_exp_f32 v54, v54
v_exp_f32 v55, v55
v_exp_f32 v56, v56
v_exp_f32 v57, v57
buffer_load_dwordx4 v10, s[64:67], s95 offen offset:2048 nt lds
v_mfma_f32_32x32x16_bf16 v[192:207], v[240:243], v[32:35], 0
v_exp_f32 v58, v58
v_exp_f32 v59, v59
v_exp_f32 v60, v60
v_exp_f32 v61, v61
v_exp_f32 v62, v62
buffer_load_dwordx4 v10, s[64:67], s95 offen offset:3072 nt lds
v_mfma_f32_32x32x16_bf16 v[208:223], v[248:251], v[32:35], 0
v_exp_f32 v63, v63
v_add_f32 v29, v29, v48
v_add_f32 v30, v30, v49
v_add_f32 v29, v29, v50
v_add_f32 v30, v30, v51
s_add_u32 s95, s95, 4096
s_add_u32 m0, s31, 4096
s_nop 0
buffer_load_dwordx4 v10, s[64:67], s95 offen offset:0 nt lds
v_mfma_f32_32x32x16_bf16 v[160:175], v[228:231], v[36:39], v[160:175]
v_add_f32 v29, v29, v52
v_add_f32 v30, v30, v53
v_add_f32 v29, v29, v54
v_add_f32 v30, v30, v55
v_add_f32 v29, v29, v56
buffer_load_dwordx4 v10, s[64:67], s95 offen offset:1024 nt lds
v_mfma_f32_32x32x16_bf16 v[176:191], v[236:239], v[36:39], v[176:191]
v_add_f32 v30, v30, v57
v_add_f32 v29, v29, v58
v_add_f32 v30, v30, v59
v_add_f32 v29, v29, v60
v_add_f32 v30, v30, v61
buffer_load_dwordx4 v10, s[64:67], s95 offen offset:2048 nt lds
v_mfma_f32_32x32x16_bf16 v[192:207], v[244:247], v[36:39], v[192:207]
v_add_f32 v29, v29, v62
v_add_f32 v30, v30, v63
v_cvt_pk_bf16_f32 v48, v48, v49
v_cvt_pk_bf16_f32 v49, v50, v51
v_cvt_pk_bf16_f32 v50, v52, v53
buffer_load_dwordx4 v10, s[64:67], s95 offen offset:3072 nt lds
v_mfma_f32_32x32x16_bf16 v[208:223], v[252:255], v[36:39], v[208:223]
v_cvt_pk_bf16_f32 v51, v54, v55
v_cvt_pk_bf16_f32 v52, v56, v57
v_cvt_pk_bf16_f32 v53, v58, v59
v_cvt_pk_bf16_f32 v54, v60, v61
v_cvt_pk_bf16_f32 v55, v62, v63
s_waitcnt vmcnt(20)
ds_read_b64_tr_b16 v[224:225], v19 offset:8192
ds_read_b64_tr_b16 v[226:227], v19 offset:10240
ds_read_b64_tr_b16 v[228:229], v19 offset:12288
ds_read_b64_tr_b16 v[230:231], v19 offset:14336
ds_read_b64_tr_b16 v[232:233], v20 offset:8192
ds_read_b64_tr_b16 v[234:235], v20 offset:10240
ds_read_b64_tr_b16 v[236:237], v20 offset:12288
ds_read_b64_tr_b16 v[238:239], v20 offset:14336
ds_read_b64_tr_b16 v[240:241], v21 offset:8192
ds_read_b64_tr_b16 v[242:243], v21 offset:10240
ds_read_b64_tr_b16 v[244:245], v21 offset:12288
ds_read_b64_tr_b16 v[246:247], v21 offset:14336
ds_read_b64_tr_b16 v[248:249], v22 offset:8192
ds_read_b64_tr_b16 v[250:251], v22 offset:10240
ds_read_b64_tr_b16 v[252:253], v22 offset:12288
ds_read_b64_tr_b16 v[254:255], v22 offset:14336
v_fma_f32 v64, v64, s91, v28
v_fma_f32 v65, v65, s91, v28
v_fma_f32 v66, v66, s91, v28
v_fma_f32 v67, v67, s91, v28
v_fma_f32 v68, v68, s91, v28
v_fma_f32 v69, v69, s91, v28
v_fma_f32 v70, v70, s91, v28
v_fma_f32 v71, v71, s91, v28
v_fma_f32 v72, v72, s91, v28
v_fma_f32 v73, v73, s91, v28
v_fma_f32 v74, v74, s91, v28
v_fma_f32 v75, v75, s91, v28
v_fma_f32 v76, v76, s91, v28
v_fma_f32 v77, v77, s91, v28
v_fma_f32 v78, v78, s91, v28
v_fma_f32 v79, v79, s91, v28
s_waitcnt lgkmcnt(0)
v_mfma_f32_32x32x16_bf16 v[160:175], v[224:227], v[48:51], v[160:175]
v_exp_f32 v64, v64
v_exp_f32 v65, v65
v_exp_f32 v66, v66
v_exp_f32 v67, v67
v_exp_f32 v68, v68
v_mfma_f32_32x32x16_bf16 v[176:191], v[232:235], v[48:51], v[176:191]
v_exp_f32 v69, v69
v_exp_f32 v70, v70
v_exp_f32 v71, v71
v_exp_f32 v72, v72
v_exp_f32 v73, v73
v_mfma_f32_32x32x16_bf16 v[192:207], v[240:243], v[48:51], v[192:207]
v_exp_f32 v74, v74
v_exp_f32 v75, v75
v_exp_f32 v76, v76
v_exp_f32 v77, v77
v_exp_f32 v78, v78
v_mfma_f32_32x32x16_bf16 v[208:223], v[248:251], v[48:51], v[208:223]
v_exp_f32 v79, v79
v_add_f32 v29, v29, v64
v_add_f32 v30, v30, v65
v_add_f32 v29, v29, v66
v_add_f32 v30, v30, v67
v_mfma_f32_32x32x16_bf16 v[160:175], v[228:231], v[52:55], v[160:175]
v_add_f32 v29, v29, v68
v_add_f32 v30, v30, v69
v_add_f32 v29, v29, v70
v_add_f32 v30, v30, v71
v_add_f32 v29, v29, v72
v_mfma_f32_32x32x16_bf16 v[176:191], v[236:239], v[52:55], v[176:191]
v_add_f32 v30, v30, v73
v_add_f32 v29, v29, v74
v_add_f32 v30, v30, v75
v_add_f32 v29, v29, v76
v_add_f32 v30, v30, v77
v_mfma_f32_32x32x16_bf16 v[192:207], v[244:247], v[52:55], v[192:207]
v_add_f32 v29, v29, v78
v_add_f32 v30, v30, v79
v_cvt_pk_bf16_f32 v64, v64, v65
v_cvt_pk_bf16_f32 v65, v66, v67
v_cvt_pk_bf16_f32 v66, v68, v69
v_mfma_f32_32x32x16_bf16 v[208:223], v[252:255], v[52:55], v[208:223]
v_cvt_pk_bf16_f32 v67, v70, v71
v_cvt_pk_bf16_f32 v68, v72, v73
v_cvt_pk_bf16_f32 v69, v74, v75
v_cvt_pk_bf16_f32 v70, v76, v77
v_cvt_pk_bf16_f32 v71, v78, v79
v_xor_b32 v224, 0, v4
v_add_u32 v224, s85, v224
v_xor_b32 v225, 64, v4
v_add_u32 v225, s85, v225
v_xor_b32 v226, 128, v4
v_add_u32 v226, s85, v226
v_xor_b32 v227, 192, v4
v_add_u32 v227, s85, v227
s_waitcnt vmcnt(16)
ds_read_b64_tr_b16 a[0:1], v224 offset:4096
ds_read_b64_tr_b16 a[2:3], v224 offset:6144
ds_read_b64_tr_b16 a[4:5], v225 offset:4096
ds_read_b64_tr_b16 a[6:7], v225 offset:6144
ds_read_b64_tr_b16 a[8:9], v226 offset:4096
ds_read_b64_tr_b16 a[10:11], v226 offset:6144
ds_read_b64_tr_b16 a[12:13], v227 offset:4096
ds_read_b64_tr_b16 a[14:15], v227 offset:6144
s_waitcnt lgkmcnt(0)
s_add_u32 s95, s82, 49152
s_add_u32 m0, s85, 4096
s_nop 0
buffer_load_dwordx4 v11, s[72:75], s95 offen offset:0 lds
buffer_load_dwordx4 v12, s[72:75], s95 offen offset:1024 lds
buffer_load_dwordx4 v13, s[72:75], s95 offen offset:2048 lds
buffer_load_dwordx4 v14, s[72:75], s95 offen offset:3072 lds
s_waitcnt vmcnt(16)
ds_read_b64_tr_b16 a[16:17], v224 offset:8192
ds_read_b64_tr_b16 a[18:19], v224 offset:10240
ds_read_b64_tr_b16 a[20:21], v225 offset:8192
ds_read_b64_tr_b16 a[22:23], v225 offset:10240
ds_read_b64_tr_b16 a[24:25], v226 offset:8192
ds_read_b64_tr_b16 a[26:27], v226 offset:10240
ds_read_b64_tr_b16 a[28:29], v227 offset:8192
ds_read_b64_tr_b16 a[30:31], v227 offset:10240
s_waitcnt lgkmcnt(0)
s_add_u32 s95, s82, 65536
s_add_u32 m0, s85, 8192
s_nop 0
buffer_load_dwordx4 v11, s[72:75], s95 offen offset:0 lds
buffer_load_dwordx4 v12, s[72:75], s95 offen offset:1024 lds
buffer_load_dwordx4 v13, s[72:75], s95 offen offset:2048 lds
buffer_load_dwordx4 v14, s[72:75], s95 offen offset:3072 lds
s_waitcnt vmcnt(16)
ds_read_b64_tr_b16 a[32:33], v224 offset:0
ds_read_b64_tr_b16 a[34:35], v224 offset:2048
ds_read_b64_tr_b16 a[36:37], v225 offset:0
ds_read_b64_tr_b16 a[38:39], v225 offset:2048
ds_read_b64_tr_b16 a[40:41], v226 offset:0
ds_read_b64_tr_b16 a[42:43], v226 offset:2048
ds_read_b64_tr_b16 a[44:45], v227 offset:0
ds_read_b64_tr_b16 a[46:47], v227 offset:2048
s_waitcnt lgkmcnt(0)
s_add_u32 s95, s82, 81920
s_add_u32 m0, s85, 0
s_nop 0
buffer_load_dwordx4 v11, s[72:75], s95 offen offset:0 lds
buffer_load_dwordx4 v12, s[72:75], s95 offen offset:1024 lds
buffer_load_dwordx4 v13, s[72:75], s95 offen offset:2048 lds
buffer_load_dwordx4 v14, s[72:75], s95 offen offset:3072 lds
s_waitcnt vmcnt(8)
ds_read_b64_tr_b16 a[48:49], v224 offset:4096
ds_read_b64_tr_b16 a[50:51], v224 offset:6144
ds_read_b64_tr_b16 a[52:53], v225 offset:4096
ds_read_b64_tr_b16 a[54:55], v225 offset:6144
ds_read_b64_tr_b16 a[56:57], v226 offset:4096
ds_read_b64_tr_b16 a[58:59], v226 offset:6144
ds_read_b64_tr_b16 a[60:61], v227 offset:4096
ds_read_b64_tr_b16 a[62:63], v227 offset:6144
s_waitcnt lgkmcnt(0)
s_add_u32 s95, s82, 98304
s_add_u32 m0, s85, 4096
s_nop 0
buffer_load_dwordx4 v11, s[72:75], s95 offen offset:0 lds
buffer_load_dwordx4 v12, s[72:75], s95 offen offset:1024 lds
buffer_load_dwordx4 v13, s[72:75], s95 offen offset:2048 lds
buffer_load_dwordx4 v14, s[72:75], s95 offen offset:3072 lds
s_waitcnt vmcnt(8)
ds_read_b64_tr_b16 a[64:65], v224 offset:8192
ds_read_b64_tr_b16 a[66:67], v224 offset:10240
ds_read_b64_tr_b16 a[68:69], v225 offset:8192
ds_read_b64_tr_b16 a[70:71], v225 offset:10240
ds_read_b64_tr_b16 a[72:73], v226 offset:8192
ds_read_b64_tr_b16 a[74:75], v226 offset:10240
ds_read_b64_tr_b16 a[76:77], v227 offset:8192
ds_read_b64_tr_b16 a[78:79], v227 offset:10240
s_waitcnt lgkmcnt(0)
s_add_u32 s95, s82, 114688
s_add_u32 m0, s85, 8192
s_nop 0
buffer_load_dwordx4 v11, s[72:75], s95 offen offset:0 lds
buffer_load_dwordx4 v12, s[72:75], s95 offen offset:1024 lds
buffer_load_dwordx4 v13, s[72:75], s95 offen offset:2048 lds
buffer_load_dwordx4 v14, s[72:75], s95 offen offset:3072 lds
s_waitcnt vmcnt(8)
ds_read_b64_tr_b16 a[80:81], v224 offset:0
ds_read_b64_tr_b16 a[82:83], v224 offset:2048
ds_read_b64_tr_b16 a[84:85], v225 offset:0
ds_read_b64_tr_b16 a[86:87], v225 offset:2048
ds_read_b64_tr_b16 a[88:89], v226 offset:0
ds_read_b64_tr_b16 a[90:91], v226 offset:2048
ds_read_b64_tr_b16 a[92:93], v227 offset:0
ds_read_b64_tr_b16 a[94:95], v227 offset:2048
s_waitcnt lgkmcnt(0)
s_add_u32 s95, s82, 131072
s_add_u32 m0, s85, 0
s_nop 0
buffer_load_dwordx4 v11, s[72:75], s95 offen offset:0 lds
buffer_load_dwordx4 v12, s[72:75], s95 offen offset:1024 lds
buffer_load_dwordx4 v13, s[72:75], s95 offen offset:2048 lds
buffer_load_dwordx4 v14, s[72:75], s95 offen offset:3072 lds
s_waitcnt vmcnt(8)
ds_read_b64_tr_b16 a[96:97], v224 offset:4096
ds_read_b64_tr_b16 a[98:99], v224 offset:6144
ds_read_b64_tr_b16 a[100:101], v225 offset:4096
ds_read_b64_tr_b16 a[102:103], v225 offset:6144
ds_read_b64_tr_b16 a[104:105], v226 offset:4096
ds_read_b64_tr_b16 a[106:107], v226 offset:6144
ds_read_b64_tr_b16 a[108:109], v227 offset:4096
ds_read_b64_tr_b16 a[110:111], v227 offset:6144
s_waitcnt lgkmcnt(0)
s_add_u32 s95, s82, 147456
s_add_u32 m0, s85, 4096
s_nop 0
buffer_load_dwordx4 v11, s[72:75], s95 offen offset:0 lds
buffer_load_dwordx4 v12, s[72:75], s95 offen offset:1024 lds
buffer_load_dwordx4 v13, s[72:75], s95 offen offset:2048 lds
buffer_load_dwordx4 v14, s[72:75], s95 offen offset:3072 lds
s_waitcnt vmcnt(8)
ds_read_b64_tr_b16 a[112:113], v224 offset:8192
ds_read_b64_tr_b16 a[114:115], v224 offset:10240
ds_read_b64_tr_b16 a[116:117], v225 offset:8192
ds_read_b64_tr_b16 a[118:119], v225 offset:10240
ds_read_b64_tr_b16 a[120:121], v226 offset:8192
ds_read_b64_tr_b16 a[122:123], v226 offset:10240
ds_read_b64_tr_b16 a[124:125], v227 offset:8192
ds_read_b64_tr_b16 a[126:127], v227 offset:10240
s_waitcnt lgkmcnt(0)
s_add_u32 s95, s82, 163840
s_add_u32 m0, s85, 8192
s_nop 0
buffer_load_dwordx4 v11, s[72:75], s95 offen offset:0 lds
buffer_load_dwordx4 v12, s[72:75], s95 offen offset:1024 lds
buffer_load_dwordx4 v13, s[72:75], s95 offen offset:2048 lds
buffer_load_dwordx4 v14, s[72:75], s95 offen offset:3072 lds
s_waitcnt vmcnt(8)
ds_read_b64_tr_b16 a[128:129], v224 offset:0
ds_read_b64_tr_b16 a[130:131], v224 offset:2048
ds_read_b64_tr_b16 a[132:133], v225 offset:0
ds_read_b64_tr_b16 a[134:135], v225 offset:2048
ds_read_b64_tr_b16 a[136:137], v226 offset:0
ds_read_b64_tr_b16 a[138:139], v226 offset:2048
ds_read_b64_tr_b16 a[140:141], v227 offset:0
ds_read_b64_tr_b16 a[142:143], v227 offset:2048
s_waitcnt lgkmcnt(0)
s_add_u32 s95, s82, 180224
s_add_u32 m0, s85, 0
s_nop 0
buffer_load_dwordx4 v11, s[72:75], s95 offen offset:0 lds
buffer_load_dwordx4 v12, s[72:75], s95 offen offset:1024 lds
buffer_load_dwordx4 v13, s[72:75], s95 offen offset:2048 lds
buffer_load_dwordx4 v14, s[72:75], s95 offen offset:3072 lds
s_waitcnt vmcnt(8)
ds_read_b64_tr_b16 a[144:145], v224 offset:4096
ds_read_b64_tr_b16 a[146:147], v224 offset:6144
ds_read_b64_tr_b16 a[148:149], v225 offset:4096
ds_read_b64_tr_b16 a[150:151], v225 offset:6144
ds_read_b64_tr_b16 a[152:153], v226 offset:4096
ds_read_b64_tr_b16 a[154:155], v226 offset:6144
ds_read_b64_tr_b16 a[156:157], v227 offset:4096
ds_read_b64_tr_b16 a[158:159], v227 offset:6144
s_waitcnt lgkmcnt(0)
s_add_u32 s95, s82, 196608
s_add_u32 m0, s85, 4096
s_nop 0
buffer_load_dwordx4 v11, s[72:75], s95 offen offset:0 lds
buffer_load_dwordx4 v12, s[72:75], s95 offen offset:1024 lds
buffer_load_dwordx4 v13, s[72:75], s95 offen offset:2048 lds
buffer_load_dwordx4 v14, s[72:75], s95 offen offset:3072 lds
s_waitcnt vmcnt(8)
ds_read_b64_tr_b16 a[160:161], v224 offset:8192
ds_read_b64_tr_b16 a[162:163], v224 offset:10240
ds_read_b64_tr_b16 a[164:165], v225 offset:8192
ds_read_b64_tr_b16 a[166:167], v225 offset:10240
ds_read_b64_tr_b16 a[168:169], v226 offset:8192
ds_read_b64_tr_b16 a[170:171], v226 offset:10240
ds_read_b64_tr_b16 a[172:173], v227 offset:8192
ds_read_b64_tr_b16 a[174:175], v227 offset:10240
s_waitcnt lgkmcnt(0)
s_add_u32 s95, s82, 212992
s_add_u32 m0, s85, 8192
s_nop 0
buffer_load_dwordx4 v11, s[72:75], s95 offen offset:0 lds
buffer_load_dwordx4 v12, s[72:75], s95 offen offset:1024 lds
buffer_load_dwordx4 v13, s[72:75], s95 offen offset:2048 lds
buffer_load_dwordx4 v14, s[72:75], s95 offen offset:3072 lds
s_waitcnt vmcnt(8)
ds_read_b64_tr_b16 a[176:177], v224 offset:0
ds_read_b64_tr_b16 a[178:179], v224 offset:2048
ds_read_b64_tr_b16 a[180:181], v225 offset:0
ds_read_b64_tr_b16 a[182:183], v225 offset:2048
ds_read_b64_tr_b16 a[184:185], v226 offset:0
ds_read_b64_tr_b16 a[186:187], v226 offset:2048
ds_read_b64_tr_b16 a[188:189], v227 offset:0
ds_read_b64_tr_b16 a[190:191], v227 offset:2048
s_waitcnt lgkmcnt(0)
s_add_u32 s95, s82, 229376
s_add_u32 m0, s85, 0
s_nop 0
buffer_load_dwordx4 v11, s[72:75], s95 offen offset:0 lds
buffer_load_dwordx4 v12, s[72:75], s95 offen offset:1024 lds
buffer_load_dwordx4 v13, s[72:75], s95 offen offset:2048 lds
buffer_load_dwordx4 v14, s[72:75], s95 offen offset:3072 lds
s_waitcnt vmcnt(8)
ds_read_b64_tr_b16 a[192:193], v224 offset:4096
ds_read_b64_tr_b16 a[194:195], v224 offset:6144
ds_read_b64_tr_b16 a[196:197], v225 offset:4096
ds_read_b64_tr_b16 a[198:199], v225 offset:6144
ds_read_b64_tr_b16 a[200:201], v226 offset:4096
ds_read_b64_tr_b16 a[202:203], v226 offset:6144
ds_read_b64_tr_b16 a[204:205], v227 offset:4096
ds_read_b64_tr_b16 a[206:207], v227 offset:6144
s_waitcnt lgkmcnt(0)
s_add_u32 s95, s82, 245760
s_add_u32 m0, s85, 4096
s_nop 0
buffer_load_dwordx4 v11, s[72:75], s95 offen offset:0 lds
buffer_load_dwordx4 v12, s[72:75], s95 offen offset:1024 lds
buffer_load_dwordx4 v13, s[72:75], s95 offen offset:2048 lds
buffer_load_dwordx4 v14, s[72:75], s95 offen offset:3072 lds
s_waitcnt vmcnt(8)
ds_read_b64_tr_b16 a[208:209], v224 offset:8192
ds_read_b64_tr_b16 a[210:211], v224 offset:10240
ds_read_b64_tr_b16 a[212:213], v225 offset:8192
ds_read_b64_tr_b16 a[214:215], v225 offset:10240
ds_read_b64_tr_b16 a[216:217], v226 offset:8192
ds_read_b64_tr_b16 a[218:219], v226 offset:10240
ds_read_b64_tr_b16 a[220:221], v227 offset:8192
ds_read_b64_tr_b16 a[222:223], v227 offset:10240
s_waitcnt lgkmcnt(0)
s_add_u32 s95, s3, 3
s_and_b32 s95, s95, 7
s_lshl_b32 s95, s95, 14
s_add_u32 s95, s95, s96
s_add_u32 m0, s31, 8192
s_nop 0
buffer_load_dwordx4 v10, s[64:67], s95 offen offset:0 nt lds
buffer_load_dwordx4 v10, s[64:67], s95 offen offset:1024 nt lds
buffer_load_dwordx4 v10, s[64:67], s95 offen offset:2048 nt lds
buffer_load_dwordx4 v10, s[64:67], s95 offen offset:3072 nt lds
s_add_u32 s95, s95, 4096
s_add_u32 m0, s31, 12288
s_nop 0
buffer_load_dwordx4 v10, s[64:67], s95 offen offset:0 nt lds
buffer_load_dwordx4 v10, s[64:67], s95 offen offset:1024 nt lds
buffer_load_dwordx4 v10, s[64:67], s95 offen offset:2048 nt lds
buffer_load_dwordx4 v10, s[64:67], s95 offen offset:3072 nt lds
s_waitcnt vmcnt(12)
ds_read_b64_tr_b16 a[224:225], v224 offset:0
ds_read_b64_tr_b16 a[226:227], v224 offset:2048
ds_read_b64_tr_b16 a[228:229], v225 offset:0
ds_read_b64_tr_b16 a[230:231], v225 offset:2048
ds_read_b64_tr_b16 a[232:233], v226 offset:0
ds_read_b64_tr_b16 a[234:235], v226 offset:2048
ds_read_b64_tr_b16 a[236:237], v227 offset:0
ds_read_b64_tr_b16 a[238:239], v227 offset:2048
s_waitcnt lgkmcnt(0)
s_waitcnt vmcnt(8)
ds_read_b64_tr_b16 a[240:241], v224 offset:4096
ds_read_b64_tr_b16 a[242:243], v224 offset:6144
ds_read_b64_tr_b16 a[244:245], v225 offset:4096
ds_read_b64_tr_b16 a[246:247], v225 offset:6144
ds_read_b64_tr_b16 a[248:249], v226 offset:4096
ds_read_b64_tr_b16 a[250:251], v226 offset:6144
ds_read_b64_tr_b16 a[252:253], v227 offset:4096
ds_read_b64_tr_b16 a[254:255], v227 offset:6144
s_waitcnt lgkmcnt(0)
ds_read_b64_tr_b16 v[224:225], v19 offset:0
ds_read_b64_tr_b16 v[226:227], v19 offset:2048
ds_read_b64_tr_b16 v[228:229], v19 offset:4096
ds_read_b64_tr_b16 v[230:231], v19 offset:6144
ds_read_b64_tr_b16 v[232:233], v20 offset:0
ds_read_b64_tr_b16 v[234:235], v20 offset:2048
ds_read_b64_tr_b16 v[236:237], v20 offset:4096
ds_read_b64_tr_b16 v[238:239], v20 offset:6144
ds_read_b64_tr_b16 v[240:241], v21 offset:0
ds_read_b64_tr_b16 v[242:243], v21 offset:2048
ds_read_b64_tr_b16 v[244:245], v21 offset:4096
ds_read_b64_tr_b16 v[246:247], v21 offset:6144
ds_read_b64_tr_b16 v[248:249], v22 offset:0
ds_read_b64_tr_b16 v[250:251], v22 offset:2048
ds_read_b64_tr_b16 v[252:253], v22 offset:4096
ds_read_b64_tr_b16 v[254:255], v22 offset:6144
v_fma_f32 v80, v80, s91, v28
v_fma_f32 v81, v81, s91, v28
v_fma_f32 v82, v82, s91, v28
v_fma_f32 v83, v83, s91, v28
v_fma_f32 v84, v84, s91, v28
v_fma_f32 v85, v85, s91, v28
v_fma_f32 v86, v86, s91, v28
v_fma_f32 v87, v87, s91, v28
v_fma_f32 v88, v88, s91, v28
v_fma_f32 v89, v89, s91, v28
v_fma_f32 v90, v90, s91, v28
v_fma_f32 v91, v91, s91, v28
v_fma_f32 v92, v92, s91, v28
v_fma_f32 v93, v93, s91, v28
v_fma_f32 v94, v94, s91, v28
v_fma_f32 v95, v95, s91, v28
s_waitcnt lgkmcnt(0)
s_add_u32 s95, s3, 4
s_and_b32 s95, s95, 7
s_lshl_b32 s95, s95, 14
s_add_u32 s95, s95, s96
s_add_u32 m0, s31, 0
s_nop 0
buffer_load_dwordx4 v10, s[64:67], s95 offen offset:0 nt lds
v_mfma_f32_32x32x16_bf16 v[160:175], v[224:227], v[64:67], v[160:175]
v_exp_f32 v80, v80
v_exp_f32 v81, v81
v_exp_f32 v82, v82
v_exp_f32 v83, v83
v_exp_f32 v84, v84
buffer_load_dwordx4 v10, s[64:67], s95 offen offset:1024 nt lds
v_mfma_f32_32x32x16_bf16 v[176:191], v[232:235], v[64:67], v[176:191]
v_exp_f32 v85, v85
v_exp_f32 v86, v86
v_exp_f32 v87, v87
v_exp_f32 v88, v88
v_exp_f32 v89, v89
buffer_load_dwordx4 v10, s[64:67], s95 offen offset:2048 nt lds
v_mfma_f32_32x32x16_bf16 v[192:207], v[240:243], v[64:67], v[192:207]
v_exp_f32 v90, v90
v_exp_f32 v91, v91
v_exp_f32 v92, v92
v_exp_f32 v93, v93
v_exp_f32 v94, v94
buffer_load_dwordx4 v10, s[64:67], s95 offen offset:3072 nt lds
v_mfma_f32_32x32x16_bf16 v[208:223], v[248:251], v[64:67], v[208:223]
v_exp_f32 v95, v95
v_add_f32 v29, v29, v80
v_add_f32 v30, v30, v81
v_add_f32 v29, v29, v82
v_add_f32 v30, v30, v83
s_add_u32 s95, s95, 4096
s_add_u32 m0, s31, 4096
s_nop 0
buffer_load_dwordx4 v10, s[64:67], s95 offen offset:0 nt lds
v_mfma_f32_32x32x16_bf16 v[160:175], v[228:231], v[68:71], v[160:175]
v_add_f32 v29, v29, v84
v_add_f32 v30, v30, v85
v_add_f32 v29, v29, v86
v_add_f32 v30, v30, v87
v_add_f32 v29, v29, v88
buffer_load_dwordx4 v10, s[64:67], s95 offen offset:1024 nt lds
v_mfma_f32_32x32x16_bf16 v[176:191], v[236:239], v[68:71], v[176:191]
v_add_f32 v30, v30, v89
v_add_f32 v29, v29, v90
v_add_f32 v30, v30, v91
v_add_f32 v29, v29, v92
v_add_f32 v30, v30, v93
buffer_load_dwordx4 v10, s[64:67], s95 offen offset:2048 nt lds
v_mfma_f32_32x32x16_bf16 v[192:207], v[244:247], v[68:71], v[192:207]
v_add_f32 v29, v29, v94
v_add_f32 v30, v30, v95
v_cvt_pk_bf16_f32 v80, v80, v81
v_cvt_pk_bf16_f32 v81, v82, v83
v_cvt_pk_bf16_f32 v82, v84, v85
buffer_load_dwordx4 v10, s[64:67], s95 offen offset:3072 nt lds
v_mfma_f32_32x32x16_bf16 v[208:223], v[252:255], v[68:71], v[208:223]
v_cvt_pk_bf16_f32 v83, v86, v87
v_cvt_pk_bf16_f32 v84, v88, v89
v_cvt_pk_bf16_f32 v85, v90, v91
v_cvt_pk_bf16_f32 v86, v92, v93
v_cvt_pk_bf16_f32 v87, v94, v95
s_waitcnt vmcnt(8)
ds_read_b64_tr_b16 v[224:225], v19 offset:8192
ds_read_b64_tr_b16 v[226:227], v19 offset:10240
ds_read_b64_tr_b16 v[228:229], v19 offset:12288
ds_read_b64_tr_b16 v[230:231], v19 offset:14336
ds_read_b64_tr_b16 v[232:233], v20 offset:8192
ds_read_b64_tr_b16 v[234:235], v20 offset:10240
ds_read_b64_tr_b16 v[236:237], v20 offset:12288
ds_read_b64_tr_b16 v[238:239], v20 offset:14336
ds_read_b64_tr_b16 v[240:241], v21 offset:8192
ds_read_b64_tr_b16 v[242:243], v21 offset:10240
ds_read_b64_tr_b16 v[244:245], v21 offset:12288
ds_read_b64_tr_b16 v[246:247], v21 offset:14336
ds_read_b64_tr_b16 v[248:249], v22 offset:8192
ds_read_b64_tr_b16 v[250:251], v22 offset:10240
ds_read_b64_tr_b16 v[252:253], v22 offset:12288
ds_read_b64_tr_b16 v[254:255], v22 offset:14336
v_fma_f32 v96, v96, s91, v28
v_fma_f32 v97, v97, s91, v28
v_fma_f32 v98, v98, s91, v28
v_fma_f32 v99, v99, s91, v28
v_fma_f32 v100, v100, s91, v28
v_fma_f32 v101, v101, s91, v28
v_fma_f32 v102, v102, s91, v28
v_fma_f32 v103, v103, s91, v28
v_fma_f32 v104, v104, s91, v28
v_fma_f32 v105, v105, s91, v28
v_fma_f32 v106, v106, s91, v28
v_fma_f32 v107, v107, s91, v28
v_fma_f32 v108, v108, s91, v28
v_fma_f32 v109, v109, s91, v28
v_fma_f32 v110, v110, s91, v28
v_fma_f32 v111, v111, s91, v28
s_waitcnt lgkmcnt(0)
s_add_u32 s95, s3, 5
s_and_b32 s95, s95, 7
s_lshl_b32 s95, s95, 14
s_add_u32 s95, s95, s96
s_add_u32 m0, s31, 8192
s_nop 0
buffer_load_dwordx4 v10, s[64:67], s95 offen offset:0 nt lds
v_mfma_f32_32x32x16_bf16 v[160:175], v[224:227], v[80:83], v[160:175]
v_exp_f32 v96, v96
v_exp_f32 v97, v97
v_exp_f32 v98, v98
v_exp_f32 v99, v99
v_exp_f32 v100, v100
buffer_load_dwordx4 v10, s[64:67], s95 offen offset:1024 nt lds
v_mfma_f32_32x32x16_bf16 v[176:191], v[232:235], v[80:83], v[176:191]
v_exp_f32 v101, v101
v_exp_f32 v102, v102
v_exp_f32 v103, v103
v_exp_f32 v104, v104
v_exp_f32 v105, v105
buffer_load_dwordx4 v10, s[64:67], s95 offen offset:2048 nt lds
v_mfma_f32_32x32x16_bf16 v[192:207], v[240:243], v[80:83], v[192:207]
v_exp_f32 v106, v106
v_exp_f32 v107, v107
v_exp_f32 v108, v108
v_exp_f32 v109, v109
v_exp_f32 v110, v110
buffer_load_dwordx4 v10, s[64:67], s95 offen offset:3072 nt lds
v_mfma_f32_32x32x16_bf16 v[208:223], v[248:251], v[80:83], v[208:223]
v_exp_f32 v111, v111
v_add_f32 v29, v29, v96
v_add_f32 v30, v30, v97
v_add_f32 v29, v29, v98
v_add_f32 v30, v30, v99
s_add_u32 s95, s95, 4096
s_add_u32 m0, s31, 12288
s_nop 0
buffer_load_dwordx4 v10, s[64:67], s95 offen offset:0 nt lds
v_mfma_f32_32x32x16_bf16 v[160:175], v[228:231], v[84:87], v[160:175]
v_add_f32 v29, v29, v100
v_add_f32 v30, v30, v101
v_add_f32 v29, v29, v102
v_add_f32 v30, v30, v103
v_add_f32 v29, v29, v104
buffer_load_dwordx4 v10, s[64:67], s95 offen offset:1024 nt lds
v_mfma_f32_32x32x16_bf16 v[176:191], v[236:239], v[84:87], v[176:191]
v_add_f32 v30, v30, v105
v_add_f32 v29, v29, v106
v_add_f32 v30, v30, v107
v_add_f32 v29, v29, v108
v_add_f32 v30, v30, v109
buffer_load_dwordx4 v10, s[64:67], s95 offen offset:2048 nt lds
v_mfma_f32_32x32x16_bf16 v[192:207], v[244:247], v[84:87], v[192:207]
v_add_f32 v29, v29, v110
v_add_f32 v30, v30, v111
v_cvt_pk_bf16_f32 v96, v96, v97
v_cvt_pk_bf16_f32 v97, v98, v99
v_cvt_pk_bf16_f32 v98, v100, v101
buffer_load_dwordx4 v10, s[64:67], s95 offen offset:3072 nt lds
v_mfma_f32_32x32x16_bf16 v[208:223], v[252:255], v[84:87], v[208:223]
v_cvt_pk_bf16_f32 v99, v102, v103
v_cvt_pk_bf16_f32 v100, v104, v105
v_cvt_pk_bf16_f32 v101, v106, v107
v_cvt_pk_bf16_f32 v102, v108, v109
v_cvt_pk_bf16_f32 v103, v110, v111
s_waitcnt vmcnt(8)
ds_read_b64_tr_b16 v[224:225], v19 offset:0
ds_read_b64_tr_b16 v[226:227], v19 offset:2048
ds_read_b64_tr_b16 v[228:229], v19 offset:4096
ds_read_b64_tr_b16 v[230:231], v19 offset:6144
ds_read_b64_tr_b16 v[232:233], v20 offset:0
ds_read_b64_tr_b16 v[234:235], v20 offset:2048
ds_read_b64_tr_b16 v[236:237], v20 offset:4096
ds_read_b64_tr_b16 v[238:239], v20 offset:6144
ds_read_b64_tr_b16 v[240:241], v21 offset:0
ds_read_b64_tr_b16 v[242:243], v21 offset:2048
ds_read_b64_tr_b16 v[244:245], v21 offset:4096
ds_read_b64_tr_b16 v[246:247], v21 offset:6144
ds_read_b64_tr_b16 v[248:249], v22 offset:0
ds_read_b64_tr_b16 v[250:251], v22 offset:2048
ds_read_b64_tr_b16 v[252:253], v22 offset:4096
ds_read_b64_tr_b16 v[254:255], v22 offset:6144
v_fma_f32 v112, v112, s91, v28
v_fma_f32 v113, v113, s91, v28
v_fma_f32 v114, v114, s91, v28
v_fma_f32 v115, v115, s91, v28
v_fma_f32 v116, v116, s91, v28
v_fma_f32 v117, v117, s91, v28
v_fma_f32 v118, v118, s91, v28
v_fma_f32 v119, v119, s91, v28
v_fma_f32 v120, v120, s91, v28
v_fma_f32 v121, v121, s91, v28
v_fma_f32 v122, v122, s91, v28
v_fma_f32 v123, v123, s91, v28
v_fma_f32 v124, v124, s91, v28
v_fma_f32 v125, v125, s91, v28
v_fma_f32 v126, v126, s91, v28
v_fma_f32 v127, v127, s91, v28
s_waitcnt lgkmcnt(0)
s_add_u32 s95, s3, 6
s_and_b32 s95, s95, 7
s_lshl_b32 s95, s95, 14
s_add_u32 s95, s95, s96
s_add_u32 m0, s31, 0
s_nop 0
buffer_load_dwordx4 v10, s[64:67], s95 offen offset:0 nt lds
v_mfma_f32_32x32x16_bf16 v[160:175], v[224:227], v[96:99], v[160:175]
v_exp_f32 v112, v112
v_exp_f32 v113, v113
v_exp_f32 v114, v114
v_exp_f32 v115, v115
v_exp_f32 v116, v116
buffer_load_dwordx4 v10, s[64:67], s95 offen offset:1024 nt lds
v_mfma_f32_32x32x16_bf16 v[176:191], v[232:235], v[96:99], v[176:191]
v_exp_f32 v117, v117
v_exp_f32 v118, v118
v_exp_f32 v119, v119
v_exp_f32 v120, v120
v_exp_f32 v121, v121
buffer_load_dwordx4 v10, s[64:67], s95 offen offset:2048 nt lds
v_mfma_f32_32x32x16_bf16 v[192:207], v[240:243], v[96:99], v[192:207]
v_exp_f32 v122, v122
v_exp_f32 v123, v123
v_exp_f32 v124, v124
v_exp_f32 v125, v125
v_exp_f32 v126, v126
buffer_load_dwordx4 v10, s[64:67], s95 offen offset:3072 nt lds
v_mfma_f32_32x32x16_bf16 v[208:223], v[248:251], v[96:99], v[208:223]
v_exp_f32 v127, v127
v_add_f32 v29, v29, v112
v_add_f32 v30, v30, v113
v_add_f32 v29, v29, v114
v_add_f32 v30, v30, v115
s_add_u32 s95, s95, 4096
s_add_u32 m0, s31, 4096
s_nop 0
buffer_load_dwordx4 v10, s[64:67], s95 offen offset:0 nt lds
v_mfma_f32_32x32x16_bf16 v[160:175], v[228:231], v[100:103], v[160:175]
v_add_f32 v29, v29, v116
v_add_f32 v30, v30, v117
v_add_f32 v29, v29, v118
v_add_f32 v30, v30, v119
v_add_f32 v29, v29, v120
buffer_load_dwordx4 v10, s[64:67], s95 offen offset:1024 nt lds
v_mfma_f32_32x32x16_bf16 v[176:191], v[236:239], v[100:103], v[176:191]
v_add_f32 v30, v30, v121
v_add_f32 v29, v29, v122
v_add_f32 v30, v30, v123
v_add_f32 v29, v29, v124
v_add_f32 v30, v30, v125
buffer_load_dwordx4 v10, s[64:67], s95 offen offset:2048 nt lds
v_mfma_f32_32x32x16_bf16 v[192:207], v[244:247], v[100:103], v[192:207]
v_add_f32 v29, v29, v126
v_add_f32 v30, v30, v127
v_cvt_pk_bf16_f32 v112, v112, v113
v_cvt_pk_bf16_f32 v113, v114, v115
v_cvt_pk_bf16_f32 v114, v116, v117
buffer_load_dwordx4 v10, s[64:67], s95 offen offset:3072 nt lds
v_mfma_f32_32x32x16_bf16 v[208:223], v[252:255], v[100:103], v[208:223]
v_cvt_pk_bf16_f32 v115, v118, v119
v_cvt_pk_bf16_f32 v116, v120, v121
v_cvt_pk_bf16_f32 v117, v122, v123
v_cvt_pk_bf16_f32 v118, v124, v125
v_cvt_pk_bf16_f32 v119, v126, v127
s_waitcnt vmcnt(8)
ds_read_b64_tr_b16 v[224:225], v19 offset:8192
ds_read_b64_tr_b16 v[226:227], v19 offset:10240
ds_read_b64_tr_b16 v[228:229], v19 offset:12288
ds_read_b64_tr_b16 v[230:231], v19 offset:14336
ds_read_b64_tr_b16 v[232:233], v20 offset:8192
ds_read_b64_tr_b16 v[234:235], v20 offset:10240
ds_read_b64_tr_b16 v[236:237], v20 offset:12288
ds_read_b64_tr_b16 v[238:239], v20 offset:14336
ds_read_b64_tr_b16 v[240:241], v21 offset:8192
ds_read_b64_tr_b16 v[242:243], v21 offset:10240
ds_read_b64_tr_b16 v[244:245], v21 offset:12288
ds_read_b64_tr_b16 v[246:247], v21 offset:14336
ds_read_b64_tr_b16 v[248:249], v22 offset:8192
ds_read_b64_tr_b16 v[250:251], v22 offset:10240
ds_read_b64_tr_b16 v[252:253], v22 offset:12288
ds_read_b64_tr_b16 v[254:255], v22 offset:14336
v_fma_f32 v128, v128, s91, v28
v_fma_f32 v129, v129, s91, v28
v_fma_f32 v130, v130, s91, v28
v_fma_f32 v131, v131, s91, v28
v_fma_f32 v132, v132, s91, v28
v_fma_f32 v133, v133, s91, v28
v_fma_f32 v134, v134, s91, v28
v_fma_f32 v135, v135, s91, v28
v_fma_f32 v136, v136, s91, v28
v_fma_f32 v137, v137, s91, v28
v_fma_f32 v138, v138, s91, v28
v_fma_f32 v139, v139, s91, v28
v_fma_f32 v140, v140, s91, v28
v_fma_f32 v141, v141, s91, v28
v_fma_f32 v142, v142, s91, v28
v_fma_f32 v143, v143, s91, v28
s_waitcnt lgkmcnt(0)
s_add_u32 s95, s3, 7
s_and_b32 s95, s95, 7
s_lshl_b32 s95, s95, 14
s_add_u32 s95, s95, s96
s_add_u32 m0, s31, 8192
s_nop 0
buffer_load_dwordx4 v10, s[64:67], s95 offen offset:0 nt lds
v_mfma_f32_32x32x16_bf16 v[160:175], v[224:227], v[112:115], v[160:175]
v_exp_f32 v128, v128
v_exp_f32 v129, v129
v_exp_f32 v130, v130
v_exp_f32 v131, v131
v_exp_f32 v132, v132
buffer_load_dwordx4 v10, s[64:67], s95 offen offset:1024 nt lds
v_mfma_f32_32x32x16_bf16 v[176:191], v[232:235], v[112:115], v[176:191]
v_exp_f32 v133, v133
v_exp_f32 v134, v134
v_exp_f32 v135, v135
v_exp_f32 v136, v136
v_exp_f32 v137, v137
buffer_load_dwordx4 v10, s[64:67], s95 offen offset:2048 nt lds
v_mfma_f32_32x32x16_bf16 v[192:207], v[240:243], v[112:115], v[192:207]
v_exp_f32 v138, v138
v_exp_f32 v139, v139
v_exp_f32 v140, v140
v_exp_f32 v141, v141
v_exp_f32 v142, v142
buffer_load_dwordx4 v10, s[64:67], s95 offen offset:3072 nt lds
v_mfma_f32_32x32x16_bf16 v[208:223], v[248:251], v[112:115], v[208:223]
v_exp_f32 v143, v143
v_add_f32 v29, v29, v128
v_add_f32 v30, v30, v129
v_add_f32 v29, v29, v130
v_add_f32 v30, v30, v131
s_add_u32 s95, s95, 4096
s_add_u32 m0, s31, 12288
s_nop 0
buffer_load_dwordx4 v10, s[64:67], s95 offen offset:0 nt lds
v_mfma_f32_32x32x16_bf16 v[160:175], v[228:231], v[116:119], v[160:175]
v_add_f32 v29, v29, v132
v_add_f32 v30, v30, v133
v_add_f32 v29, v29, v134
v_add_f32 v30, v30, v135
v_add_f32 v29, v29, v136
buffer_load_dwordx4 v10, s[64:67], s95 offen offset:1024 nt lds
v_mfma_f32_32x32x16_bf16 v[176:191], v[236:239], v[116:119], v[176:191]
v_add_f32 v30, v30, v137
v_add_f32 v29, v29, v138
v_add_f32 v30, v30, v139
v_add_f32 v29, v29, v140
v_add_f32 v30, v30, v141
buffer_load_dwordx4 v10, s[64:67], s95 offen offset:2048 nt lds
v_mfma_f32_32x32x16_bf16 v[192:207], v[244:247], v[116:119], v[192:207]
v_add_f32 v29, v29, v142
v_add_f32 v30, v30, v143
v_cvt_pk_bf16_f32 v128, v128, v129
v_cvt_pk_bf16_f32 v129, v130, v131
v_cvt_pk_bf16_f32 v130, v132, v133
buffer_load_dwordx4 v10, s[64:67], s95 offen offset:3072 nt lds
v_mfma_f32_32x32x16_bf16 v[208:223], v[252:255], v[116:119], v[208:223]
v_cvt_pk_bf16_f32 v131, v134, v135
v_cvt_pk_bf16_f32 v132, v136, v137
v_cvt_pk_bf16_f32 v133, v138, v139
v_cvt_pk_bf16_f32 v134, v140, v141
v_cvt_pk_bf16_f32 v135, v142, v143
s_waitcnt vmcnt(8)
ds_read_b64_tr_b16 v[224:225], v19 offset:0
ds_read_b64_tr_b16 v[226:227], v19 offset:2048
ds_read_b64_tr_b16 v[228:229], v19 offset:4096
ds_read_b64_tr_b16 v[230:231], v19 offset:6144
ds_read_b64_tr_b16 v[232:233], v20 offset:0
ds_read_b64_tr_b16 v[234:235], v20 offset:2048
ds_read_b64_tr_b16 v[236:237], v20 offset:4096
ds_read_b64_tr_b16 v[238:239], v20 offset:6144
ds_read_b64_tr_b16 v[240:241], v21 offset:0
ds_read_b64_tr_b16 v[242:243], v21 offset:2048
ds_read_b64_tr_b16 v[244:245], v21 offset:4096
ds_read_b64_tr_b16 v[246:247], v21 offset:6144
ds_read_b64_tr_b16 v[248:249], v22 offset:0
ds_read_b64_tr_b16 v[250:251], v22 offset:2048
ds_read_b64_tr_b16 v[252:253], v22 offset:4096
ds_read_b64_tr_b16 v[254:255], v22 offset:6144
v_fma_f32 v144, v144, s91, v28
v_fma_f32 v145, v145, s91, v28
v_fma_f32 v146, v146, s91, v28
v_fma_f32 v147, v147, s91, v28
v_fma_f32 v148, v148, s91, v28
v_fma_f32 v149, v149, s91, v28
v_fma_f32 v150, v150, s91, v28
v_fma_f32 v151, v151, s91, v28
v_fma_f32 v152, v152, s91, v28
v_fma_f32 v153, v153, s91, v28
v_fma_f32 v154, v154, s91, v28
v_fma_f32 v155, v155, s91, v28
v_fma_f32 v156, v156, s91, v28
v_fma_f32 v157, v157, s91, v28
v_fma_f32 v158, v158, s91, v28
v_fma_f32 v159, v159, s91, v28
s_waitcnt lgkmcnt(0)
s_add_u32 s95, s3, 0
s_and_b32 s95, s95, 3
s_lshl_b32 s95, s95, 14
s_add_u32 s95, s95, s96
s_add_u32 s95, s95, 4194304
s_add_u32 m0, s31, 0
s_nop 0
buffer_load_dwordx4 v6, s[60:63], s95 offen offset:0 nt lds
v_mfma_f32_32x32x16_bf16 v[160:175], v[224:227], v[128:131], v[160:175]
v_exp_f32 v144, v144
v_exp_f32 v145, v145
v_exp_f32 v146, v146
v_exp_f32 v147, v147
v_exp_f32 v148, v148
buffer_load_dwordx4 v7, s[60:63], s95 offen offset:1024 nt lds
v_mfma_f32_32x32x16_bf16 v[176:191], v[232:235], v[128:131], v[176:191]
v_exp_f32 v149, v149
v_exp_f32 v150, v150
v_exp_f32 v151, v151
v_exp_f32 v152, v152
v_exp_f32 v153, v153
buffer_load_dwordx4 v8, s[60:63], s95 offen offset:2048 nt lds
v_mfma_f32_32x32x16_bf16 v[192:207], v[240:243], v[128:131], v[192:207]
v_exp_f32 v154, v154
v_exp_f32 v155, v155
v_exp_f32 v156, v156
v_exp_f32 v157, v157
v_exp_f32 v158, v158
buffer_load_dwordx4 v9, s[60:63], s95 offen offset:3072 nt lds
v_mfma_f32_32x32x16_bf16 v[208:223], v[248:251], v[128:131], v[208:223]
v_exp_f32 v159, v159
v_add_f32 v29, v29, v144
v_add_f32 v30, v30, v145
v_add_f32 v29, v29, v146
v_add_f32 v30, v30, v147
s_add_u32 s95, s95, 4096
s_add_u32 m0, s31, 4096
s_nop 0
buffer_load_dwordx4 v6, s[60:63], s95 offen offset:0 nt lds
v_mfma_f32_32x32x16_bf16 v[160:175], v[228:231], v[132:135], v[160:175]
v_add_f32 v29, v29, v148
v_add_f32 v30, v30, v149
v_add_f32 v29, v29, v150
v_add_f32 v30, v30, v151
v_add_f32 v29, v29, v152
buffer_load_dwordx4 v7, s[60:63], s95 offen offset:1024 nt lds
v_mfma_f32_32x32x16_bf16 v[176:191], v[236:239], v[132:135], v[176:191]
v_add_f32 v30, v30, v153
v_add_f32 v29, v29, v154
v_add_f32 v30, v30, v155
v_add_f32 v29, v29, v156
v_add_f32 v30, v30, v157
buffer_load_dwordx4 v8, s[60:63], s95 offen offset:2048 nt lds
v_mfma_f32_32x32x16_bf16 v[192:207], v[244:247], v[132:135], v[192:207]
v_add_f32 v29, v29, v158
v_add_f32 v30, v30, v159
v_cvt_pk_bf16_f32 v144, v144, v145
v_cvt_pk_bf16_f32 v145, v146, v147
v_cvt_pk_bf16_f32 v146, v148, v149
buffer_load_dwordx4 v9, s[60:63], s95 offen offset:3072 nt lds
v_mfma_f32_32x32x16_bf16 v[208:223], v[252:255], v[132:135], v[208:223]
v_cvt_pk_bf16_f32 v147, v150, v151
v_cvt_pk_bf16_f32 v148, v152, v153
v_cvt_pk_bf16_f32 v149, v154, v155
v_cvt_pk_bf16_f32 v150, v156, v157
v_cvt_pk_bf16_f32 v151, v158, v159
s_waitcnt vmcnt(8)
ds_read_b64_tr_b16 v[224:225], v19 offset:8192
ds_read_b64_tr_b16 v[226:227], v19 offset:10240
ds_read_b64_tr_b16 v[228:229], v19 offset:12288
ds_read_b64_tr_b16 v[230:231], v19 offset:14336
ds_read_b64_tr_b16 v[232:233], v20 offset:8192
ds_read_b64_tr_b16 v[234:235], v20 offset:10240
ds_read_b64_tr_b16 v[236:237], v20 offset:12288
ds_read_b64_tr_b16 v[238:239], v20 offset:14336
ds_read_b64_tr_b16 v[240:241], v21 offset:8192
ds_read_b64_tr_b16 v[242:243], v21 offset:10240
ds_read_b64_tr_b16 v[244:245], v21 offset:12288
ds_read_b64_tr_b16 v[246:247], v21 offset:14336
ds_read_b64_tr_b16 v[248:249], v22 offset:8192
ds_read_b64_tr_b16 v[250:251], v22 offset:10240
ds_read_b64_tr_b16 v[252:253], v22 offset:12288
ds_read_b64_tr_b16 v[254:255], v22 offset:14336
s_waitcnt lgkmcnt(0)
s_add_u32 s95, s3, 1
s_and_b32 s95, s95, 3
s_lshl_b32 s95, s95, 14
s_add_u32 s95, s95, s96
s_add_u32 s95, s95, 4194304
s_add_u32 m0, s31, 8192
s_nop 0
buffer_load_dwordx4 v6, s[60:63], s95 offen offset:0 nt lds
v_mfma_f32_32x32x16_bf16 v[160:175], v[224:227], v[144:147], v[160:175]
buffer_load_dwordx4 v7, s[60:63], s95 offen offset:1024 nt lds
v_mfma_f32_32x32x16_bf16 v[176:191], v[232:235], v[144:147], v[176:191]
buffer_load_dwordx4 v8, s[60:63], s95 offen offset:2048 nt lds
v_mfma_f32_32x32x16_bf16 v[192:207], v[240:243], v[144:147], v[192:207]
buffer_load_dwordx4 v9, s[60:63], s95 offen offset:3072 nt lds
v_mfma_f32_32x32x16_bf16 v[208:223], v[248:251], v[144:147], v[208:223]
s_add_u32 s95, s95, 4096
s_add_u32 m0, s31, 12288
s_nop 0
buffer_load_dwordx4 v6, s[60:63], s95 offen offset:0 nt lds
v_mfma_f32_32x32x16_bf16 v[160:175], v[228:231], v[148:151], v[160:175]
buffer_load_dwordx4 v7, s[60:63], s95 offen offset:1024 nt lds
v_mfma_f32_32x32x16_bf16 v[176:191], v[236:239], v[148:151], v[176:191]
buffer_load_dwordx4 v8, s[60:63], s95 offen offset:2048 nt lds
v_mfma_f32_32x32x16_bf16 v[192:207], v[244:247], v[148:151], v[192:207]
buffer_load_dwordx4 v9, s[60:63], s95 offen offset:3072 nt lds
v_mfma_f32_32x32x16_bf16 v[208:223], v[252:255], v[148:151], v[208:223]
s_lshl_b32 s93, s30, 13
s_add_u32 s93, s93, 147456
v_add_u32 v31, s93, v1
ds_read_b128 v[128:131], v31 offset:0
ds_read_b128 v[132:135], v31 offset:1024
ds_read_b128 v[136:139], v31 offset:2048
ds_read_b128 v[140:143], v31 offset:3072
ds_read_b128 v[144:147], v31 offset:4096
ds_read_b128 v[148:151], v31 offset:5120
ds_read_b128 v[152:155], v31 offset:6144
ds_read_b128 v[156:159], v31 offset:7168
s_waitcnt lgkmcnt(0)
s_barrier
v_add_f32 v29, v29, v30
v_mov_b32 v31, v29
s_nop 1
v_permlane32_swap_b32 v29, v31
v_add_f32 v29, v29, v31
v_mov_b32 v224, v27
v_mov_b32 v225, v29
v_add_u32 v19, s86, v1
v_add_u32 v20, s87, v1
v_lshlrev_b32 v31, 3, v0
s_lshl_b32 s93, s26, 9
s_add_u32 s93, s93, 147456
s_xor_b32 s92, s93, 0x400
v_add_u32 v21, s93, v31
v_add_u32 v22, s92, v31
ds_write_b64 v21, v[224:225]
ds_write_b128 v19, v[192:195] offset:0
ds_write_b128 v19, v[196:199] offset:1024
ds_write_b128 v19, v[200:203] offset:2048
ds_write_b128 v19, v[204:207] offset:3072
ds_write_b128 v19, v[208:211] offset:4096
ds_write_b128 v19, v[212:215] offset:5120
ds_write_b128 v19, v[216:219] offset:6144
ds_write_b128 v19, v[220:223] offset:7168
s_waitcnt lgkmcnt(0)
s_barrier
ds_read_b64 v[226:227], v22
ds_read_b128 v[32:35], v20 offset:0
ds_read_b128 v[36:39], v20 offset:1024
ds_read_b128 v[40:43], v20 offset:2048
ds_read_b128 v[44:47], v20 offset:3072
ds_read_b128 v[48:51], v20 offset:4096
ds_read_b128 v[52:55], v20 offset:5120
ds_read_b128 v[56:59], v20 offset:6144
ds_read_b128 v[60:63], v20 offset:7168
s_waitcnt lgkmcnt(8)
v_max_f32 v228, v224, v226
v_sub_f32 v229, v224, v228
v_sub_f32 v230, v226, v228
v_mul_f32 v229, s91, v229
v_mul_f32 v230, s91, v230
v_exp_f32 v229, v229
v_exp_f32 v230, v230
v_mul_f32 v232, v225, v229
v_fma_f32 v232, v227, v230, v232
v_rcp_f32 v232, v232
s_nop 0
v_mul_f32 v229, v229, v232
v_mul_f32 v230, v230, v232
v_mul_f32 v160, v160, v229
v_mul_f32 v161, v161, v229
v_mul_f32 v162, v162, v229
v_mul_f32 v163, v163, v229
v_mul_f32 v164, v164, v229
v_mul_f32 v165, v165, v229
v_mul_f32 v166, v166, v229
v_mul_f32 v167, v167, v229
v_mul_f32 v168, v168, v229
v_mul_f32 v169, v169, v229
v_mul_f32 v170, v170, v229
v_mul_f32 v171, v171, v229
v_mul_f32 v172, v172, v229
v_mul_f32 v173, v173, v229
v_mul_f32 v174, v174, v229
v_mul_f32 v175, v175, v229
v_mul_f32 v176, v176, v229
v_mul_f32 v177, v177, v229
v_mul_f32 v178, v178, v229
v_mul_f32 v179, v179, v229
v_mul_f32 v180, v180, v229
v_mul_f32 v181, v181, v229
v_mul_f32 v182, v182, v229
v_mul_f32 v183, v183, v229
v_mul_f32 v184, v184, v229
v_mul_f32 v185, v185, v229
v_mul_f32 v186, v186, v229
v_mul_f32 v187, v187, v229
v_mul_f32 v188, v188, v229
v_mul_f32 v189, v189, v229
v_mul_f32 v190, v190, v229
v_mul_f32 v191, v191, v229
s_waitcnt lgkmcnt(0)
v_fma_f32 v160, v32, v230, v160
v_fma_f32 v161, v33, v230, v161
v_fma_f32 v162, v34, v230, v162
v_fma_f32 v163, v35, v230, v163
v_fma_f32 v164, v36, v230, v164
v_fma_f32 v165, v37, v230, v165
v_fma_f32 v166, v38, v230, v166
v_fma_f32 v167, v39, v230, v167
v_fma_f32 v168, v40, v230, v168
v_fma_f32 v169, v41, v230, v169
v_fma_f32 v170, v42, v230, v170
v_fma_f32 v171, v43, v230, v171
v_fma_f32 v172, v44, v230, v172
v_fma_f32 v173, v45, v230, v173
v_fma_f32 v174, v46, v230, v174
v_fma_f32 v175, v47, v230, v175
v_fma_f32 v176, v48, v230, v176
v_fma_f32 v177, v49, v230, v177
v_fma_f32 v178, v50, v230, v178
v_fma_f32 v179, v51, v230, v179
v_fma_f32 v180, v52, v230, v180
v_fma_f32 v181, v53, v230, v181
v_fma_f32 v182, v54, v230, v182
v_fma_f32 v183, v55, v230, v183
v_fma_f32 v184, v56, v230, v184
v_fma_f32 v185, v57, v230, v185
v_fma_f32 v186, v58, v230, v186
v_fma_f32 v187, v59, v230, v187
v_fma_f32 v188, v60, v230, v188
v_fma_f32 v189, v61, v230, v189
v_fma_f32 v190, v62, v230, v190
v_fma_f32 v191, v63, v230, v191
v_cvt_pk_bf16_f32 v64, v160, v161
v_cvt_pk_bf16_f32 v65, v162, v163
v_cvt_pk_bf16_f32 v66, v164, v165
v_cvt_pk_bf16_f32 v67, v166, v167
v_cvt_pk_bf16_f32 v68, v168, v169
v_cvt_pk_bf16_f32 v69, v170, v171
v_cvt_pk_bf16_f32 v70, v172, v173
v_cvt_pk_bf16_f32 v71, v174, v175
v_cvt_pk_bf16_f32 v72, v176, v177
v_cvt_pk_bf16_f32 v73, v178, v179
v_cvt_pk_bf16_f32 v74, v180, v181
v_cvt_pk_bf16_f32 v75, v182, v183
v_cvt_pk_bf16_f32 v76, v184, v185
v_cvt_pk_bf16_f32 v77, v186, v187
v_cvt_pk_bf16_f32 v78, v188, v189
v_cvt_pk_bf16_f32 v79, v190, v191
ds_write_b128 v20, v[64:67] offset:0
ds_write_b128 v20, v[68:71] offset:1024
ds_write_b128 v20, v[72:75] offset:2048
ds_write_b128 v20, v[76:79] offset:3072
s_waitcnt lgkmcnt(0)
s_barrier
v_mov_b32 v192, v128
v_mov_b32 v193, v129
v_mov_b32 v194, v130
v_mov_b32 v195, v131
v_mov_b32 v196, v132
v_mov_b32 v197, v133
v_mov_b32 v198, v134
v_mov_b32 v199, v135
v_mov_b32 v200, v136
v_mov_b32 v201, v137
v_mov_b32 v202, v138
v_mov_b32 v203, v139
v_mov_b32 v204, v140
v_mov_b32 v205, v141
v_mov_b32 v206, v142
v_mov_b32 v207, v143
v_mov_b32 v208, v144
v_mov_b32 v209, v145
v_mov_b32 v210, v146
v_mov_b32 v211, v147
v_mov_b32 v212, v148
v_mov_b32 v213, v149
v_mov_b32 v214, v150
v_mov_b32 v215, v151
v_mov_b32 v216, v152
v_mov_b32 v217, v153
v_mov_b32 v218, v154
v_mov_b32 v219, v155
v_mov_b32 v220, v156
v_mov_b32 v221, v157
v_mov_b32 v222, v158
v_mov_b32 v223, v159
v_add_u32 v19, s31, v2
v_xor_b32 v20, 32, v19
v_xor_b32 v21, 64, v19
v_xor_b32 v22, 96, v19
v_xor_b32 v23, 128, v19
v_xor_b32 v24, 160, v19
v_xor_b32 v25, 192, v19
v_xor_b32 v26, 224, v19
s_waitcnt vmcnt(8)
ds_read_b128 v[224:227], v19 offset:0
ds_read_b128 v[228:231], v20 offset:0
ds_read_b128 v[232:235], v21 offset:0
ds_read_b128 v[236:239], v22 offset:0
ds_read_b128 v[240:243], v23 offset:0
ds_read_b128 v[244:247], v24 offset:0
ds_read_b128 v[248:251], v25 offset:0
ds_read_b128 v[252:255], v26 offset:0
s_waitcnt lgkmcnt(0)
s_add_u32 s95, s3, 2
s_and_b32 s95, s95, 3
s_lshl_b32 s95, s95, 14
s_add_u32 s95, s95, s96
s_add_u32 s95, s95, 4194304
s_add_u32 m0, s31, 0
s_nop 0
buffer_load_dwordx4 v6, s[60:63], s95 offen offset:0 nt lds
v_mfma_f32_32x32x16_bf16 v[32:47], v[224:227], v[192:195], 0
buffer_load_dwordx4 v7, s[60:63], s95 offen offset:1024 nt lds
v_mfma_f32_32x32x16_bf16 v[32:47], v[228:231], v[196:199], v[32:47]
buffer_load_dwordx4 v8, s[60:63], s95 offen offset:2048 nt lds
v_mfma_f32_32x32x16_bf16 v[32:47], v[232:235], v[200:203], v[32:47]
buffer_load_dwordx4 v9, s[60:63], s95 offen offset:3072 nt lds
v_mfma_f32_32x32x16_bf16 v[32:47], v[236:239], v[204:207], v[32:47]
s_add_u32 s95, s95, 4096
s_add_u32 m0, s31, 4096
s_nop 0
buffer_load_dwordx4 v6, s[60:63], s95 offen offset:0 nt lds
v_mfma_f32_32x32x16_bf16 v[32:47], v[240:243], v[208:211], v[32:47]
buffer_load_dwordx4 v7, s[60:63], s95 offen offset:1024 nt lds
v_mfma_f32_32x32x16_bf16 v[32:47], v[244:247], v[212:215], v[32:47]
buffer_load_dwordx4 v8, s[60:63], s95 offen offset:2048 nt lds
v_mfma_f32_32x32x16_bf16 v[32:47], v[248:251], v[216:219], v[32:47]
buffer_load_dwordx4 v9, s[60:63], s95 offen offset:3072 nt lds
v_mfma_f32_32x32x16_bf16 v[32:47], v[252:255], v[220:223], v[32:47]
v_add_u32 v31, 114688, v1
ds_read_b128 v[160:163], v31 offset:16384
ds_read_b128 v[164:167], v31 offset:17408
ds_read_b128 v[168:171], v31 offset:18432
ds_read_b128 v[172:175], v31 offset:19456
s_waitcnt lgkmcnt(3)
v_mfma_f32_32x32x16_bf16 v[96:111], a[0:3], v[160:163], 0
v_mfma_f32_32x32x16_bf16 v[112:127], a[4:7], v[160:163], 0
v_mfma_f32_32x32x16_bf16 v[128:143], a[8:11], v[160:163], 0
v_mfma_f32_32x32x16_bf16 v[144:159], a[12:15], v[160:163], 0
s_waitcnt lgkmcnt(2)
v_mfma_f32_32x32x16_bf16 v[96:111], a[16:19], v[164:167], v[96:111]
v_mfma_f32_32x32x16_bf16 v[112:127], a[20:23], v[164:167], v[112:127]
v_mfma_f32_32x32x16_bf16 v[128:143], a[24:27], v[164:167], v[128:143]
v_mfma_f32_32x32x16_bf16 v[144:159], a[28:31], v[164:167], v[144:159]
s_waitcnt lgkmcnt(1)
v_mfma_f32_32x32x16_bf16 v[96:111], a[32:35], v[168:171], v[96:111]
v_mfma_f32_32x32x16_bf16 v[112:127], a[36:39], v[168:171], v[112:127]
v_mfma_f32_32x32x16_bf16 v[128:143], a[40:43], v[168:171], v[128:143]
v_mfma_f32_32x32x16_bf16 v[144:159], a[44:47], v[168:171], v[144:159]
s_waitcnt lgkmcnt(0)
v_mfma_f32_32x32x16_bf16 v[96:111], a[48:51], v[172:175], v[96:111]
v_mfma_f32_32x32x16_bf16 v[112:127], a[52:55], v[172:175], v[112:127]
v_mfma_f32_32x32x16_bf16 v[128:143], a[56:59], v[172:175], v[128:143]
v_mfma_f32_32x32x16_bf16 v[144:159], a[60:63], v[172:175], v[144:159]
s_waitcnt vmcnt(8)
ds_read_b128 v[224:227], v19 offset:8192
ds_read_b128 v[228:231], v20 offset:8192
ds_read_b128 v[232:235], v21 offset:8192
ds_read_b128 v[236:239], v22 offset:8192
ds_read_b128 v[240:243], v23 offset:8192
ds_read_b128 v[244:247], v24 offset:8192
ds_read_b128 v[248:251], v25 offset:8192
ds_read_b128 v[252:255], v26 offset:8192
v_max_f32 v27, v32, v33
v_max3_f32 v27, v27, v34, v35
v_max3_f32 v27, v27, v36, v37
v_max3_f32 v27, v27, v38, v39
v_max3_f32 v27, v27, v40, v41
v_max3_f32 v27, v27, v42, v43
v_max3_f32 v27, v27, v44, v45
v_max3_f32 v27, v27, v46, v47
s_waitcnt lgkmcnt(0)
s_add_u32 s95, s3, 3
s_and_b32 s95, s95, 3
s_lshl_b32 s95, s95, 14
s_add_u32 s95, s95, s96
s_add_u32 s95, s95, 4194304
s_add_u32 m0, s31, 8192
s_nop 0
buffer_load_dwordx4 v6, s[60:63], s95 offen offset:0 nt lds
v_mfma_f32_32x32x16_bf16 v[48:63], v[224:227], v[192:195], 0
buffer_load_dwordx4 v7, s[60:63], s95 offen offset:1024 nt lds
v_mfma_f32_32x32x16_bf16 v[48:63], v[228:231], v[196:199], v[48:63]
buffer_load_dwordx4 v8, s[60:63], s95 offen offset:2048 nt lds
v_mfma_f32_32x32x16_bf16 v[48:63], v[232:235], v[200:203], v[48:63]
buffer_load_dwordx4 v9, s[60:63], s95 offen offset:3072 nt lds
v_mfma_f32_32x32x16_bf16 v[48:63], v[236:239], v[204:207], v[48:63]
s_add_u32 s95, s95, 4096
s_add_u32 m0, s31, 12288
s_nop 0
buffer_load_dwordx4 v6, s[60:63], s95 offen offset:0 nt lds
v_mfma_f32_32x32x16_bf16 v[48:63], v[240:243], v[208:211], v[48:63]
buffer_load_dwordx4 v7, s[60:63], s95 offen offset:1024 nt lds
v_mfma_f32_32x32x16_bf16 v[48:63], v[244:247], v[212:215], v[48:63]
buffer_load_dwordx4 v8, s[60:63], s95 offen offset:2048 nt lds
v_mfma_f32_32x32x16_bf16 v[48:63], v[248:251], v[216:219], v[48:63]
buffer_load_dwordx4 v9, s[60:63], s95 offen offset:3072 nt lds
v_mfma_f32_32x32x16_bf16 v[48:63], v[252:255], v[220:223], v[48:63]
v_add_u32 v31, 114688, v1
ds_read_b128 v[160:163], v31 offset:0
ds_read_b128 v[164:167], v31 offset:1024
ds_read_b128 v[168:171], v31 offset:2048
ds_read_b128 v[172:175], v31 offset:3072
s_waitcnt lgkmcnt(3)
v_mfma_f32_32x32x16_bf16 v[96:111], a[64:67], v[160:163], v[96:111]
v_mfma_f32_32x32x16_bf16 v[112:127], a[68:71], v[160:163], v[112:127]
v_mfma_f32_32x32x16_bf16 v[128:143], a[72:75], v[160:163], v[128:143]
v_mfma_f32_32x32x16_bf16 v[144:159], a[76:79], v[160:163], v[144:159]
s_waitcnt lgkmcnt(2)
v_mfma_f32_32x32x16_bf16 v[96:111], a[80:83], v[164:167], v[96:111]
v_mfma_f32_32x32x16_bf16 v[112:127], a[84:87], v[164:167], v[112:127]
v_mfma_f32_32x32x16_bf16 v[128:143], a[88:91], v[164:167], v[128:143]
v_mfma_f32_32x32x16_bf16 v[144:159], a[92:95], v[164:167], v[144:159]
s_waitcnt lgkmcnt(1)
v_mfma_f32_32x32x16_bf16 v[96:111], a[96:99], v[168:171], v[96:111]
v_mfma_f32_32x32x16_bf16 v[112:127], a[100:103], v[168:171], v[112:127]
v_mfma_f32_32x32x16_bf16 v[128:143], a[104:107], v[168:171], v[128:143]
v_mfma_f32_32x32x16_bf16 v[144:159], a[108:111], v[168:171], v[144:159]
s_waitcnt lgkmcnt(0)
v_mfma_f32_32x32x16_bf16 v[96:111], a[112:115], v[172:175], v[96:111]
v_mfma_f32_32x32x16_bf16 v[112:127], a[116:119], v[172:175], v[112:127]
v_mfma_f32_32x32x16_bf16 v[128:143], a[120:123], v[172:175], v[128:143]
v_mfma_f32_32x32x16_bf16 v[144:159], a[124:127], v[172:175], v[144:159]
s_waitcnt vmcnt(8)
ds_read_b128 v[224:227], v19 offset:0
ds_read_b128 v[228:231], v20 offset:0
ds_read_b128 v[232:235], v21 offset:0
ds_read_b128 v[236:239], v22 offset:0
ds_read_b128 v[240:243], v23 offset:0
ds_read_b128 v[244:247], v24 offset:0
ds_read_b128 v[248:251], v25 offset:0
ds_read_b128 v[252:255], v26 offset:0
v_max3_f32 v27, v27, v48, v49
v_max3_f32 v27, v27, v50, v51
v_max3_f32 v27, v27, v52, v53
v_max3_f32 v27, v27, v54, v55
v_max3_f32 v27, v27, v56, v57
v_max3_f32 v27, v27, v58, v59
v_max3_f32 v27, v27, v60, v61
v_max3_f32 v27, v27, v62, v63
s_waitcnt lgkmcnt(0)
s_add_u32 s95, s3, 0
s_and_b32 s95, s95, 3
s_lshl_b32 s95, s95, 14
s_add_u32 s95, s95, s96
s_add_u32 s95, s95, 4194304
s_add_u32 m0, s31, 0
s_nop 0
buffer_load_dwordx4 v10, s[64:67], s95 offen offset:0 nt lds
v_mfma_f32_32x32x16_bf16 v[64:79], v[224:227], v[192:195], 0
buffer_load_dwordx4 v10, s[64:67], s95 offen offset:1024 nt lds
v_mfma_f32_32x32x16_bf16 v[64:79], v[228:231], v[196:199], v[64:79]
buffer_load_dwordx4 v10, s[64:67], s95 offen offset:2048 nt lds
v_mfma_f32_32x32x16_bf16 v[64:79], v[232:235], v[200:203], v[64:79]
buffer_load_dwordx4 v10, s[64:67], s95 offen offset:3072 nt lds
v_mfma_f32_32x32x16_bf16 v[64:79], v[236:239], v[204:207], v[64:79]
s_add_u32 s95, s95, 4096
s_add_u32 m0, s31, 4096
s_nop 0
buffer_load_dwordx4 v10, s[64:67], s95 offen offset:0 nt lds
v_mfma_f32_32x32x16_bf16 v[64:79], v[240:243], v[208:211], v[64:79]
buffer_load_dwordx4 v10, s[64:67], s95 offen offset:1024 nt lds
v_mfma_f32_32x32x16_bf16 v[64:79], v[244:247], v[212:215], v[64:79]
buffer_load_dwordx4 v10, s[64:67], s95 offen offset:2048 nt lds
v_mfma_f32_32x32x16_bf16 v[64:79], v[248:251], v[216:219], v[64:79]
buffer_load_dwordx4 v10, s[64:67], s95 offen offset:3072 nt lds
v_mfma_f32_32x32x16_bf16 v[64:79], v[252:255], v[220:223], v[64:79]
v_add_u32 v31, 114688, v1
ds_read_b128 v[160:163], v31 offset:24576
ds_read_b128 v[164:167], v31 offset:25600
ds_read_b128 v[168:171], v31 offset:26624
ds_read_b128 v[172:175], v31 offset:27648
s_waitcnt lgkmcnt(3)
v_mfma_f32_32x32x16_bf16 v[96:111], a[128:131], v[160:163], v[96:111]
v_mfma_f32_32x32x16_bf16 v[112:127], a[132:135], v[160:163], v[112:127]
v_mfma_f32_32x32x16_bf16 v[128:143], a[136:139], v[160:163], v[128:143]
v_mfma_f32_32x32x16_bf16 v[144:159], a[140:143], v[160:163], v[144:159]
s_waitcnt lgkmcnt(2)
v_mfma_f32_32x32x16_bf16 v[96:111], a[144:147], v[164:167], v[96:111]
v_mfma_f32_32x32x16_bf16 v[112:127], a[148:151], v[164:167], v[112:127]
v_mfma_f32_32x32x16_bf16 v[128:143], a[152:155], v[164:167], v[128:143]
v_mfma_f32_32x32x16_bf16 v[144:159], a[156:159], v[164:167], v[144:159]
s_waitcnt lgkmcnt(1)
v_mfma_f32_32x32x16_bf16 v[96:111], a[160:163], v[168:171], v[96:111]
v_mfma_f32_32x32x16_bf16 v[112:127], a[164:167], v[168:171], v[112:127]
v_mfma_f32_32x32x16_bf16 v[128:143], a[168:171], v[168:171], v[128:143]
v_mfma_f32_32x32x16_bf16 v[144:159], a[172:175], v[168:171], v[144:159]
s_waitcnt lgkmcnt(0)
v_mfma_f32_32x32x16_bf16 v[96:111], a[176:179], v[172:175], v[96:111]
v_mfma_f32_32x32x16_bf16 v[112:127], a[180:183], v[172:175], v[112:127]
v_mfma_f32_32x32x16_bf16 v[128:143], a[184:187], v[172:175], v[128:143]
v_mfma_f32_32x32x16_bf16 v[144:159], a[188:191], v[172:175], v[144:159]
s_waitcnt vmcnt(8)
ds_read_b128 v[224:227], v19 offset:8192
ds_read_b128 v[228:231], v20 offset:8192
ds_read_b128 v[232:235], v21 offset:8192
ds_read_b128 v[236:239], v22 offset:8192
ds_read_b128 v[240:243], v23 offset:8192
ds_read_b128 v[244:247], v24 offset:8192
ds_read_b128 v[248:251], v25 offset:8192
ds_read_b128 v[252:255], v26 offset:8192
v_max3_f32 v27, v27, v64, v65
v_max3_f32 v27, v27, v66, v67
v_max3_f32 v27, v27, v68, v69
v_max3_f32 v27, v27, v70, v71
v_max3_f32 v27, v27, v72, v73
v_max3_f32 v27, v27, v74, v75
v_max3_f32 v27, v27, v76, v77
v_max3_f32 v27, v27, v78, v79
s_waitcnt lgkmcnt(0)
s_add_u32 s95, s3, 1
s_and_b32 s95, s95, 3
s_lshl_b32 s95, s95, 14
s_add_u32 s95, s95, s96
s_add_u32 s95, s95, 4194304
s_add_u32 m0, s31, 8192
s_nop 0
buffer_load_dwordx4 v10, s[64:67], s95 offen offset:0 nt lds
v_mfma_f32_32x32x16_bf16 v[80:95], v[224:227], v[192:195], 0
buffer_load_dwordx4 v10, s[64:67], s95 offen offset:1024 nt lds
v_mfma_f32_32x32x16_bf16 v[80:95], v[228:231], v[196:199], v[80:95]
buffer_load_dwordx4 v10, s[64:67], s95 offen offset:2048 nt lds
v_mfma_f32_32x32x16_bf16 v[80:95], v[232:235], v[200:203], v[80:95]
buffer_load_dwordx4 v10, s[64:67], s95 offen offset:3072 nt lds
v_mfma_f32_32x32x16_bf16 v[80:95], v[236:239], v[204:207], v[80:95]
s_add_u32 s95, s95, 4096
s_add_u32 m0, s31, 12288
s_nop 0
buffer_load_dwordx4 v10, s[64:67], s95 offen offset:0 nt lds
v_mfma_f32_32x32x16_bf16 v[80:95], v[240:243], v[208:211], v[80:95]
buffer_load_dwordx4 v10, s[64:67], s95 offen offset:1024 nt lds
v_mfma_f32_32x32x16_bf16 v[80:95], v[244:247], v[212:215], v[80:95]
buffer_load_dwordx4 v10, s[64:67], s95 offen offset:2048 nt lds
v_mfma_f32_32x32x16_bf16 v[80:95], v[248:251], v[216:219], v[80:95]
buffer_load_dwordx4 v10, s[64:67], s95 offen offset:3072 nt lds
v_mfma_f32_32x32x16_bf16 v[80:95], v[252:255], v[220:223], v[80:95]
v_add_u32 v31, 114688, v1
ds_read_b128 v[160:163], v31 offset:8192
ds_read_b128 v[164:167], v31 offset:9216
ds_read_b128 v[168:171], v31 offset:10240
ds_read_b128 v[172:175], v31 offset:11264
s_waitcnt lgkmcnt(3)
v_mfma_f32_32x32x16_bf16 v[96:111], a[192:195], v[160:163], v[96:111]
v_mfma_f32_32x32x16_bf16 v[112:127], a[196:199], v[160:163], v[112:127]
v_mfma_f32_32x32x16_bf16 v[128:143], a[200:203], v[160:163], v[128:143]
v_mfma_f32_32x32x16_bf16 v[144:159], a[204:207], v[160:163], v[144:159]
s_waitcnt lgkmcnt(2)
v_mfma_f32_32x32x16_bf16 v[96:111], a[208:211], v[164:167], v[96:111]
v_mfma_f32_32x32x16_bf16 v[112:127], a[212:215], v[164:167], v[112:127]
v_mfma_f32_32x32x16_bf16 v[128:143], a[216:219], v[164:167], v[128:143]
v_mfma_f32_32x32x16_bf16 v[144:159], a[220:223], v[164:167], v[144:159]
s_waitcnt lgkmcnt(1)
v_mfma_f32_32x32x16_bf16 v[96:111], a[224:227], v[168:171], v[96:111]
v_mfma_f32_32x32x16_bf16 v[112:127], a[228:231], v[168:171], v[112:127]
v_mfma_f32_32x32x16_bf16 v[128:143], a[232:235], v[168:171], v[128:143]
v_mfma_f32_32x32x16_bf16 v[144:159], a[236:239], v[168:171], v[144:159]
s_waitcnt lgkmcnt(0)
v_mfma_f32_32x32x16_bf16 v[96:111], a[240:243], v[172:175], v[96:111]
v_mfma_f32_32x32x16_bf16 v[112:127], a[244:247], v[172:175], v[112:127]
v_mfma_f32_32x32x16_bf16 v[128:143], a[248:251], v[172:175], v[128:143]
v_mfma_f32_32x32x16_bf16 v[144:159], a[252:255], v[172:175], v[144:159]
s_nop 8
v_cvt_pk_bf16_f32 v160, v96, v97
v_cvt_pk_bf16_f32 v161, v98, v99
v_cvt_pk_bf16_f32 v162, v100, v101
v_cvt_pk_bf16_f32 v163, v102, v103
v_cvt_pk_bf16_f32 v164, v104, v105
v_cvt_pk_bf16_f32 v165, v106, v107
v_cvt_pk_bf16_f32 v166, v108, v109
v_cvt_pk_bf16_f32 v167, v110, v111
v_cvt_pk_bf16_f32 v168, v112, v113
v_cvt_pk_bf16_f32 v169, v114, v115
v_cvt_pk_bf16_f32 v170, v116, v117
v_cvt_pk_bf16_f32 v171, v118, v119
v_cvt_pk_bf16_f32 v172, v120, v121
v_cvt_pk_bf16_f32 v173, v122, v123
v_cvt_pk_bf16_f32 v174, v124, v125
v_cvt_pk_bf16_f32 v175, v126, v127
s_add_u32 s93, s88, 0
buffer_store_dwordx4 v[160:163], v1, s[76:79], s93 offen offset:0 sc1
buffer_store_dwordx4 v[164:167], v1, s[76:79], s93 offen offset:1024 sc1
buffer_store_dwordx4 v[168:171], v1, s[76:79], s93 offen offset:2048 sc1
buffer_store_dwordx4 v[172:175], v1, s[76:79], s93 offen offset:3072 sc1
v_cvt_pk_bf16_f32 v176, v128, v129
v_cvt_pk_bf16_f32 v177, v130, v131
v_cvt_pk_bf16_f32 v178, v132, v133
v_cvt_pk_bf16_f32 v179, v134, v135
v_cvt_pk_bf16_f32 v180, v136, v137
v_cvt_pk_bf16_f32 v181, v138, v139
v_cvt_pk_bf16_f32 v182, v140, v141
v_cvt_pk_bf16_f32 v183, v142, v143
v_cvt_pk_bf16_f32 v184, v144, v145
v_cvt_pk_bf16_f32 v185, v146, v147
v_cvt_pk_bf16_f32 v186, v148, v149
v_cvt_pk_bf16_f32 v187, v150, v151
v_cvt_pk_bf16_f32 v188, v152, v153
v_cvt_pk_bf16_f32 v189, v154, v155
v_cvt_pk_bf16_f32 v190, v156, v157
v_cvt_pk_bf16_f32 v191, v158, v159
s_add_u32 s93, s88, 4096
buffer_store_dwordx4 v[176:179], v1, s[76:79], s93 offen offset:0 sc1
buffer_store_dwordx4 v[180:183], v1, s[76:79], s93 offen offset:1024 sc1
buffer_store_dwordx4 v[184:187], v1, s[76:79], s93 offen offset:2048 sc1
buffer_store_dwordx4 v[188:191], v1, s[76:79], s93 offen offset:3072 sc1
s_lshl_b32 s93, s29, 7
v_xor_b32 v31, s93, v3
v_add_u32 v19, s31, v31
v_xor_b32 v20, 64, v19
v_xor_b32 v21, 128, v19
v_xor_b32 v22, 192, v19
v_max3_f32 v27, v27, v80, v81
v_max3_f32 v27, v27, v82, v83
v_max3_f32 v27, v27, v84, v85
v_max3_f32 v27, v27, v86, v87
v_max3_f32 v27, v27, v88, v89
v_max3_f32 v27, v27, v90, v91
v_max3_f32 v27, v27, v92, v93
v_max3_f32 v27, v27, v94, v95
v_mov_b32 v31, v27
s_nop 1
v_permlane32_swap_b32 v27, v31
v_max_f32 v27, v27, v31
v_mul_f32 v28, s91, v27
v_sub_f32 v28, 0, v28
v_mov_b32 v29, 0
v_mov_b32 v30, 0
v_fma_f32 v32, v32, s91, v28
v_fma_f32 v33, v33, s91, v28
v_fma_f32 v34, v34, s91, v28
v_fma_f32 v35, v35, s91, v28
v_fma_f32 v36, v36, s91, v28
v_fma_f32 v37, v37, s91, v28
v_fma_f32 v38, v38, s91, v28
v_fma_f32 v39, v39, s91, v28
v_fma_f32 v40, v40, s91, v28
v_fma_f32 v41, v41, s91, v28
v_fma_f32 v42, v42, s91, v28
v_fma_f32 v43, v43, s91, v28
v_fma_f32 v44, v44, s91, v28
v_fma_f32 v45, v45, s91, v28
v_fma_f32 v46, v46, s91, v28
v_fma_f32 v47, v47, s91, v28
v_exp_f32 v32, v32
v_exp_f32 v33, v33
v_exp_f32 v34, v34
v_exp_f32 v35, v35
v_exp_f32 v36, v36
v_exp_f32 v37, v37
v_exp_f32 v38, v38
v_exp_f32 v39, v39
v_exp_f32 v40, v40
v_exp_f32 v41, v41
v_exp_f32 v42, v42
v_exp_f32 v43, v43
v_exp_f32 v44, v44
v_exp_f32 v45, v45
v_exp_f32 v46, v46
v_exp_f32 v47, v47
v_add_f32 v29, v29, v32
v_add_f32 v30, v30, v33
v_add_f32 v29, v29, v34
v_add_f32 v30, v30, v35
v_add_f32 v29, v29, v36
v_add_f32 v30, v30, v37
v_add_f32 v29, v29, v38
v_add_f32 v30, v30, v39
v_add_f32 v29, v29, v40
v_add_f32 v30, v30, v41
v_add_f32 v29, v29, v42
v_add_f32 v30, v30, v43
v_add_f32 v29, v29, v44
v_add_f32 v30, v30, v45
v_add_f32 v29, v29, v46
v_add_f32 v30, v30, v47
v_cvt_pk_bf16_f32 v32, v32, v33
v_cvt_pk_bf16_f32 v33, v34, v35
v_cvt_pk_bf16_f32 v34, v36, v37
v_cvt_pk_bf16_f32 v35, v38, v39
v_cvt_pk_bf16_f32 v36, v40, v41
v_cvt_pk_bf16_f32 v37, v42, v43
v_cvt_pk_bf16_f32 v38, v44, v45
v_cvt_pk_bf16_f32 v39, v46, v47
s_waitcnt vmcnt(16)
s_lshl_b32 s94, s26, 3
s_add_u32 s94, s94, s99
v_and_b32 v134, 0, v0
v_lshlrev_b32 v134, 3, v134
buffer_load_dwordx2 v[132:133], v134, s[76:79], s94 offen offset:128 sc1
ds_read_b64_tr_b16 v[224:225], v19 offset:0
ds_read_b64_tr_b16 v[226:227], v19 offset:2048
ds_read_b64_tr_b16 v[228:229], v19 offset:4096
ds_read_b64_tr_b16 v[230:231], v19 offset:6144
ds_read_b64_tr_b16 v[232:233], v20 offset:0
ds_read_b64_tr_b16 v[234:235], v20 offset:2048
ds_read_b64_tr_b16 v[236:237], v20 offset:4096
ds_read_b64_tr_b16 v[238:239], v20 offset:6144
ds_read_b64_tr_b16 v[240:241], v21 offset:0
ds_read_b64_tr_b16 v[242:243], v21 offset:2048
ds_read_b64_tr_b16 v[244:245], v21 offset:4096
ds_read_b64_tr_b16 v[246:247], v21 offset:6144
ds_read_b64_tr_b16 v[248:249], v22 offset:0
ds_read_b64_tr_b16 v[250:251], v22 offset:2048
ds_read_b64_tr_b16 v[252:253], v22 offset:4096
ds_read_b64_tr_b16 v[254:255], v22 offset:6144
v_fma_f32 v48, v48, s91, v28
v_fma_f32 v49, v49, s91, v28
v_fma_f32 v50, v50, s91, v28
v_fma_f32 v51, v51, s91, v28
v_fma_f32 v52, v52, s91, v28
v_fma_f32 v53, v53, s91, v28
v_fma_f32 v54, v54, s91, v28
v_fma_f32 v55, v55, s91, v28
v_fma_f32 v56, v56, s91, v28
v_fma_f32 v57, v57, s91, v28
v_fma_f32 v58, v58, s91, v28
v_fma_f32 v59, v59, s91, v28
v_fma_f32 v60, v60, s91, v28
v_fma_f32 v61, v61, s91, v28
v_fma_f32 v62, v62, s91, v28
v_fma_f32 v63, v63, s91, v28
s_waitcnt lgkmcnt(0)
s_add_u32 s95, s3, 2
s_and_b32 s95, s95, 3
s_lshl_b32 s95, s95, 14
s_add_u32 s95, s95, s96
s_add_u32 s95, s95, 4194304
s_add_u32 m0, s31, 0
s_nop 0
buffer_load_dwordx4 v10, s[64:67], s95 offen offset:0 nt lds
v_mfma_f32_32x32x16_bf16 v[160:175], v[224:227], v[32:35], 0
v_exp_f32 v48, v48
v_exp_f32 v49, v49
v_exp_f32 v50, v50
v_exp_f32 v51, v51
v_exp_f32 v52, v52
buffer_load_dwordx4 v10, s[64:67], s95 offen offset:1024 nt lds
v_mfma_f32_32x32x16_bf16 v[176:191], v[232:235], v[32:35], 0
v_exp_f32 v53, v53
v_exp_f32 v54, v54
v_exp_f32 v55, v55
v_exp_f32 v56, v56
v_exp_f32 v57, v57
buffer_load_dwordx4 v10, s[64:67], s95 offen offset:2048 nt lds
v_mfma_f32_32x32x16_bf16 v[192:207], v[240:243], v[32:35], 0
v_exp_f32 v58, v58
v_exp_f32 v59, v59
v_exp_f32 v60, v60
v_exp_f32 v61, v61
v_exp_f32 v62, v62
buffer_load_dwordx4 v10, s[64:67], s95 offen offset:3072 nt lds
v_mfma_f32_32x32x16_bf16 v[208:223], v[248:251], v[32:35], 0
v_exp_f32 v63, v63
v_add_f32 v29, v29, v48
v_add_f32 v30, v30, v49
v_add_f32 v29, v29, v50
v_add_f32 v30, v30, v51
s_add_u32 s95, s95, 4096
s_add_u32 m0, s31, 4096
s_nop 0
buffer_load_dwordx4 v10, s[64:67], s95 offen offset:0 nt lds
v_mfma_f32_32x32x16_bf16 v[160:175], v[228:231], v[36:39], v[160:175]
v_add_f32 v29, v29, v52
v_add_f32 v30, v30, v53
v_add_f32 v29, v29, v54
v_add_f32 v30, v30, v55
v_add_f32 v29, v29, v56
buffer_load_dwordx4 v10, s[64:67], s95 offen offset:1024 nt lds
v_mfma_f32_32x32x16_bf16 v[176:191], v[236:239], v[36:39], v[176:191]
v_add_f32 v30, v30, v57
v_add_f32 v29, v29, v58
v_add_f32 v30, v30, v59
v_add_f32 v29, v29, v60
v_add_f32 v30, v30, v61
buffer_load_dwordx4 v10, s[64:67], s95 offen offset:2048 nt lds
v_mfma_f32_32x32x16_bf16 v[192:207], v[244:247], v[36:39], v[192:207]
v_add_f32 v29, v29, v62
v_add_f32 v30, v30, v63
v_cvt_pk_bf16_f32 v48, v48, v49
v_cvt_pk_bf16_f32 v49, v50, v51
v_cvt_pk_bf16_f32 v50, v52, v53
buffer_load_dwordx4 v10, s[64:67], s95 offen offset:3072 nt lds
v_mfma_f32_32x32x16_bf16 v[208:223], v[252:255], v[36:39], v[208:223]
v_cvt_pk_bf16_f32 v51, v54, v55
v_cvt_pk_bf16_f32 v52, v56, v57
v_cvt_pk_bf16_f32 v53, v58, v59
v_cvt_pk_bf16_f32 v54, v60, v61
v_cvt_pk_bf16_f32 v55, v62, v63
s_waitcnt vmcnt(17)
ds_read_b64_tr_b16 v[224:225], v19 offset:8192
ds_read_b64_tr_b16 v[226:227], v19 offset:10240
ds_read_b64_tr_b16 v[228:229], v19 offset:12288
ds_read_b64_tr_b16 v[230:231], v19 offset:14336
ds_read_b64_tr_b16 v[232:233], v20 offset:8192
ds_read_b64_tr_b16 v[234:235], v20 offset:10240
ds_read_b64_tr_b16 v[236:237], v20 offset:12288
ds_read_b64_tr_b16 v[238:239], v20 offset:14336
ds_read_b64_tr_b16 v[240:241], v21 offset:8192
ds_read_b64_tr_b16 v[242:243], v21 offset:10240
ds_read_b64_tr_b16 v[244:245], v21 offset:12288
ds_read_b64_tr_b16 v[246:247], v21 offset:14336
ds_read_b64_tr_b16 v[248:249], v22 offset:8192
ds_read_b64_tr_b16 v[250:251], v22 offset:10240
ds_read_b64_tr_b16 v[252:253], v22 offset:12288
ds_read_b64_tr_b16 v[254:255], v22 offset:14336
v_fma_f32 v64, v64, s91, v28
v_fma_f32 v65, v65, s91, v28
v_fma_f32 v66, v66, s91, v28
v_fma_f32 v67, v67, s91, v28
v_fma_f32 v68, v68, s91, v28
v_fma_f32 v69, v69, s91, v28
v_fma_f32 v70, v70, s91, v28
v_fma_f32 v71, v71, s91, v28
v_fma_f32 v72, v72, s91, v28
v_fma_f32 v73, v73, s91, v28
v_fma_f32 v74, v74, s91, v28
v_fma_f32 v75, v75, s91, v28
v_fma_f32 v76, v76, s91, v28
v_fma_f32 v77, v77, s91, v28
v_fma_f32 v78, v78, s91, v28
v_fma_f32 v79, v79, s91, v28
s_waitcnt lgkmcnt(0)
s_add_u32 s95, s3, 3
s_and_b32 s95, s95, 3
s_lshl_b32 s95, s95, 14
s_add_u32 s95, s95, s96
s_add_u32 s95, s95, 4194304
s_add_u32 m0, s31, 8192
s_nop 0
buffer_load_dwordx4 v10, s[64:67], s95 offen offset:0 nt lds
v_mfma_f32_32x32x16_bf16 v[160:175], v[224:227], v[48:51], v[160:175]
v_exp_f32 v64, v64
v_exp_f32 v65, v65
v_exp_f32 v66, v66
v_exp_f32 v67, v67
v_exp_f32 v68, v68
buffer_load_dwordx4 v10, s[64:67], s95 offen offset:1024 nt lds
v_mfma_f32_32x32x16_bf16 v[176:191], v[232:235], v[48:51], v[176:191]
v_exp_f32 v69, v69
v_exp_f32 v70, v70
v_exp_f32 v71, v71
v_exp_f32 v72, v72
v_exp_f32 v73, v73
buffer_load_dwordx4 v10, s[64:67], s95 offen offset:2048 nt lds
v_mfma_f32_32x32x16_bf16 v[192:207], v[240:243], v[48:51], v[192:207]
v_exp_f32 v74, v74
v_exp_f32 v75, v75
v_exp_f32 v76, v76
v_exp_f32 v77, v77
v_exp_f32 v78, v78
buffer_load_dwordx4 v10, s[64:67], s95 offen offset:3072 nt lds
v_mfma_f32_32x32x16_bf16 v[208:223], v[248:251], v[48:51], v[208:223]
v_exp_f32 v79, v79
v_add_f32 v29, v29, v64
v_add_f32 v30, v30, v65
v_add_f32 v29, v29, v66
v_add_f32 v30, v30, v67
s_add_u32 s95, s95, 4096
s_add_u32 m0, s31, 12288
s_nop 0
buffer_load_dwordx4 v10, s[64:67], s95 offen offset:0 nt lds
v_mfma_f32_32x32x16_bf16 v[160:175], v[228:231], v[52:55], v[160:175]
v_add_f32 v29, v29, v68
v_add_f32 v30, v30, v69
v_add_f32 v29, v29, v70
v_add_f32 v30, v30, v71
v_add_f32 v29, v29, v72
buffer_load_dwordx4 v10, s[64:67], s95 offen offset:1024 nt lds
v_mfma_f32_32x32x16_bf16 v[176:191], v[236:239], v[52:55], v[176:191]
v_add_f32 v30, v30, v73
v_add_f32 v29, v29, v74
v_add_f32 v30, v30, v75
v_add_f32 v29, v29, v76
v_add_f32 v30, v30, v77
buffer_load_dwordx4 v10, s[64:67], s95 offen offset:2048 nt lds
v_mfma_f32_32x32x16_bf16 v[192:207], v[244:247], v[52:55], v[192:207]
v_add_f32 v29, v29, v78
v_add_f32 v30, v30, v79
v_cvt_pk_bf16_f32 v64, v64, v65
v_cvt_pk_bf16_f32 v65, v66, v67
v_cvt_pk_bf16_f32 v66, v68, v69
buffer_load_dwordx4 v10, s[64:67], s95 offen offset:3072 nt lds
v_mfma_f32_32x32x16_bf16 v[208:223], v[252:255], v[52:55], v[208:223]
v_cvt_pk_bf16_f32 v67, v70, v71
v_cvt_pk_bf16_f32 v68, v72, v73
v_cvt_pk_bf16_f32 v69, v74, v75
v_cvt_pk_bf16_f32 v70, v76, v77
v_cvt_pk_bf16_f32 v71, v78, v79
s_waitcnt vmcnt(8)
v_mov_b32 v224, s100
v_mov_b32 v225, s101
s_lshl_b32 s92, s83, 3
v_mov_b32 v226, s92
s_mov_b64 exec, 1
buffer_store_dwordx2 v[224:225], v226, s[76:79], s24 offen offset:0 sc1
s_mov_b64 exec, -1
s_mov_b32 s93, 0
L_pollBo1:
v_cmp_ne_u64 vcc, s[100:101], v[132:133]
s_nop 1
s_cmp_eq_u64 vcc, 0
s_cbranch_scc1 L_polledBo1
s_add_u32 s93, s93, 1
s_cmp_ge_u32 s93, 400000
s_cbranch_scc1 L_polledBo1
s_sleep 4
buffer_load_dwordx2 v[132:133], v134, s[76:79], s94 offen offset:128 sc1
s_waitcnt vmcnt(0)
s_branch L_pollBo1
L_polledBo1:
s_lshl_b32 s92, s97, 16
s_lshl_b32 s93, s26, 14
s_add_u32 s92, s92, s93
s_add_u32 s92, s92, 20971520
buffer_load_dwordx4 v[96:99], v1, s[76:79], s92 offen offset:0 sc1
buffer_load_dwordx4 v[100:103], v1, s[76:79], s92 offen offset:1024 sc1
buffer_load_dwordx4 v[104:107], v1, s[76:79], s92 offen offset:2048 sc1
buffer_load_dwordx4 v[108:111], v1, s[76:79], s92 offen offset:3072 sc1
s_add_u32 s92, s92, 4096
buffer_load_dwordx4 v[128:131], v1, s[76:79], s92 offen sc1
ds_read_b64_tr_b16 v[224:225], v19 offset:0
ds_read_b64_tr_b16 v[226:227], v19 offset:2048
ds_read_b64_tr_b16 v[228:229], v19 offset:4096
ds_read_b64_tr_b16 v[230:231], v19 offset:6144
ds_read_b64_tr_b16 v[232:233], v20 offset:0
ds_read_b64_tr_b16 v[234:235], v20 offset:2048
ds_read_b64_tr_b16 v[236:237], v20 offset:4096
ds_read_b64_tr_b16 v[238:239], v20 offset:6144
ds_read_b64_tr_b16 v[240:241], v21 offset:0
ds_read_b64_tr_b16 v[242:243], v21 offset:2048
ds_read_b64_tr_b16 v[244:245], v21 offset:4096
ds_read_b64_tr_b16 v[246:247], v21 offset:6144
ds_read_b64_tr_b16 v[248:249], v22 offset:0
ds_read_b64_tr_b16 v[250:251], v22 offset:2048
ds_read_b64_tr_b16 v[252:253], v22 offset:4096
ds_read_b64_tr_b16 v[254:255], v22 offset:6144
v_fma_f32 v80, v80, s91, v28
v_fma_f32 v81, v81, s91, v28
v_fma_f32 v82, v82, s91, v28
v_fma_f32 v83, v83, s91, v28
v_fma_f32 v84, v84, s91, v28
v_fma_f32 v85, v85, s91, v28
v_fma_f32 v86, v86, s91, v28
v_fma_f32 v87, v87, s91, v28
v_fma_f32 v88, v88, s91, v28
v_fma_f32 v89, v89, s91, v28
v_fma_f32 v90, v90, s91, v28
v_fma_f32 v91, v91, s91, v28
v_fma_f32 v92, v92, s91, v28
v_fma_f32 v93, v93, s91, v28
v_fma_f32 v94, v94, s91, v28
v_fma_f32 v95, v95, s91, v28
s_waitcnt lgkmcnt(0)
v_mfma_f32_32x32x16_bf16 v[160:175], v[224:227], v[64:67], v[160:175]
v_exp_f32 v80, v80
v_exp_f32 v81, v81
v_exp_f32 v82, v82
v_exp_f32 v83, v83
v_exp_f32 v84, v84
v_mfma_f32_32x32x16_bf16 v[176:191], v[232:235], v[64:67], v[176:191]
v_exp_f32 v85, v85
v_exp_f32 v86, v86
v_exp_f32 v87, v87
v_exp_f32 v88, v88
v_exp_f32 v89, v89
v_mfma_f32_32x32x16_bf16 v[192:207], v[240:243], v[64:67], v[192:207]
v_exp_f32 v90, v90
v_exp_f32 v91, v91
v_exp_f32 v92, v92
v_exp_f32 v93, v93
v_exp_f32 v94, v94
v_mfma_f32_32x32x16_bf16 v[208:223], v[248:251], v[64:67], v[208:223]
v_exp_f32 v95, v95
v_add_f32 v29, v29, v80
v_add_f32 v30, v30, v81
v_add_f32 v29, v29, v82
v_add_f32 v30, v30, v83
v_mfma_f32_32x32x16_bf16 v[160:175], v[228:231], v[68:71], v[160:175]
v_add_f32 v29, v29, v84
v_add_f32 v30, v30, v85
v_add_f32 v29, v29, v86
v_add_f32 v30, v30, v87
v_add_f32 v29, v29, v88
v_mfma_f32_32x32x16_bf16 v[176:191], v[236:239], v[68:71], v[176:191]
v_add_f32 v30, v30, v89
v_add_f32 v29, v29, v90
v_add_f32 v30, v30, v91
v_add_f32 v29, v29, v92
v_add_f32 v30, v30, v93
v_mfma_f32_32x32x16_bf16 v[192:207], v[244:247], v[68:71], v[192:207]
v_add_f32 v29, v29, v94
v_add_f32 v30, v30, v95
v_cvt_pk_bf16_f32 v80, v80, v81
v_cvt_pk_bf16_f32 v81, v82, v83
v_cvt_pk_bf16_f32 v82, v84, v85
v_mfma_f32_32x32x16_bf16 v[208:223], v[252:255], v[68:71], v[208:223]
v_cvt_pk_bf16_f32 v83, v86, v87
v_cvt_pk_bf16_f32 v84, v88, v89
v_cvt_pk_bf16_f32 v85, v90, v91
v_cvt_pk_bf16_f32 v86, v92, v93
v_cvt_pk_bf16_f32 v87, v94, v95
s_waitcnt vmcnt(6)
ds_read_b64_tr_b16 v[224:225], v19 offset:8192
ds_read_b64_tr_b16 v[226:227], v19 offset:10240
ds_read_b64_tr_b16 v[228:229], v19 offset:12288
ds_read_b64_tr_b16 v[230:231], v19 offset:14336
ds_read_b64_tr_b16 v[232:233], v20 offset:8192
ds_read_b64_tr_b16 v[234:235], v20 offset:10240
ds_read_b64_tr_b16 v[236:237], v20 offset:12288
ds_read_b64_tr_b16 v[238:239], v20 offset:14336
ds_read_b64_tr_b16 v[240:241], v21 offset:8192
ds_read_b64_tr_b16 v[242:243], v21 offset:10240
ds_read_b64_tr_b16 v[244:245], v21 offset:12288
ds_read_b64_tr_b16 v[246:247], v21 offset:14336
ds_read_b64_tr_b16 v[248:249], v22 offset:8192
ds_read_b64_tr_b16 v[250:251], v22 offset:10240
ds_read_b64_tr_b16 v[252:253], v22 offset:12288
ds_read_b64_tr_b16 v[254:255], v22 offset:14336
s_waitcnt lgkmcnt(0)
v_mfma_f32_32x32x16_bf16 v[160:175], v[224:227], v[80:83], v[160:175]
v_mfma_f32_32x32x16_bf16 v[176:191], v[232:235], v[80:83], v[176:191]
v_mfma_f32_32x32x16_bf16 v[192:207], v[240:243], v[80:83], v[192:207]
v_mfma_f32_32x32x16_bf16 v[208:223], v[248:251], v[80:83], v[208:223]
v_mfma_f32_32x32x16_bf16 v[160:175], v[228:231], v[84:87], v[160:175]
v_mfma_f32_32x32x16_bf16 v[176:191], v[236:239], v[84:87], v[176:191]
v_mfma_f32_32x32x16_bf16 v[192:207], v[244:247], v[84:87], v[192:207]
v_mfma_f32_32x32x16_bf16 v[208:223], v[252:255], v[84:87], v[208:223]
s_barrier
v_add_f32 v29, v29, v30
v_mov_b32 v31, v29
s_nop 1
v_permlane32_swap_b32 v29, v31
v_add_f32 v29, v29, v31
v_mov_b32 v224, v27
v_mov_b32 v225, v29
v_add_u32 v19, s86, v1
v_add_u32 v20, s87, v1
v_lshlrev_b32 v31, 3, v0
s_lshl_b32 s93, s26, 9
s_add_u32 s93, s93, 147456
s_xor_b32 s92, s93, 0x400
v_add_u32 v21, s93, v31
v_add_u32 v22, s92, v31
ds_write_b64 v21, v[224:225]
ds_write_b128 v19, v[192:195] offset:0
ds_write_b128 v19, v[196:199] offset:1024
ds_write_b128 v19, v[200:203] offset:2048
ds_write_b128 v19, v[204:207] offset:3072
ds_write_b128 v19, v[208:211] offset:4096
ds_write_b128 v19, v[212:215] offset:5120
ds_write_b128 v19, v[216:219] offset:6144
ds_write_b128 v19, v[220:223] offset:7168
s_waitcnt lgkmcnt(0)
s_barrier
ds_read_b64 v[226:227], v22
ds_read_b128 v[32:35], v20 offset:0
ds_read_b128 v[36:39], v20 offset:1024
ds_read_b128 v[40:43], v20 offset:2048
ds_read_b128 v[44:47], v20 offset:3072
ds_read_b128 v[48:51], v20 offset:4096
ds_read_b128 v[52:55], v20 offset:5120
ds_read_b128 v[56:59], v20 offset:6144
ds_read_b128 v[60:63], v20 offset:7168
s_waitcnt lgkmcnt(8)
s_waitcnt vmcnt(0)
v_max3_f32 v228, v224, v226, v128
v_sub_f32 v231, v128, v228
v_mul_f32 v231, s91, v231
v_exp_f32 v231, v231
v_sub_f32 v229, v224, v228
v_sub_f32 v230, v226, v228
v_mul_f32 v229, s91, v229
v_mul_f32 v230, s91, v230
v_exp_f32 v229, v229
v_exp_f32 v230, v230
v_mul_f32 v232, v225, v229
v_fma_f32 v232, v227, v230, v232
v_mul_f32 v231, v129, v231
v_add_f32 v232, v232, v231
v_rcp_f32 v232, v232
s_nop 0
v_mul_f32 v229, v229, v232
v_mul_f32 v230, v230, v232
v_mul_f32 v231, v231, v232
v_mul_f32 v160, v160, v229
v_mul_f32 v161, v161, v229
v_mul_f32 v162, v162, v229
v_mul_f32 v163, v163, v229
v_mul_f32 v164, v164, v229
v_mul_f32 v165, v165, v229
v_mul_f32 v166, v166, v229
v_mul_f32 v167, v167, v229
v_mul_f32 v168, v168, v229
v_mul_f32 v169, v169, v229
v_mul_f32 v170, v170, v229
v_mul_f32 v171, v171, v229
v_mul_f32 v172, v172, v229
v_mul_f32 v173, v173, v229
v_mul_f32 v174, v174, v229
v_mul_f32 v175, v175, v229
v_mul_f32 v176, v176, v229
v_mul_f32 v177, v177, v229
v_mul_f32 v178, v178, v229
v_mul_f32 v179, v179, v229
v_mul_f32 v180, v180, v229
v_mul_f32 v181, v181, v229
v_mul_f32 v182, v182, v229
v_mul_f32 v183, v183, v229
v_mul_f32 v184, v184, v229
v_mul_f32 v185, v185, v229
v_mul_f32 v186, v186, v229
v_mul_f32 v187, v187, v229
v_mul_f32 v188, v188, v229
v_mul_f32 v189, v189, v229
v_mul_f32 v190, v190, v229
v_mul_f32 v191, v191, v229
v_lshlrev_b32 v112, 16, v96
v_and_b32 v113, 0xffff0000, v96
v_fma_f32 v160, v112, v231, v160
v_fma_f32 v161, v113, v231, v161
v_lshlrev_b32 v112, 16, v97
v_and_b32 v113, 0xffff0000, v97
v_fma_f32 v162, v112, v231, v162
v_fma_f32 v163, v113, v231, v163
v_lshlrev_b32 v112, 16, v98
v_and_b32 v113, 0xffff0000, v98
v_fma_f32 v164, v112, v231, v164
v_fma_f32 v165, v113, v231, v165
v_lshlrev_b32 v112, 16, v99
v_and_b32 v113, 0xffff0000, v99
v_fma_f32 v166, v112, v231, v166
v_fma_f32 v167, v113, v231, v167
v_lshlrev_b32 v112, 16, v100
v_and_b32 v113, 0xffff0000, v100
v_fma_f32 v168, v112, v231, v168
v_fma_f32 v169, v113, v231, v169
v_lshlrev_b32 v112, 16, v101
v_and_b32 v113, 0xffff0000, v101
v_fma_f32 v170, v112, v231, v170
v_fma_f32 v171, v113, v231, v171
v_lshlrev_b32 v112, 16, v102
v_and_b32 v113, 0xffff0000, v102
v_fma_f32 v172, v112, v231, v172
v_fma_f32 v173, v113, v231, v173
v_lshlrev_b32 v112, 16, v103
v_and_b32 v113, 0xffff0000, v103
v_fma_f32 v174, v112, v231, v174
v_fma_f32 v175, v113, v231, v175
v_lshlrev_b32 v112, 16, v104
v_and_b32 v113, 0xffff0000, v104
v_fma_f32 v176, v112, v231, v176
v_fma_f32 v177, v113, v231, v177
v_lshlrev_b32 v112, 16, v105
v_and_b32 v113, 0xffff0000, v105
v_fma_f32 v178, v112, v231, v178
v_fma_f32 v179, v113, v231, v179
v_lshlrev_b32 v112, 16, v106
v_and_b32 v113, 0xffff0000, v106
v_fma_f32 v180, v112, v231, v180
v_fma_f32 v181, v113, v231, v181
v_lshlrev_b32 v112, 16, v107
v_and_b32 v113, 0xffff0000, v107
v_fma_f32 v182, v112, v231, v182
v_fma_f32 v183, v113, v231, v183
v_lshlrev_b32 v112, 16, v108
v_and_b32 v113, 0xffff0000, v108
v_fma_f32 v184, v112, v231, v184
v_fma_f32 v185, v113, v231, v185
v_lshlrev_b32 v112, 16, v109
v_and_b32 v113, 0xffff0000, v109
v_fma_f32 v186, v112, v231, v186
v_fma_f32 v187, v113, v231, v187
v_lshlrev_b32 v112, 16, v110
v_and_b32 v113, 0xffff0000, v110
v_fma_f32 v188, v112, v231, v188
v_fma_f32 v189, v113, v231, v189
v_lshlrev_b32 v112, 16, v111
v_and_b32 v113, 0xffff0000, v111
v_fma_f32 v190, v112, v231, v190
v_fma_f32 v191, v113, v231, v191
s_waitcnt lgkmcnt(0)
v_fma_f32 v160, v32, v230, v160
v_fma_f32 v161, v33, v230, v161
v_fma_f32 v162, v34, v230, v162
v_fma_f32 v163, v35, v230, v163
v_fma_f32 v164, v36, v230, v164
v_fma_f32 v165, v37, v230, v165
v_fma_f32 v166, v38, v230, v166
v_fma_f32 v167, v39, v230, v167
v_fma_f32 v168, v40, v230, v168
v_fma_f32 v169, v41, v230, v169
v_fma_f32 v170, v42, v230, v170
v_fma_f32 v171, v43, v230, v171
v_fma_f32 v172, v44, v230, v172
v_fma_f32 v173, v45, v230, v173
v_fma_f32 v174, v46, v230, v174
v_fma_f32 v175, v47, v230, v175
v_fma_f32 v176, v48, v230, v176
v_fma_f32 v177, v49, v230, v177
v_fma_f32 v178, v50, v230, v178
v_fma_f32 v179, v51, v230, v179
v_fma_f32 v180, v52, v230, v180
v_fma_f32 v181, v53, v230, v181
v_fma_f32 v182, v54, v230, v182
v_fma_f32 v183, v55, v230, v183
v_fma_f32 v184, v56, v230, v184
v_fma_f32 v185, v57, v230, v185
v_fma_f32 v186, v58, v230, v186
v_fma_f32 v187, v59, v230, v187
v_fma_f32 v188, v60, v230, v188
v_fma_f32 v189, v61, v230, v189
v_fma_f32 v190, v62, v230, v190
v_fma_f32 v191, v63, v230, v191
v_cvt_pk_bf16_f32 v64, v160, v161
v_cvt_pk_bf16_f32 v65, v162, v163
v_cvt_pk_bf16_f32 v66, v164, v165
v_cvt_pk_bf16_f32 v67, v166, v167
v_cvt_pk_bf16_f32 v68, v168, v169
v_cvt_pk_bf16_f32 v69, v170, v171
v_cvt_pk_bf16_f32 v70, v172, v173
v_cvt_pk_bf16_f32 v71, v174, v175
v_cvt_pk_bf16_f32 v72, v176, v177
v_cvt_pk_bf16_f32 v73, v178, v179
v_cvt_pk_bf16_f32 v74, v180, v181
v_cvt_pk_bf16_f32 v75, v182, v183
v_cvt_pk_bf16_f32 v76, v184, v185
v_cvt_pk_bf16_f32 v77, v186, v187
v_cvt_pk_bf16_f32 v78, v188, v189
v_cvt_pk_bf16_f32 v79, v190, v191
ds_write_b128 v20, v[64:67] offset:0
ds_write_b128 v20, v[68:71] offset:1024
ds_write_b128 v20, v[72:75] offset:2048
ds_write_b128 v20, v[76:79] offset:3072
s_waitcnt lgkmcnt(0)
s_barrier
v_and_b32 v130, 15, v0
v_lshlrev_b32 v130, 3, v130
buffer_load_dwordx2 v[128:129], v130, s[76:79], s24 offen offset:0 sc1
v_add_u32 v31, 114688, v1
ds_read_b128 v[32:35], v31 offset:16384
ds_read_b128 v[36:39], v31 offset:17408
ds_read_b128 v[40:43], v31 offset:18432
ds_read_b128 v[44:47], v31 offset:19456
ds_read_b128 v[48:51], v31 offset:0
ds_read_b128 v[52:55], v31 offset:1024
ds_read_b128 v[56:59], v31 offset:2048
ds_read_b128 v[60:63], v31 offset:3072
ds_read_b128 v[64:67], v31 offset:24576
ds_read_b128 v[68:71], v31 offset:25600
ds_read_b128 v[72:75], v31 offset:26624
ds_read_b128 v[76:79], v31 offset:27648
ds_read_b128 v[80:83], v31 offset:8192
ds_read_b128 v[84:87], v31 offset:9216
ds_read_b128 v[88:91], v31 offset:10240
ds_read_b128 v[92:95], v31 offset:11264
s_waitcnt lgkmcnt(15)
v_mfma_f32_32x32x16_bf16 v[160:175], a[0:3], v[32:35], 0
v_mfma_f32_32x32x16_bf16 v[176:191], a[4:7], v[32:35], 0
v_mfma_f32_32x32x16_bf16 v[192:207], a[8:11], v[32:35], 0
v_mfma_f32_32x32x16_bf16 v[208:223], a[12:15], v[32:35], 0
s_waitcnt lgkmcnt(14)
v_mfma_f32_32x32x16_bf16 v[160:175], a[16:19], v[36:39], v[160:175]
v_mfma_f32_32x32x16_bf16 v[176:191], a[20:23], v[36:39], v[176:191]
v_mfma_f32_32x32x16_bf16 v[192:207], a[24:27], v[36:39], v[192:207]
v_mfma_f32_32x32x16_bf16 v[208:223], a[28:31], v[36:39], v[208:223]
s_waitcnt lgkmcnt(13)
v_mfma_f32_32x32x16_bf16 v[160:175], a[32:35], v[40:43], v[160:175]
v_mfma_f32_32x32x16_bf16 v[176:191], a[36:39], v[40:43], v[176:191]
v_mfma_f32_32x32x16_bf16 v[192:207], a[40:43], v[40:43], v[192:207]
v_mfma_f32_32x32x16_bf16 v[208:223], a[44:47], v[40:43], v[208:223]
s_waitcnt lgkmcnt(12)
v_mfma_f32_32x32x16_bf16 v[160:175], a[48:51], v[44:47], v[160:175]
v_mfma_f32_32x32x16_bf16 v[176:191], a[52:55], v[44:47], v[176:191]
v_mfma_f32_32x32x16_bf16 v[192:207], a[56:59], v[44:47], v[192:207]
v_mfma_f32_32x32x16_bf16 v[208:223], a[60:63], v[44:47], v[208:223]
s_waitcnt lgkmcnt(11)
v_mfma_f32_32x32x16_bf16 v[160:175], a[64:67], v[48:51], v[160:175]
v_mfma_f32_32x32x16_bf16 v[176:191], a[68:71], v[48:51], v[176:191]
v_mfma_f32_32x32x16_bf16 v[192:207], a[72:75], v[48:51], v[192:207]
v_mfma_f32_32x32x16_bf16 v[208:223], a[76:79], v[48:51], v[208:223]
s_waitcnt lgkmcnt(10)
v_mfma_f32_32x32x16_bf16 v[160:175], a[80:83], v[52:55], v[160:175]
v_mfma_f32_32x32x16_bf16 v[176:191], a[84:87], v[52:55], v[176:191]
v_mfma_f32_32x32x16_bf16 v[192:207], a[88:91], v[52:55], v[192:207]
v_mfma_f32_32x32x16_bf16 v[208:223], a[92:95], v[52:55], v[208:223]
s_waitcnt lgkmcnt(9)
v_mfma_f32_32x32x16_bf16 v[160:175], a[96:99], v[56:59], v[160:175]
v_mfma_f32_32x32x16_bf16 v[176:191], a[100:103], v[56:59], v[176:191]
v_mfma_f32_32x32x16_bf16 v[192:207], a[104:107], v[56:59], v[192:207]
v_mfma_f32_32x32x16_bf16 v[208:223], a[108:111], v[56:59], v[208:223]
s_waitcnt lgkmcnt(8)
v_mfma_f32_32x32x16_bf16 v[160:175], a[112:115], v[60:63], v[160:175]
v_mfma_f32_32x32x16_bf16 v[176:191], a[116:119], v[60:63], v[176:191]
v_mfma_f32_32x32x16_bf16 v[192:207], a[120:123], v[60:63], v[192:207]
v_mfma_f32_32x32x16_bf16 v[208:223], a[124:127], v[60:63], v[208:223]
s_waitcnt lgkmcnt(7)
v_mfma_f32_32x32x16_bf16 v[160:175], a[128:131], v[64:67], v[160:175]
v_mfma_f32_32x32x16_bf16 v[176:191], a[132:135], v[64:67], v[176:191]
v_mfma_f32_32x32x16_bf16 v[192:207], a[136:139], v[64:67], v[192:207]
v_mfma_f32_32x32x16_bf16 v[208:223], a[140:143], v[64:67], v[208:223]
s_waitcnt lgkmcnt(6)
v_mfma_f32_32x32x16_bf16 v[160:175], a[144:147], v[68:71], v[160:175]
v_mfma_f32_32x32x16_bf16 v[176:191], a[148:151], v[68:71], v[176:191]
v_mfma_f32_32x32x16_bf16 v[192:207], a[152:155], v[68:71], v[192:207]
v_mfma_f32_32x32x16_bf16 v[208:223], a[156:159], v[68:71], v[208:223]
s_waitcnt lgkmcnt(5)
v_mfma_f32_32x32x16_bf16 v[160:175], a[160:163], v[72:75], v[160:175]
v_mfma_f32_32x32x16_bf16 v[176:191], a[164:167], v[72:75], v[176:191]
v_mfma_f32_32x32x16_bf16 v[192:207], a[168:171], v[72:75], v[192:207]
v_mfma_f32_32x32x16_bf16 v[208:223], a[172:175], v[72:75], v[208:223]
s_waitcnt lgkmcnt(4)
v_mfma_f32_32x32x16_bf16 v[160:175], a[176:179], v[76:79], v[160:175]
v_mfma_f32_32x32x16_bf16 v[176:191], a[180:183], v[76:79], v[176:191]
v_mfma_f32_32x32x16_bf16 v[192:207], a[184:187], v[76:79], v[192:207]
v_mfma_f32_32x32x16_bf16 v[208:223], a[188:191], v[76:79], v[208:223]
s_waitcnt lgkmcnt(3)
v_mfma_f32_32x32x16_bf16 v[160:175], a[192:195], v[80:83], v[160:175]
v_mfma_f32_32x32x16_bf16 v[176:191], a[196:199], v[80:83], v[176:191]
v_mfma_f32_32x32x16_bf16 v[192:207], a[200:203], v[80:83], v[192:207]
v_mfma_f32_32x32x16_bf16 v[208:223], a[204:207], v[80:83], v[208:223]
s_waitcnt lgkmcnt(2)
v_mfma_f32_32x32x16_bf16 v[160:175], a[208:211], v[84:87], v[160:175]
v_mfma_f32_32x32x16_bf16 v[176:191], a[212:215], v[84:87], v[176:191]
v_mfma_f32_32x32x16_bf16 v[192:207], a[216:219], v[84:87], v[192:207]
v_mfma_f32_32x32x16_bf16 v[208:223], a[220:223], v[84:87], v[208:223]
s_waitcnt lgkmcnt(1)
v_mfma_f32_32x32x16_bf16 v[160:175], a[224:227], v[88:91], v[160:175]
v_mfma_f32_32x32x16_bf16 v[176:191], a[228:231], v[88:91], v[176:191]
v_mfma_f32_32x32x16_bf16 v[192:207], a[232:235], v[88:91], v[192:207]
v_mfma_f32_32x32x16_bf16 v[208:223], a[236:239], v[88:91], v[208:223]
s_waitcnt lgkmcnt(0)
v_mfma_f32_32x32x16_bf16 v[160:175], a[240:243], v[92:95], v[160:175]
v_mfma_f32_32x32x16_bf16 v[176:191], a[244:247], v[92:95], v[176:191]
v_mfma_f32_32x32x16_bf16 v[192:207], a[248:251], v[92:95], v[192:207]
v_mfma_f32_32x32x16_bf16 v[208:223], a[252:255], v[92:95], v[208:223]
s_nop 8
v_cvt_pk_bf16_f32 v96, v160, v161
v_cvt_pk_bf16_f32 v97, v162, v163
v_cvt_pk_bf16_f32 v98, v164, v165
v_cvt_pk_bf16_f32 v99, v166, v167
v_cvt_pk_bf16_f32 v100, v168, v169
v_cvt_pk_bf16_f32 v101, v170, v171
v_cvt_pk_bf16_f32 v102, v172, v173
v_cvt_pk_bf16_f32 v103, v174, v175
v_cvt_pk_bf16_f32 v104, v176, v177
v_cvt_pk_bf16_f32 v105, v178, v179
v_cvt_pk_bf16_f32 v106, v180, v181
v_cvt_pk_bf16_f32 v107, v182, v183
v_cvt_pk_bf16_f32 v108, v184, v185
v_cvt_pk_bf16_f32 v109, v186, v187
v_cvt_pk_bf16_f32 v110, v188, v189
v_cvt_pk_bf16_f32 v111, v190, v191
s_add_u32 s93, s88, 1048576
buffer_store_dwordx4 v[96:99], v1, s[76:79], s93 offen offset:0 sc1
buffer_store_dwordx4 v[100:103], v1, s[76:79], s93 offen offset:1024 sc1
buffer_store_dwordx4 v[104:107], v1, s[76:79], s93 offen offset:2048 sc1
buffer_store_dwordx4 v[108:111], v1, s[76:79], s93 offen offset:3072 sc1
v_cvt_pk_bf16_f32 v112, v192, v193
v_cvt_pk_bf16_f32 v113, v194, v195
v_cvt_pk_bf16_f32 v114, v196, v197
v_cvt_pk_bf16_f32 v115, v198, v199
v_cvt_pk_bf16_f32 v116, v200, v201
v_cvt_pk_bf16_f32 v117, v202, v203
v_cvt_pk_bf16_f32 v118, v204, v205
v_cvt_pk_bf16_f32 v119, v206, v207
v_cvt_pk_bf16_f32 v120, v208, v209
v_cvt_pk_bf16_f32 v121, v210, v211
v_cvt_pk_bf16_f32 v122, v212, v213
v_cvt_pk_bf16_f32 v123, v214, v215
v_cvt_pk_bf16_f32 v124, v216, v217
v_cvt_pk_bf16_f32 v125, v218, v219
v_cvt_pk_bf16_f32 v126, v220, v221
v_cvt_pk_bf16_f32 v127, v222, v223
s_add_u32 s93, s88, 1052672
buffer_store_dwordx4 v[112:115], v1, s[76:79], s93 offen offset:0 sc1
buffer_store_dwordx4 v[116:119], v1, s[76:79], s93 offen offset:1024 sc1
buffer_store_dwordx4 v[120:123], v1, s[76:79], s93 offen offset:2048 sc1
buffer_store_dwordx4 v[124:127], v1, s[76:79], s93 offen offset:3072 sc1
v_and_b32 v20, 31, v0
v_lshrrev_b32 v21, 5, v0
v_lshlrev_b32 v19, 4, v20
v_lshl_add_u32 v19, v21, 19, v19
v_lshlrev_b32 v20, 11, v20
s_waitcnt vmcnt(8)
s_mov_b32 s93, 0
L_pollR01:
v_cmp_ne_u64 vcc, s[100:101], v[128:129]
s_nop 1
s_cmp_eq_u64 vcc, 0
s_cbranch_scc1 L_polledR01
s_add_u32 s93, s93, 1
s_cmp_ge_u32 s93, 400000
s_cbranch_scc1 L_polledR01
s_sleep 4
buffer_load_dwordx2 v[128:129], v130, s[76:79], s24 offen offset:0 sc1
s_waitcnt vmcnt(0)
s_branch L_pollR01
L_polledR01:
s_add_u32 s92, s25, 0
buffer_load_dwordx4 v[32:35], v19, s[76:79], s92 offen sc1
s_add_u32 s92, s25, 65536
buffer_load_dwordx4 v[36:39], v19, s[76:79], s92 offen sc1
s_add_u32 s92, s25, 131072
buffer_load_dwordx4 v[40:43], v19, s[76:79], s92 offen sc1
s_add_u32 s92, s25, 196608
buffer_load_dwordx4 v[44:47], v19, s[76:79], s92 offen sc1
s_add_u32 s92, s25, 262144
buffer_load_dwordx4 v[48:51], v19, s[76:79], s92 offen sc1
s_add_u32 s92, s25, 327680
buffer_load_dwordx4 v[52:55], v19, s[76:79], s92 offen sc1
s_add_u32 s92, s25, 393216
buffer_load_dwordx4 v[56:59], v19, s[76:79], s92 offen sc1
s_add_u32 s92, s25, 458752
buffer_load_dwordx4 v[60:63], v19, s[76:79], s92 offen sc1
s_waitcnt vmcnt(8)
v_mov_b32 v224, s100
v_mov_b32 v225, s101
s_lshl_b32 s92, s83, 3
v_mov_b32 v226, s92
s_mov_b64 exec, 1
buffer_store_dwordx2 v[224:225], v226, s[76:79], s24 offen offset:1024 sc1
s_mov_b64 exec, -1
v_and_b32 v130, 15, v0
v_lshlrev_b32 v130, 3, v130
buffer_load_dwordx2 v[128:129], v130, s[76:79], s24 offen offset:1024 sc1
s_waitcnt vmcnt(9)
v_lshlrev_b32 v160, 16, v32
v_and_b32 v161, 0xffff0000, v32
v_lshlrev_b32 v162, 16, v33
v_and_b32 v163, 0xffff0000, v33
v_lshlrev_b32 v164, 16, v34
v_and_b32 v165, 0xffff0000, v34
v_lshlrev_b32 v166, 16, v35
v_and_b32 v167, 0xffff0000, v35
s_waitcnt vmcnt(8)
v_lshlrev_b32 v168, 16, v36
v_and_b32 v169, 0xffff0000, v36
v_add_f32 v160, v160, v168
v_add_f32 v161, v161, v169
v_lshlrev_b32 v168, 16, v37
v_and_b32 v169, 0xffff0000, v37
v_add_f32 v162, v162, v168
v_add_f32 v163, v163, v169
v_lshlrev_b32 v168, 16, v38
v_and_b32 v169, 0xffff0000, v38
v_add_f32 v164, v164, v168
v_add_f32 v165, v165, v169
v_lshlrev_b32 v168, 16, v39
v_and_b32 v169, 0xffff0000, v39
v_add_f32 v166, v166, v168
v_add_f32 v167, v167, v169
s_waitcnt vmcnt(7)
v_lshlrev_b32 v168, 16, v40
v_and_b32 v169, 0xffff0000, v40
v_add_f32 v160, v160, v168
v_add_f32 v161, v161, v169
v_lshlrev_b32 v168, 16, v41
v_and_b32 v169, 0xffff0000, v41
v_add_f32 v162, v162, v168
v_add_f32 v163, v163, v169
v_lshlrev_b32 v168, 16, v42
v_and_b32 v169, 0xffff0000, v42
v_add_f32 v164, v164, v168
v_add_f32 v165, v165, v169
v_lshlrev_b32 v168, 16, v43
v_and_b32 v169, 0xffff0000, v43
v_add_f32 v166, v166, v168
v_add_f32 v167, v167, v169
s_waitcnt vmcnt(6)
v_lshlrev_b32 v168, 16, v44
v_and_b32 v169, 0xffff0000, v44
v_add_f32 v160, v160, v168
v_add_f32 v161, v161, v169
v_lshlrev_b32 v168, 16, v45
v_and_b32 v169, 0xffff0000, v45
v_add_f32 v162, v162, v168
v_add_f32 v163, v163, v169
v_lshlrev_b32 v168, 16, v46
v_and_b32 v169, 0xffff0000, v46
v_add_f32 v164, v164, v168
v_add_f32 v165, v165, v169
v_lshlrev_b32 v168, 16, v47
v_and_b32 v169, 0xffff0000, v47
v_add_f32 v166, v166, v168
v_add_f32 v167, v167, v169
s_waitcnt vmcnt(5)
v_lshlrev_b32 v168, 16, v48
v_and_b32 v169, 0xffff0000, v48
v_add_f32 v160, v160, v168
v_add_f32 v161, v161, v169
v_lshlrev_b32 v168, 16, v49
v_and_b32 v169, 0xffff0000, v49
v_add_f32 v162, v162, v168
v_add_f32 v163, v163, v169
v_lshlrev_b32 v168, 16, v50
v_and_b32 v169, 0xffff0000, v50
v_add_f32 v164, v164, v168
v_add_f32 v165, v165, v169
v_lshlrev_b32 v168, 16, v51
v_and_b32 v169, 0xffff0000, v51
v_add_f32 v166, v166, v168
v_add_f32 v167, v167, v169
s_waitcnt vmcnt(4)
v_lshlrev_b32 v168, 16, v52
v_and_b32 v169, 0xffff0000, v52
v_add_f32 v160, v160, v168
v_add_f32 v161, v161, v169
v_lshlrev_b32 v168, 16, v53
v_and_b32 v169, 0xffff0000, v53
v_add_f32 v162, v162, v168
v_add_f32 v163, v163, v169
v_lshlrev_b32 v168, 16, v54
v_and_b32 v169, 0xffff0000, v54
v_add_f32 v164, v164, v168
v_add_f32 v165, v165, v169
v_lshlrev_b32 v168, 16, v55
v_and_b32 v169, 0xffff0000, v55
v_add_f32 v166, v166, v168
v_add_f32 v167, v167, v169
s_waitcnt vmcnt(3)
v_lshlrev_b32 v168, 16, v56
v_and_b32 v169, 0xffff0000, v56
v_add_f32 v160, v160, v168
v_add_f32 v161, v161, v169
v_lshlrev_b32 v168, 16, v57
v_and_b32 v169, 0xffff0000, v57
v_add_f32 v162, v162, v168
v_add_f32 v163, v163, v169
v_lshlrev_b32 v168, 16, v58
v_and_b32 v169, 0xffff0000, v58
v_add_f32 v164, v164, v168
v_add_f32 v165, v165, v169
v_lshlrev_b32 v168, 16, v59
v_and_b32 v169, 0xffff0000, v59
v_add_f32 v166, v166, v168
v_add_f32 v167, v167, v169
s_waitcnt vmcnt(2)
v_lshlrev_b32 v168, 16, v60
v_and_b32 v169, 0xffff0000, v60
v_add_f32 v160, v160, v168
v_add_f32 v161, v161, v169
v_lshlrev_b32 v168, 16, v61
v_and_b32 v169, 0xffff0000, v61
v_add_f32 v162, v162, v168
v_add_f32 v163, v163, v169
v_lshlrev_b32 v168, 16, v62
v_and_b32 v169, 0xffff0000, v62
v_add_f32 v164, v164, v168
v_add_f32 v165, v165, v169
v_lshlrev_b32 v168, 16, v63
v_and_b32 v169, 0xffff0000, v63
v_add_f32 v166, v166, v168
v_add_f32 v167, v167, v169
v_mov_b32 v176, v160
v_mov_b32 v177, v161
v_mov_b32 v178, v162
v_mov_b32 v179, v163
v_mov_b32 v180, v164
v_mov_b32 v181, v165
v_mov_b32 v182, v166
v_mov_b32 v183, v167
v_permlane32_swap_b32 v160, v176
v_permlane32_swap_b32 v161, v177
v_permlane32_swap_b32 v162, v178
v_permlane32_swap_b32 v163, v179
v_permlane32_swap_b32 v164, v180
v_permlane32_swap_b32 v165, v181
v_permlane32_swap_b32 v166, v182
v_permlane32_swap_b32 v167, v183
v_add_f32 v160, v160, v176
v_add_f32 v161, v161, v177
v_add_f32 v162, v162, v178
v_add_f32 v163, v163, v179
v_add_f32 v164, v164, v180
v_add_f32 v165, v165, v181
v_add_f32 v166, v166, v182
v_add_f32 v167, v167, v183
v_cvt_pk_bf16_f32 v172, v160, v161
v_cvt_pk_bf16_f32 v173, v162, v163
v_cvt_pk_bf16_f32 v174, v164, v165
v_cvt_pk_bf16_f32 v175, v166, v167
s_add_u32 s92, s98, 0
buffer_store_dwordx4 v[172:175], v20, s[20:23], s92 offen
s_waitcnt vmcnt(1)
s_mov_b32 s93, 0
L_pollR11:
v_cmp_ne_u64 vcc, s[100:101], v[128:129]
s_nop 1
s_cmp_eq_u64 vcc, 0
s_cbranch_scc1 L_polledR11
s_add_u32 s93, s93, 1
s_cmp_ge_u32 s93, 400000
s_cbranch_scc1 L_polledR11
s_sleep 4
buffer_load_dwordx2 v[128:129], v130, s[76:79], s24 offen offset:1024 sc1
s_waitcnt vmcnt(0)
s_branch L_pollR11
L_polledR11:
s_add_u32 s92, s25, 1048576
buffer_load_dwordx4 v[64:67], v19, s[76:79], s92 offen sc1
s_add_u32 s92, s25, 1114112
buffer_load_dwordx4 v[68:71], v19, s[76:79], s92 offen sc1
s_add_u32 s92, s25, 1179648
buffer_load_dwordx4 v[72:75], v19, s[76:79], s92 offen sc1
s_add_u32 s92, s25, 1245184
buffer_load_dwordx4 v[76:79], v19, s[76:79], s92 offen sc1
s_add_u32 s92, s25, 1310720
buffer_load_dwordx4 v[80:83], v19, s[76:79], s92 offen sc1
s_add_u32 s92, s25, 1376256
buffer_load_dwordx4 v[84:87], v19, s[76:79], s92 offen sc1
s_add_u32 s92, s25, 1441792
buffer_load_dwordx4 v[88:91], v19, s[76:79], s92 offen sc1
s_add_u32 s92, s25, 1507328
buffer_load_dwordx4 v[92:95], v19, s[76:79], s92 offen sc1
s_waitcnt vmcnt(7)
v_lshlrev_b32 v192, 16, v64
v_and_b32 v193, 0xffff0000, v64
v_lshlrev_b32 v194, 16, v65
v_and_b32 v195, 0xffff0000, v65
v_lshlrev_b32 v196, 16, v66
v_and_b32 v197, 0xffff0000, v66
v_lshlrev_b32 v198, 16, v67
v_and_b32 v199, 0xffff0000, v67
s_waitcnt vmcnt(6)
v_lshlrev_b32 v200, 16, v68
v_and_b32 v201, 0xffff0000, v68
v_add_f32 v192, v192, v200
v_add_f32 v193, v193, v201
v_lshlrev_b32 v200, 16, v69
v_and_b32 v201, 0xffff0000, v69
v_add_f32 v194, v194, v200
v_add_f32 v195, v195, v201
v_lshlrev_b32 v200, 16, v70
v_and_b32 v201, 0xffff0000, v70
v_add_f32 v196, v196, v200
v_add_f32 v197, v197, v201
v_lshlrev_b32 v200, 16, v71
v_and_b32 v201, 0xffff0000, v71
v_add_f32 v198, v198, v200
v_add_f32 v199, v199, v201
s_waitcnt vmcnt(5)
v_lshlrev_b32 v200, 16, v72
v_and_b32 v201, 0xffff0000, v72
v_add_f32 v192, v192, v200
v_add_f32 v193, v193, v201
v_lshlrev_b32 v200, 16, v73
v_and_b32 v201, 0xffff0000, v73
v_add_f32 v194, v194, v200
v_add_f32 v195, v195, v201
v_lshlrev_b32 v200, 16, v74
v_and_b32 v201, 0xffff0000, v74
v_add_f32 v196, v196, v200
v_add_f32 v197, v197, v201
v_lshlrev_b32 v200, 16, v75
v_and_b32 v201, 0xffff0000, v75
v_add_f32 v198, v198, v200
v_add_f32 v199, v199, v201
s_waitcnt vmcnt(4)
v_lshlrev_b32 v200, 16, v76
v_and_b32 v201, 0xffff0000, v76
v_add_f32 v192, v192, v200
v_add_f32 v193, v193, v201
v_lshlrev_b32 v200, 16, v77
v_and_b32 v201, 0xffff0000, v77
v_add_f32 v194, v194, v200
v_add_f32 v195, v195, v201
v_lshlrev_b32 v200, 16, v78
v_and_b32 v201, 0xffff0000, v78
v_add_f32 v196, v196, v200
v_add_f32 v197, v197, v201
v_lshlrev_b32 v200, 16, v79
v_and_b32 v201, 0xffff0000, v79
v_add_f32 v198, v198, v200
v_add_f32 v199, v199, v201
s_waitcnt vmcnt(3)
v_lshlrev_b32 v200, 16, v80
v_and_b32 v201, 0xffff0000, v80
v_add_f32 v192, v192, v200
v_add_f32 v193, v193, v201
v_lshlrev_b32 v200, 16, v81
v_and_b32 v201, 0xffff0000, v81
v_add_f32 v194, v194, v200
v_add_f32 v195, v195, v201
v_lshlrev_b32 v200, 16, v82
v_and_b32 v201, 0xffff0000, v82
v_add_f32 v196, v196, v200
v_add_f32 v197, v197, v201
v_lshlrev_b32 v200, 16, v83
v_and_b32 v201, 0xffff0000, v83
v_add_f32 v198, v198, v200
v_add_f32 v199, v199, v201
s_waitcnt vmcnt(2)
v_lshlrev_b32 v200, 16, v84
v_and_b32 v201, 0xffff0000, v84
v_add_f32 v192, v192, v200
v_add_f32 v193, v193, v201
v_lshlrev_b32 v200, 16, v85
v_and_b32 v201, 0xffff0000, v85
v_add_f32 v194, v194, v200
v_add_f32 v195, v195, v201
v_lshlrev_b32 v200, 16, v86
v_and_b32 v201, 0xffff0000, v86
v_add_f32 v196, v196, v200
v_add_f32 v197, v197, v201
v_lshlrev_b32 v200, 16, v87
v_and_b32 v201, 0xffff0000, v87
v_add_f32 v198, v198, v200
v_add_f32 v199, v199, v201
s_waitcnt vmcnt(1)
v_lshlrev_b32 v200, 16, v88
v_and_b32 v201, 0xffff0000, v88
v_add_f32 v192, v192, v200
v_add_f32 v193, v193, v201
v_lshlrev_b32 v200, 16, v89
v_and_b32 v201, 0xffff0000, v89
v_add_f32 v194, v194, v200
v_add_f32 v195, v195, v201
v_lshlrev_b32 v200, 16, v90
v_and_b32 v201, 0xffff0000, v90
v_add_f32 v196, v196, v200
v_add_f32 v197, v197, v201
v_lshlrev_b32 v200, 16, v91
v_and_b32 v201, 0xffff0000, v91
v_add_f32 v198, v198, v200
v_add_f32 v199, v199, v201
s_waitcnt vmcnt(0)
v_lshlrev_b32 v200, 16, v92
v_and_b32 v201, 0xffff0000, v92
v_add_f32 v192, v192, v200
v_add_f32 v193, v193, v201
v_lshlrev_b32 v200, 16, v93
v_and_b32 v201, 0xffff0000, v93
v_add_f32 v194, v194, v200
v_add_f32 v195, v195, v201
v_lshlrev_b32 v200, 16, v94
v_and_b32 v201, 0xffff0000, v94
v_add_f32 v196, v196, v200
v_add_f32 v197, v197, v201
v_lshlrev_b32 v200, 16, v95
v_and_b32 v201, 0xffff0000, v95
v_add_f32 v198, v198, v200
v_add_f32 v199, v199, v201
v_mov_b32 v208, v192
v_mov_b32 v209, v193
v_mov_b32 v210, v194
v_mov_b32 v211, v195
v_mov_b32 v212, v196
v_mov_b32 v213, v197
v_mov_b32 v214, v198
v_mov_b32 v215, v199
v_permlane32_swap_b32 v192, v208
v_permlane32_swap_b32 v193, v209
v_permlane32_swap_b32 v194, v210
v_permlane32_swap_b32 v195, v211
v_permlane32_swap_b32 v196, v212
v_permlane32_swap_b32 v197, v213
v_permlane32_swap_b32 v198, v214
v_permlane32_swap_b32 v199, v215
v_add_f32 v192, v192, v208
v_add_f32 v193, v193, v209
v_add_f32 v194, v194, v210
v_add_f32 v195, v195, v211
v_add_f32 v196, v196, v212
v_add_f32 v197, v197, v213
v_add_f32 v198, v198, v214
v_add_f32 v199, v199, v215
v_cvt_pk_bf16_f32 v204, v192, v193
v_cvt_pk_bf16_f32 v205, v194, v195
v_cvt_pk_bf16_f32 v206, v196, v197
v_cvt_pk_bf16_f32 v207, v198, v199
s_add_u32 s92, s98, 65536
buffer_store_dwordx4 v[204:207], v20, s[20:23], s92 offen
L_pend1:
s_endpgm
L_progA:
s_nop 15
s_nop 3
s_lshr_b32 s92, s28, 1
s_and_b32 s93, s28, 1
s_lshl_b32 s96, s92, 6
s_lshl_b32 s92, s27, 2
s_add_u32 s96, s96, s92
s_lshl_b32 s93, s93, 1
s_add_u32 s96, s96, s93
s_add_u32 s96, s96, s30
s_lshl_b32 s96, s96, 17
s_lshl_b32 s92, s29, 13
s_add_u32 s96, s96, s92
s_lshl_b32 s31, s26, 14
s_lshl_b32 s97, s28, 3
s_add_u32 s97, s97, s27
s_lshl_b32 s99, s97, 8
s_add_u32 s99, s99, 29360128
v_lshl_add_u32 v40, v32, 3, v34
v_lshlrev_b32 v40, 8, v40
v_lshl_add_u32 v40, v34, 6, v40
v_lshl_add_u32 v40, v36, 5, v40
v_lshl_add_u32 v5, v37, 3, v40
v_lshlrev_b32 v41, 13, v38
v_lshl_or_b32 v15, v39, 4, v41
v_add_u32 v16, 31744, v15
v_add_u32 v17, 63488, v15
v_add_u32 v18, 95232, v15
v_xor_b32 v7, 64, v6
v_xor_b32 v8, 128, v6
v_xor_b32 v9, 192, v6
s_lshl_b32 s81, s27, 10
s_lshl_b32 s92, s26, 8
s_add_u32 s81, s81, s92
s_lshl_b32 s82, s27, 19
s_add_u32 s82, s82, s92
s_lshl_b32 s83, s28, 3
s_add_u32 s83, s83, s27
s_lshl_b32 s83, s83, 17
s_lshl_b32 s94, s26, 11
s_add_u32 s83, s83, s94
s_mov_b32 s84, 0
s_lshl_b32 s88, s28, 4
s_add_u32 s88, s88, s27
s_lshl_b32 s88, s88, 16
s_lshl_b32 s92, s26, 13
s_add_u32 s88, s88, s92
s_lshl_b32 s92, s28, 5
s_lshl_b32 s93, s26, 3
s_add_u32 s92, s92, s93
s_lshl_b32 s89, s92, 13
s_lshl_b32 s93, s27, 10
s_add_u32 s89, s89, s93
s_lshl_b32 s90, s92, 10
s_lshl_b32 s93, s27, 19
s_add_u32 s90, s90, s93
s_add_u32 s92, s89, 0
buffer_load_dwordx4 a[252:255], v1, s[48:51], s92 offen
s_add_u32 s92, s89, 8192
buffer_load_dwordx4 a[252:255], v1, s[48:51], s92 offen
s_add_u32 s92, s89, 16384
buffer_load_dwordx4 a[252:255], v1, s[48:51], s92 offen
s_add_u32 s92, s89, 24576
buffer_load_dwordx4 a[252:255], v1, s[48:51], s92 offen
s_add_u32 s92, s89, 32768
buffer_load_dwordx4 a[252:255], v1, s[48:51], s92 offen
s_add_u32 s92, s89, 40960
buffer_load_dwordx4 a[252:255], v1, s[48:51], s92 offen
s_add_u32 s92, s89, 49152
buffer_load_dwordx4 a[252:255], v1, s[48:51], s92 offen
s_add_u32 s92, s89, 57344
buffer_load_dwordx4 a[252:255], v1, s[48:51], s92 offen
s_add_u32 s92, s80, 0
s_add_u32 m0, s86, 0
s_nop 0
buffer_load_dwordx4 v48, s[36:39], s92 offen offset:0 lds
buffer_load_dwordx4 v49, s[36:39], s92 offen offset:1024 lds
buffer_load_dwordx4 v50, s[36:39], s92 offen offset:2048 lds
buffer_load_dwordx4 v51, s[36:39], s92 offen offset:3072 lds
s_add_u32 s92, s80, 4096
s_add_u32 m0, s86, 4096
s_nop 0
buffer_load_dwordx4 v52, s[36:39], s92 offen offset:0 lds
buffer_load_dwordx4 v53, s[36:39], s92 offen offset:1024 lds
buffer_load_dwordx4 v54, s[36:39], s92 offen offset:2048 lds
buffer_load_dwordx4 v55, s[36:39], s92 offen offset:3072 lds
s_add_u32 s92, s90, 0
buffer_load_dwordx4 a[252:255], v1, s[72:75], s92 offen offset:0
buffer_load_dwordx4 a[252:255], v1, s[72:75], s92 offen offset:1024
buffer_load_dwordx4 a[252:255], v1, s[72:75], s92 offen offset:2048
buffer_load_dwordx4 a[252:255], v1, s[72:75], s92 offen offset:3072
s_add_u32 s92, s90, 4096
buffer_load_dwordx4 a[252:255], v1, s[72:75], s92 offen offset:0
buffer_load_dwordx4 a[252:255], v1, s[72:75], s92 offen offset:1024
buffer_load_dwordx4 a[252:255], v1, s[72:75], s92 offen offset:2048
buffer_load_dwordx4 a[252:255], v1, s[72:75], s92 offen offset:3072
s_add_u32 s92, s90, 0
buffer_load_dwordx4 a[252:255], v1, s[52:55], s92 offen offset:0
buffer_load_dwordx4 a[252:255], v1, s[52:55], s92 offen offset:1024
buffer_load_dwordx4 a[252:255], v1, s[52:55], s92 offen offset:2048
buffer_load_dwordx4 a[252:255], v1, s[52:55], s92 offen offset:3072
s_add_u32 s92, s90, 4096
buffer_load_dwordx4 a[252:255], v1, s[52:55], s92 offen offset:0
buffer_load_dwordx4 a[252:255], v1, s[52:55], s92 offen offset:1024
buffer_load_dwordx4 a[252:255], v1, s[52:55], s92 offen offset:2048
buffer_load_dwordx4 a[252:255], v1, s[52:55], s92 offen offset:3072
s_add_u32 s95, s81, 0
s_add_u32 m0, s85, 0
s_nop 0
buffer_load_dwordx4 v15, s[48:51], s95 offen offset:0 lds
buffer_load_dwordx4 v16, s[48:51], s95 offen offset:1024 lds
buffer_load_dwordx4 v17, s[48:51], s95 offen offset:2048 lds
buffer_load_dwordx4 v18, s[48:51], s95 offen offset:3072 lds
s_add_u32 s95, s81, 131072
s_add_u32 m0, s85, 4096
s_nop 0
buffer_load_dwordx4 v15, s[48:51], s95 offen offset:0 lds
buffer_load_dwordx4 v16, s[48:51], s95 offen offset:1024 lds
buffer_load_dwordx4 v17, s[48:51], s95 offen offset:2048 lds
buffer_load_dwordx4 v18, s[48:51], s95 offen offset:3072 lds
s_add_u32 s95, s81, 262144
s_add_u32 m0, s85, 8192
s_nop 0
buffer_load_dwordx4 v15, s[48:51], s95 offen offset:0 lds
buffer_load_dwordx4 v16, s[48:51], s95 offen offset:1024 lds
buffer_load_dwordx4 v17, s[48:51], s95 offen offset:2048 lds
buffer_load_dwordx4 v18, s[48:51], s95 offen offset:3072 lds
v_and_b32 v31, 31, v0
v_mul_u32_u24 v31, 768, v31
v_add_u32 v31, v31, v2
v_add_u32 v228, 114688, v31
v_xor_b32 v229, 32, v228
v_xor_b32 v230, 64, v228
v_xor_b32 v231, 96, v228
v_xor_b32 v232, 128, v228
v_xor_b32 v233, 160, v228
v_xor_b32 v234, 192, v228
v_xor_b32 v235, 224, v228
s_waitcnt vmcnt(28)
s_barrier
v_mov_b32 v102, 0
buffer_load_dwordx2 v[100:101], v102, s[32:35], 0 offen
v_xor_b32 v224, 0, v5
v_add_u32 v236, s31, v224
v_add_u32 v224, s85, v224
v_xor_b32 v225, 64, v5
v_add_u32 v237, s31, v225
v_add_u32 v225, s85, v225
v_xor_b32 v226, 128, v5
v_add_u32 v238, s31, v226
v_add_u32 v226, s85, v226
v_xor_b32 v227, 192, v5
v_add_u32 v239, s31, v227
v_add_u32 v227, s85, v227
s_waitcnt vmcnt(9)
ds_read_b64_tr_b16 a[64:65], v224 offset:0
ds_read_b64_tr_b16 a[66:67], v224 offset:1024
ds_read_b64_tr_b16 a[68:69], v225 offset:0
ds_read_b64_tr_b16 a[70:71], v225 offset:1024
ds_read_b64_tr_b16 a[72:73], v226 offset:0
ds_read_b64_tr_b16 a[74:75], v226 offset:1024
ds_read_b64_tr_b16 a[76:77], v227 offset:0
ds_read_b64_tr_b16 a[78:79], v227 offset:1024
ds_read_b128 a[96:99], v228 offset:0
s_waitcnt lgkmcnt(0)
s_add_u32 s95, s81, 393216
s_add_u32 m0, s85, 0
s_nop 0
buffer_load_dwordx4 v15, s[48:51], s95 offen offset:0 lds
buffer_load_dwordx4 v16, s[48:51], s95 offen offset:1024 lds
buffer_load_dwordx4 v17, s[48:51], s95 offen offset:2048 lds
buffer_load_dwordx4 v18, s[48:51], s95 offen offset:3072 lds
s_waitcnt vmcnt(9)
ds_read_b64_tr_b16 a[80:81], v224 offset:4096
ds_read_b64_tr_b16 a[82:83], v224 offset:5120
ds_read_b64_tr_b16 a[84:85], v225 offset:4096
ds_read_b64_tr_b16 a[86:87], v225 offset:5120
ds_read_b64_tr_b16 a[88:89], v226 offset:4096
ds_read_b64_tr_b16 a[90:91], v226 offset:5120
ds_read_b64_tr_b16 a[92:93], v227 offset:4096
ds_read_b64_tr_b16 a[94:95], v227 offset:5120
ds_read_b128 a[100:103], v229 offset:0
v_mfma_f32_32x32x16_bf16 v[160:175], a[64:67], a[96:99], 0
v_mfma_f32_32x32x16_bf16 v[176:191], a[68:71], a[96:99], 0
v_mfma_f32_32x32x16_bf16 v[192:207], a[72:75], a[96:99], 0
s_waitcnt lgkmcnt(0)
s_add_u32 s95, s81, 524288
s_add_u32 m0, s85, 4096
s_nop 0
buffer_load_dwordx4 v15, s[48:51], s95 offen offset:0 lds
buffer_load_dwordx4 v16, s[48:51], s95 offen offset:1024 lds
v_mfma_f32_32x32x16_bf16 v[208:223], a[76:79], a[96:99], 0
buffer_load_dwordx4 v17, s[48:51], s95 offen offset:2048 lds
buffer_load_dwordx4 v18, s[48:51], s95 offen offset:3072 lds
s_waitcnt vmcnt(9)
ds_read_b64_tr_b16 a[64:65], v224 offset:8192
ds_read_b64_tr_b16 a[66:67], v224 offset:9216
ds_read_b64_tr_b16 a[68:69], v225 offset:8192
ds_read_b64_tr_b16 a[70:71], v225 offset:9216
ds_read_b64_tr_b16 a[72:73], v226 offset:8192
ds_read_b64_tr_b16 a[74:75], v226 offset:9216
ds_read_b64_tr_b16 a[76:77], v227 offset:8192
ds_read_b64_tr_b16 a[78:79], v227 offset:9216
ds_read_b128 a[96:99], v230 offset:0
v_mfma_f32_32x32x16_bf16 v[160:175], a[80:83], a[100:103], v[160:175]
v_mfma_f32_32x32x16_bf16 v[176:191], a[84:87], a[100:103], v[176:191]
v_mfma_f32_32x32x16_bf16 v[192:207], a[88:91], a[100:103], v[192:207]
s_waitcnt lgkmcnt(0)
s_add_u32 s95, s81, 655360
s_add_u32 m0, s85, 8192
s_nop 0
buffer_load_dwordx4 v15, s[48:51], s95 offen offset:0 lds
buffer_load_dwordx4 v16, s[48:51], s95 offen offset:1024 lds
v_mfma_f32_32x32x16_bf16 v[208:223], a[92:95], a[100:103], v[208:223]
buffer_load_dwordx4 v17, s[48:51], s95 offen offset:2048 lds
buffer_load_dwordx4 v18, s[48:51], s95 offen offset:3072 lds
s_waitcnt vmcnt(8)
ds_read_b64_tr_b16 a[80:81], v224 offset:0
ds_read_b64_tr_b16 a[82:83], v224 offset:1024
ds_read_b64_tr_b16 a[84:85], v225 offset:0
ds_read_b64_tr_b16 a[86:87], v225 offset:1024
ds_read_b64_tr_b16 a[88:89], v226 offset:0
ds_read_b64_tr_b16 a[90:91], v226 offset:1024
ds_read_b64_tr_b16 a[92:93], v227 offset:0
ds_read_b64_tr_b16 a[94:95], v227 offset:1024
ds_read_b128 a[100:103], v231 offset:0
v_mfma_f32_32x32x16_bf16 v[160:175], a[64:67], a[96:99], v[160:175]
v_mfma_f32_32x32x16_bf16 v[176:191], a[68:71], a[96:99], v[176:191]
v_mfma_f32_32x32x16_bf16 v[192:207], a[72:75], a[96:99], v[192:207]
s_waitcnt lgkmcnt(0)
s_add_u32 s95, s81, 786432
s_add_u32 m0, s85, 0
s_nop 0
buffer_load_dwordx4 v15, s[48:51], s95 offen offset:0 lds
buffer_load_dwordx4 v16, s[48:51], s95 offen offset:1024 lds
v_mfma_f32_32x32x16_bf16 v[208:223], a[76:79], a[96:99], v[208:223]
buffer_load_dwordx4 v17, s[48:51], s95 offen offset:2048 lds
buffer_load_dwordx4 v18, s[48:51], s95 offen offset:3072 lds
s_waitcnt vmcnt(8)
ds_read_b64_tr_b16 a[64:65], v224 offset:4096
ds_read_b64_tr_b16 a[66:67], v224 offset:5120
ds_read_b64_tr_b16 a[68:69], v225 offset:4096
ds_read_b64_tr_b16 a[70:71], v225 offset:5120
ds_read_b64_tr_b16 a[72:73], v226 offset:4096
ds_read_b64_tr_b16 a[74:75], v226 offset:5120
ds_read_b64_tr_b16 a[76:77], v227 offset:4096
ds_read_b64_tr_b16 a[78:79], v227 offset:5120
ds_read_b128 a[96:99], v232 offset:0
v_mfma_f32_32x32x16_bf16 v[160:175], a[80:83], a[100:103], v[160:175]
v_mfma_f32_32x32x16_bf16 v[176:191], a[84:87], a[100:103], v[176:191]
v_mfma_f32_32x32x16_bf16 v[192:207], a[88:91], a[100:103], v[192:207]
s_waitcnt lgkmcnt(0)
s_add_u32 s95, s81, 917504
s_add_u32 m0, s85, 4096
s_nop 0
buffer_load_dwordx4 v15, s[48:51], s95 offen offset:0 lds
buffer_load_dwordx4 v16, s[48:51], s95 offen offset:1024 lds
v_mfma_f32_32x32x16_bf16 v[208:223], a[92:95], a[100:103], v[208:223]
buffer_load_dwordx4 v17, s[48:51], s95 offen offset:2048 lds
buffer_load_dwordx4 v18, s[48:51], s95 offen offset:3072 lds
s_waitcnt vmcnt(8)
ds_read_b64_tr_b16 a[80:81], v224 offset:8192
ds_read_b64_tr_b16 a[82:83], v224 offset:9216
ds_read_b64_tr_b16 a[84:85], v225 offset:8192
ds_read_b64_tr_b16 a[86:87], v225 offset:9216
ds_read_b64_tr_b16 a[88:89], v226 offset:8192
ds_read_b64_tr_b16 a[90:91], v226 offset:9216
ds_read_b64_tr_b16 a[92:93], v227 offset:8192
ds_read_b64_tr_b16 a[94:95], v227 offset:9216
ds_read_b128 a[100:103], v233 offset:0
v_mfma_f32_32x32x16_bf16 v[160:175], a[64:67], a[96:99], v[160:175]
v_mfma_f32_32x32x16_bf16 v[176:191], a[68:71], a[96:99], v[176:191]
v_mfma_f32_32x32x16_bf16 v[192:207], a[72:75], a[96:99], v[192:207]
s_waitcnt lgkmcnt(0)
s_add_u32 s95, s81, 1048576
s_add_u32 m0, s85, 8192
s_nop 0
buffer_load_dwordx4 v15, s[48:51], s95 offen offset:0 lds
buffer_load_dwordx4 v16, s[48:51], s95 offen offset:1024 lds
v_mfma_f32_32x32x16_bf16 v[208:223], a[76:79], a[96:99], v[208:223]
buffer_load_dwordx4 v17, s[48:51], s95 offen offset:2048 lds
buffer_load_dwordx4 v18, s[48:51], s95 offen offset:3072 lds
s_waitcnt vmcnt(8)
ds_read_b64_tr_b16 a[64:65], v224 offset:0
ds_read_b64_tr_b16 a[66:67], v224 offset:1024
ds_read_b64_tr_b16 a[68:69], v225 offset:0
ds_read_b64_tr_b16 a[70:71], v225 offset:1024
ds_read_b64_tr_b16 a[72:73], v226 offset:0
ds_read_b64_tr_b16 a[74:75], v226 offset:1024
ds_read_b64_tr_b16 a[76:77], v227 offset:0
ds_read_b64_tr_b16 a[78:79], v227 offset:1024
ds_read_b128 a[96:99], v234 offset:0
v_mfma_f32_32x32x16_bf16 v[160:175], a[80:83], a[100:103], v[160:175]
v_mfma_f32_32x32x16_bf16 v[176:191], a[84:87], a[100:103], v[176:191]
v_mfma_f32_32x32x16_bf16 v[192:207], a[88:91], a[100:103], v[192:207]
s_waitcnt lgkmcnt(0)
s_add_u32 s95, s81, 1179648
s_add_u32 m0, s85, 0
s_nop 0
buffer_load_dwordx4 v15, s[48:51], s95 offen offset:0 lds
buffer_load_dwordx4 v16, s[48:51], s95 offen offset:1024 lds
v_mfma_f32_32x32x16_bf16 v[208:223], a[92:95], a[100:103], v[208:223]
buffer_load_dwordx4 v17, s[48:51], s95 offen offset:2048 lds
buffer_load_dwordx4 v18, s[48:51], s95 offen offset:3072 lds
s_waitcnt vmcnt(8)
ds_read_b64_tr_b16 a[80:81], v224 offset:4096
ds_read_b64_tr_b16 a[82:83], v224 offset:5120
ds_read_b64_tr_b16 a[84:85], v225 offset:4096
ds_read_b64_tr_b16 a[86:87], v225 offset:5120
ds_read_b64_tr_b16 a[88:89], v226 offset:4096
ds_read_b64_tr_b16 a[90:91], v226 offset:5120
ds_read_b64_tr_b16 a[92:93], v227 offset:4096
ds_read_b64_tr_b16 a[94:95], v227 offset:5120
ds_read_b128 a[100:103], v235 offset:0
v_mfma_f32_32x32x16_bf16 v[160:175], a[64:67], a[96:99], v[160:175]
v_mfma_f32_32x32x16_bf16 v[176:191], a[68:71], a[96:99], v[176:191]
v_mfma_f32_32x32x16_bf16 v[192:207], a[72:75], a[96:99], v[192:207]
s_waitcnt lgkmcnt(0)
s_add_u32 s95, s81, 1310720
s_add_u32 m0, s85, 4096
s_nop 0
buffer_load_dwordx4 v15, s[48:51], s95 offen offset:0 lds
buffer_load_dwordx4 v16, s[48:51], s95 offen offset:1024 lds
v_mfma_f32_32x32x16_bf16 v[208:223], a[76:79], a[96:99], v[208:223]
buffer_load_dwordx4 v17, s[48:51], s95 offen offset:2048 lds
buffer_load_dwordx4 v18, s[48:51], s95 offen offset:3072 lds
s_waitcnt vmcnt(8)
ds_read_b64_tr_b16 a[64:65], v224 offset:8192
ds_read_b64_tr_b16 a[66:67], v224 offset:9216
ds_read_b64_tr_b16 a[68:69], v225 offset:8192
ds_read_b64_tr_b16 a[70:71], v225 offset:9216
ds_read_b64_tr_b16 a[72:73], v226 offset:8192
ds_read_b64_tr_b16 a[74:75], v226 offset:9216
ds_read_b64_tr_b16 a[76:77], v227 offset:8192
ds_read_b64_tr_b16 a[78:79], v227 offset:9216
ds_read_b128 a[96:99], v228 offset:256
v_mfma_f32_32x32x16_bf16 v[160:175], a[80:83], a[100:103], v[160:175]
v_mfma_f32_32x32x16_bf16 v[176:191], a[84:87], a[100:103], v[176:191]
v_mfma_f32_32x32x16_bf16 v[192:207], a[88:91], a[100:103], v[192:207]
s_waitcnt lgkmcnt(0)
s_add_u32 s95, s81, 1441792
s_add_u32 m0, s85, 8192
s_nop 0
buffer_load_dwordx4 v15, s[48:51], s95 offen offset:0 lds
buffer_load_dwordx4 v16, s[48:51], s95 offen offset:1024 lds
v_mfma_f32_32x32x16_bf16 v[208:223], a[92:95], a[100:103], v[208:223]
buffer_load_dwordx4 v17, s[48:51], s95 offen offset:2048 lds
buffer_load_dwordx4 v18, s[48:51], s95 offen offset:3072 lds
s_waitcnt vmcnt(8)
ds_read_b64_tr_b16 a[80:81], v224 offset:0
ds_read_b64_tr_b16 a[82:83], v224 offset:1024
ds_read_b64_tr_b16 a[84:85], v225 offset:0
ds_read_b64_tr_b16 a[86:87], v225 offset:1024
ds_read_b64_tr_b16 a[88:89], v226 offset:0
ds_read_b64_tr_b16 a[90:91], v226 offset:1024
ds_read_b64_tr_b16 a[92:93], v227 offset:0
ds_read_b64_tr_b16 a[94:95], v227 offset:1024
ds_read_b128 a[100:103], v229 offset:256
v_mfma_f32_32x32x16_bf16 v[160:175], a[64:67], a[96:99], v[160:175]
v_mfma_f32_32x32x16_bf16 v[176:191], a[68:71], a[96:99], v[176:191]
v_mfma_f32_32x32x16_bf16 v[192:207], a[72:75], a[96:99], v[192:207]
s_waitcnt lgkmcnt(0)
s_add_u32 s95, s81, 1572864
s_add_u32 m0, s85, 0
s_nop 0
buffer_load_dwordx4 v15, s[48:51], s95 offen offset:0 lds
buffer_load_dwordx4 v16, s[48:51], s95 offen offset:1024 lds
v_mfma_f32_32x32x16_bf16 v[208:223], a[76:79], a[96:99], v[208:223]
buffer_load_dwordx4 v17, s[48:51], s95 offen offset:2048 lds
buffer_load_dwordx4 v18, s[48:51], s95 offen offset:3072 lds
s_waitcnt vmcnt(8)
ds_read_b64_tr_b16 a[64:65], v224 offset:4096
ds_read_b64_tr_b16 a[66:67], v224 offset:5120
ds_read_b64_tr_b16 a[68:69], v225 offset:4096
ds_read_b64_tr_b16 a[70:71], v225 offset:5120
ds_read_b64_tr_b16 a[72:73], v226 offset:4096
ds_read_b64_tr_b16 a[74:75], v226 offset:5120
ds_read_b64_tr_b16 a[76:77], v227 offset:4096
ds_read_b64_tr_b16 a[78:79], v227 offset:5120
ds_read_b128 a[96:99], v230 offset:256
v_mfma_f32_32x32x16_bf16 v[160:175], a[80:83], a[100:103], v[160:175]
v_mfma_f32_32x32x16_bf16 v[176:191], a[84:87], a[100:103], v[176:191]
v_mfma_f32_32x32x16_bf16 v[192:207], a[88:91], a[100:103], v[192:207]
s_waitcnt lgkmcnt(0)
s_add_u32 s95, s81, 1703936
s_add_u32 m0, s85, 4096
s_nop 0
buffer_load_dwordx4 v15, s[48:51], s95 offen offset:0 lds
buffer_load_dwordx4 v16, s[48:51], s95 offen offset:1024 lds
v_mfma_f32_32x32x16_bf16 v[208:223], a[92:95], a[100:103], v[208:223]
buffer_load_dwordx4 v17, s[48:51], s95 offen offset:2048 lds
buffer_load_dwordx4 v18, s[48:51], s95 offen offset:3072 lds
s_waitcnt vmcnt(8)
ds_read_b64_tr_b16 a[80:81], v224 offset:8192
ds_read_b64_tr_b16 a[82:83], v224 offset:9216
ds_read_b64_tr_b16 a[84:85], v225 offset:8192
ds_read_b64_tr_b16 a[86:87], v225 offset:9216
ds_read_b64_tr_b16 a[88:89], v226 offset:8192
ds_read_b64_tr_b16 a[90:91], v226 offset:9216
ds_read_b64_tr_b16 a[92:93], v227 offset:8192
ds_read_b64_tr_b16 a[94:95], v227 offset:9216
ds_read_b128 a[100:103], v231 offset:256
v_mfma_f32_32x32x16_bf16 v[160:175], a[64:67], a[96:99], v[160:175]
v_mfma_f32_32x32x16_bf16 v[176:191], a[68:71], a[96:99], v[176:191]
v_mfma_f32_32x32x16_bf16 v[192:207], a[72:75], a[96:99], v[192:207]
s_waitcnt lgkmcnt(0)
s_add_u32 s95, s81, 1835008
s_add_u32 m0, s85, 8192
s_nop 0
buffer_load_dwordx4 v15, s[48:51], s95 offen offset:0 lds
buffer_load_dwordx4 v16, s[48:51], s95 offen offset:1024 lds
v_mfma_f32_32x32x16_bf16 v[208:223], a[76:79], a[96:99], v[208:223]
buffer_load_dwordx4 v17, s[48:51], s95 offen offset:2048 lds
buffer_load_dwordx4 v18, s[48:51], s95 offen offset:3072 lds
s_waitcnt vmcnt(8)
ds_read_b64_tr_b16 a[64:65], v224 offset:0
ds_read_b64_tr_b16 a[66:67], v224 offset:1024
ds_read_b64_tr_b16 a[68:69], v225 offset:0
ds_read_b64_tr_b16 a[70:71], v225 offset:1024
ds_read_b64_tr_b16 a[72:73], v226 offset:0
ds_read_b64_tr_b16 a[74:75], v226 offset:1024
ds_read_b64_tr_b16 a[76:77], v227 offset:0
ds_read_b64_tr_b16 a[78:79], v227 offset:1024
ds_read_b128 a[96:99], v232 offset:256
v_mfma_f32_32x32x16_bf16 v[160:175], a[80:83], a[100:103], v[160:175]
v_mfma_f32_32x32x16_bf16 v[176:191], a[84:87], a[100:103], v[176:191]
v_mfma_f32_32x32x16_bf16 v[192:207], a[88:91], a[100:103], v[192:207]
s_waitcnt lgkmcnt(0)
s_add_u32 s95, s81, 1966080
s_add_u32 m0, s85, 0
s_nop 0
buffer_load_dwordx4 v15, s[48:51], s95 offen offset:0 lds
buffer_load_dwordx4 v16, s[48:51], s95 offen offset:1024 lds
v_mfma_f32_32x32x16_bf16 v[208:223], a[92:95], a[100:103], v[208:223]
buffer_load_dwordx4 v17, s[48:51], s95 offen offset:2048 lds
buffer_load_dwordx4 v18, s[48:51], s95 offen offset:3072 lds
s_waitcnt vmcnt(8)
ds_read_b64_tr_b16 a[80:81], v224 offset:4096
ds_read_b64_tr_b16 a[82:83], v224 offset:5120
ds_read_b64_tr_b16 a[84:85], v225 offset:4096
ds_read_b64_tr_b16 a[86:87], v225 offset:5120
ds_read_b64_tr_b16 a[88:89], v226 offset:4096
ds_read_b64_tr_b16 a[90:91], v226 offset:5120
ds_read_b64_tr_b16 a[92:93], v227 offset:4096
ds_read_b64_tr_b16 a[94:95], v227 offset:5120
ds_read_b128 a[100:103], v233 offset:256
v_mfma_f32_32x32x16_bf16 v[160:175], a[64:67], a[96:99], v[160:175]
v_mfma_f32_32x32x16_bf16 v[176:191], a[68:71], a[96:99], v[176:191]
v_mfma_f32_32x32x16_bf16 v[192:207], a[72:75], a[96:99], v[192:207]
s_waitcnt lgkmcnt(0)
s_add_u32 s95, s81, 2097152
s_add_u32 m0, s85, 4096
s_nop 0
buffer_load_dwordx4 v15, s[48:51], s95 offen offset:0 lds
buffer_load_dwordx4 v16, s[48:51], s95 offen offset:1024 lds
v_mfma_f32_32x32x16_bf16 v[208:223], a[76:79], a[96:99], v[208:223]
buffer_load_dwordx4 v17, s[48:51], s95 offen offset:2048 lds
buffer_load_dwordx4 v18, s[48:51], s95 offen offset:3072 lds
s_waitcnt vmcnt(8)
ds_read_b64_tr_b16 a[64:65], v224 offset:8192
ds_read_b64_tr_b16 a[66:67], v224 offset:9216
ds_read_b64_tr_b16 a[68:69], v225 offset:8192
ds_read_b64_tr_b16 a[70:71], v225 offset:9216
ds_read_b64_tr_b16 a[72:73], v226 offset:8192
ds_read_b64_tr_b16 a[74:75], v226 offset:9216
ds_read_b64_tr_b16 a[76:77], v227 offset:8192
ds_read_b64_tr_b16 a[78:79], v227 offset:9216
ds_read_b128 a[96:99], v234 offset:256
v_mfma_f32_32x32x16_bf16 v[160:175], a[80:83], a[100:103], v[160:175]
v_mfma_f32_32x32x16_bf16 v[176:191], a[84:87], a[100:103], v[176:191]
v_mfma_f32_32x32x16_bf16 v[192:207], a[88:91], a[100:103], v[192:207]
s_waitcnt lgkmcnt(0)
s_add_u32 s95, s81, 2228224
s_add_u32 m0, s85, 8192
s_nop 0
buffer_load_dwordx4 v15, s[48:51], s95 offen offset:0 lds
buffer_load_dwordx4 v16, s[48:51], s95 offen offset:1024 lds
v_mfma_f32_32x32x16_bf16 v[208:223], a[92:95], a[100:103], v[208:223]
buffer_load_dwordx4 v17, s[48:51], s95 offen offset:2048 lds
buffer_load_dwordx4 v18, s[48:51], s95 offen offset:3072 lds
s_waitcnt vmcnt(8)
ds_read_b64_tr_b16 a[80:81], v224 offset:0
ds_read_b64_tr_b16 a[82:83], v224 offset:1024
ds_read_b64_tr_b16 a[84:85], v225 offset:0
ds_read_b64_tr_b16 a[86:87], v225 offset:1024
ds_read_b64_tr_b16 a[88:89], v226 offset:0
ds_read_b64_tr_b16 a[90:91], v226 offset:1024
ds_read_b64_tr_b16 a[92:93], v227 offset:0
ds_read_b64_tr_b16 a[94:95], v227 offset:1024
ds_read_b128 a[100:103], v235 offset:256
v_mfma_f32_32x32x16_bf16 v[160:175], a[64:67], a[96:99], v[160:175]
v_mfma_f32_32x32x16_bf16 v[176:191], a[68:71], a[96:99], v[176:191]
v_mfma_f32_32x32x16_bf16 v[192:207], a[72:75], a[96:99], v[192:207]
s_waitcnt lgkmcnt(0)
s_add_u32 s95, s81, 2359296
s_add_u32 m0, s85, 0
s_nop 0
buffer_load_dwordx4 v15, s[48:51], s95 offen offset:0 lds
buffer_load_dwordx4 v16, s[48:51], s95 offen offset:1024 lds
v_mfma_f32_32x32x16_bf16 v[208:223], a[76:79], a[96:99], v[208:223]
buffer_load_dwordx4 v17, s[48:51], s95 offen offset:2048 lds
buffer_load_dwordx4 v18, s[48:51], s95 offen offset:3072 lds
s_waitcnt vmcnt(8)
ds_read_b64_tr_b16 a[64:65], v224 offset:4096
ds_read_b64_tr_b16 a[66:67], v224 offset:5120
ds_read_b64_tr_b16 a[68:69], v225 offset:4096
ds_read_b64_tr_b16 a[70:71], v225 offset:5120
ds_read_b64_tr_b16 a[72:73], v226 offset:4096
ds_read_b64_tr_b16 a[74:75], v226 offset:5120
ds_read_b64_tr_b16 a[76:77], v227 offset:4096
ds_read_b64_tr_b16 a[78:79], v227 offset:5120
ds_read_b128 a[96:99], v228 offset:512
v_mfma_f32_32x32x16_bf16 v[160:175], a[80:83], a[100:103], v[160:175]
v_mfma_f32_32x32x16_bf16 v[176:191], a[84:87], a[100:103], v[176:191]
v_mfma_f32_32x32x16_bf16 v[192:207], a[88:91], a[100:103], v[192:207]
s_waitcnt lgkmcnt(0)
s_add_u32 s95, s81, 2490368
s_add_u32 m0, s85, 4096
s_nop 0
buffer_load_dwordx4 v15, s[48:51], s95 offen offset:0 lds
buffer_load_dwordx4 v16, s[48:51], s95 offen offset:1024 lds
v_mfma_f32_32x32x16_bf16 v[208:223], a[92:95], a[100:103], v[208:223]
buffer_load_dwordx4 v17, s[48:51], s95 offen offset:2048 lds
buffer_load_dwordx4 v18, s[48:51], s95 offen offset:3072 lds
s_waitcnt vmcnt(8)
ds_read_b64_tr_b16 a[80:81], v224 offset:8192
ds_read_b64_tr_b16 a[82:83], v224 offset:9216
ds_read_b64_tr_b16 a[84:85], v225 offset:8192
ds_read_b64_tr_b16 a[86:87], v225 offset:9216
ds_read_b64_tr_b16 a[88:89], v226 offset:8192
ds_read_b64_tr_b16 a[90:91], v226 offset:9216
ds_read_b64_tr_b16 a[92:93], v227 offset:8192
ds_read_b64_tr_b16 a[94:95], v227 offset:9216
ds_read_b128 a[100:103], v229 offset:512
v_mfma_f32_32x32x16_bf16 v[160:175], a[64:67], a[96:99], v[160:175]
v_mfma_f32_32x32x16_bf16 v[176:191], a[68:71], a[96:99], v[176:191]
v_mfma_f32_32x32x16_bf16 v[192:207], a[72:75], a[96:99], v[192:207]
s_waitcnt lgkmcnt(0)
s_add_u32 s95, s81, 2621440
s_add_u32 m0, s85, 8192
s_nop 0
buffer_load_dwordx4 v15, s[48:51], s95 offen offset:0 lds
buffer_load_dwordx4 v16, s[48:51], s95 offen offset:1024 lds
v_mfma_f32_32x32x16_bf16 v[208:223], a[76:79], a[96:99], v[208:223]
buffer_load_dwordx4 v17, s[48:51], s95 offen offset:2048 lds
buffer_load_dwordx4 v18, s[48:51], s95 offen offset:3072 lds
s_waitcnt vmcnt(8)
ds_read_b64_tr_b16 a[64:65], v224 offset:0
ds_read_b64_tr_b16 a[66:67], v224 offset:1024
ds_read_b64_tr_b16 a[68:69], v225 offset:0
ds_read_b64_tr_b16 a[70:71], v225 offset:1024
ds_read_b64_tr_b16 a[72:73], v226 offset:0
ds_read_b64_tr_b16 a[74:75], v226 offset:1024
ds_read_b64_tr_b16 a[76:77], v227 offset:0
ds_read_b64_tr_b16 a[78:79], v227 offset:1024
ds_read_b128 a[96:99], v230 offset:512
v_mfma_f32_32x32x16_bf16 v[160:175], a[80:83], a[100:103], v[160:175]
v_mfma_f32_32x32x16_bf16 v[176:191], a[84:87], a[100:103], v[176:191]
v_mfma_f32_32x32x16_bf16 v[192:207], a[88:91], a[100:103], v[192:207]
s_waitcnt lgkmcnt(0)
s_add_u32 s95, s81, 2752512
s_add_u32 m0, s85, 0
s_nop 0
buffer_load_dwordx4 v15, s[48:51], s95 offen offset:0 lds
buffer_load_dwordx4 v16, s[48:51], s95 offen offset:1024 lds
v_mfma_f32_32x32x16_bf16 v[208:223], a[92:95], a[100:103], v[208:223]
buffer_load_dwordx4 v17, s[48:51], s95 offen offset:2048 lds
buffer_load_dwordx4 v18, s[48:51], s95 offen offset:3072 lds
s_waitcnt vmcnt(8)
ds_read_b64_tr_b16 a[80:81], v224 offset:4096
ds_read_b64_tr_b16 a[82:83], v224 offset:5120
ds_read_b64_tr_b16 a[84:85], v225 offset:4096
ds_read_b64_tr_b16 a[86:87], v225 offset:5120
ds_read_b64_tr_b16 a[88:89], v226 offset:4096
ds_read_b64_tr_b16 a[90:91], v226 offset:5120
ds_read_b64_tr_b16 a[92:93], v227 offset:4096
ds_read_b64_tr_b16 a[94:95], v227 offset:5120
ds_read_b128 a[100:103], v231 offset:512
v_mfma_f32_32x32x16_bf16 v[160:175], a[64:67], a[96:99], v[160:175]
v_mfma_f32_32x32x16_bf16 v[176:191], a[68:71], a[96:99], v[176:191]
v_mfma_f32_32x32x16_bf16 v[192:207], a[72:75], a[96:99], v[192:207]
s_waitcnt lgkmcnt(0)
s_add_u32 s95, s81, 2883584
s_add_u32 m0, s85, 4096
s_nop 0
buffer_load_dwordx4 v15, s[48:51], s95 offen offset:0 lds
buffer_load_dwordx4 v16, s[48:51], s95 offen offset:1024 lds
v_mfma_f32_32x32x16_bf16 v[208:223], a[76:79], a[96:99], v[208:223]
buffer_load_dwordx4 v17, s[48:51], s95 offen offset:2048 lds
buffer_load_dwordx4 v18, s[48:51], s95 offen offset:3072 lds
s_waitcnt vmcnt(8)
ds_read_b64_tr_b16 a[64:65], v224 offset:8192
ds_read_b64_tr_b16 a[66:67], v224 offset:9216
ds_read_b64_tr_b16 a[68:69], v225 offset:8192
ds_read_b64_tr_b16 a[70:71], v225 offset:9216
ds_read_b64_tr_b16 a[72:73], v226 offset:8192
ds_read_b64_tr_b16 a[74:75], v226 offset:9216
ds_read_b64_tr_b16 a[76:77], v227 offset:8192
ds_read_b64_tr_b16 a[78:79], v227 offset:9216
ds_read_b128 a[96:99], v232 offset:512
v_mfma_f32_32x32x16_bf16 v[160:175], a[80:83], a[100:103], v[160:175]
v_mfma_f32_32x32x16_bf16 v[176:191], a[84:87], a[100:103], v[176:191]
v_mfma_f32_32x32x16_bf16 v[192:207], a[88:91], a[100:103], v[192:207]
s_waitcnt lgkmcnt(0)
s_add_u32 s95, s81, 3014656
s_add_u32 m0, s85, 8192
s_nop 0
buffer_load_dwordx4 v15, s[48:51], s95 offen offset:0 lds
buffer_load_dwordx4 v16, s[48:51], s95 offen offset:1024 lds
v_mfma_f32_32x32x16_bf16 v[208:223], a[92:95], a[100:103], v[208:223]
buffer_load_dwordx4 v17, s[48:51], s95 offen offset:2048 lds
buffer_load_dwordx4 v18, s[48:51], s95 offen offset:3072 lds
s_waitcnt vmcnt(8)
ds_read_b64_tr_b16 a[80:81], v224 offset:0
ds_read_b64_tr_b16 a[82:83], v224 offset:1024
ds_read_b64_tr_b16 a[84:85], v225 offset:0
ds_read_b64_tr_b16 a[86:87], v225 offset:1024
ds_read_b64_tr_b16 a[88:89], v226 offset:0
ds_read_b64_tr_b16 a[90:91], v226 offset:1024
ds_read_b64_tr_b16 a[92:93], v227 offset:0
ds_read_b64_tr_b16 a[94:95], v227 offset:1024
ds_read_b128 a[100:103], v233 offset:512
v_mfma_f32_32x32x16_bf16 v[160:175], a[64:67], a[96:99], v[160:175]
v_mfma_f32_32x32x16_bf16 v[176:191], a[68:71], a[96:99], v[176:191]
v_mfma_f32_32x32x16_bf16 v[192:207], a[72:75], a[96:99], v[192:207]
s_waitcnt lgkmcnt(0)
s_add_u32 s95, s81, 3145728
s_add_u32 m0, s85, 0
s_nop 0
buffer_load_dwordx4 v15, s[48:51], s95 offen offset:0 lds
buffer_load_dwordx4 v16, s[48:51], s95 offen offset:1024 lds
v_mfma_f32_32x32x16_bf16 v[208:223], a[76:79], a[96:99], v[208:223]
buffer_load_dwordx4 v17, s[48:51], s95 offen offset:2048 lds
buffer_load_dwordx4 v18, s[48:51], s95 offen offset:3072 lds
s_waitcnt vmcnt(8)
ds_read_b64_tr_b16 a[64:65], v224 offset:4096
ds_read_b64_tr_b16 a[66:67], v224 offset:5120
ds_read_b64_tr_b16 a[68:69], v225 offset:4096
ds_read_b64_tr_b16 a[70:71], v225 offset:5120
ds_read_b64_tr_b16 a[72:73], v226 offset:4096
ds_read_b64_tr_b16 a[74:75], v226 offset:5120
ds_read_b64_tr_b16 a[76:77], v227 offset:4096
ds_read_b64_tr_b16 a[78:79], v227 offset:5120
ds_read_b128 a[96:99], v234 offset:512
v_mfma_f32_32x32x16_bf16 v[160:175], a[80:83], a[100:103], v[160:175]
v_mfma_f32_32x32x16_bf16 v[176:191], a[84:87], a[100:103], v[176:191]
v_mfma_f32_32x32x16_bf16 v[192:207], a[88:91], a[100:103], v[192:207]
s_waitcnt lgkmcnt(0)
s_add_u32 s95, s81, 3276800
s_add_u32 m0, s85, 4096
s_nop 0
buffer_load_dwordx4 v15, s[48:51], s95 offen offset:0 lds
buffer_load_dwordx4 v16, s[48:51], s95 offen offset:1024 lds
v_mfma_f32_32x32x16_bf16 v[208:223], a[92:95], a[100:103], v[208:223]
buffer_load_dwordx4 v17, s[48:51], s95 offen offset:2048 lds
buffer_load_dwordx4 v18, s[48:51], s95 offen offset:3072 lds
s_waitcnt vmcnt(8)
ds_read_b64_tr_b16 a[80:81], v224 offset:8192
ds_read_b64_tr_b16 a[82:83], v224 offset:9216
ds_read_b64_tr_b16 a[84:85], v225 offset:8192
ds_read_b64_tr_b16 a[86:87], v225 offset:9216
ds_read_b64_tr_b16 a[88:89], v226 offset:8192
ds_read_b64_tr_b16 a[90:91], v226 offset:9216
ds_read_b64_tr_b16 a[92:93], v227 offset:8192
ds_read_b64_tr_b16 a[94:95], v227 offset:9216
ds_read_b128 a[100:103], v235 offset:512
v_mfma_f32_32x32x16_bf16 v[160:175], a[64:67], a[96:99], v[160:175]
v_mfma_f32_32x32x16_bf16 v[176:191], a[68:71], a[96:99], v[176:191]
v_mfma_f32_32x32x16_bf16 v[192:207], a[72:75], a[96:99], v[192:207]
s_waitcnt lgkmcnt(0)
s_add_u32 s95, s81, 3407872
s_add_u32 m0, s85, 8192
s_nop 0
buffer_load_dwordx4 v15, s[48:51], s95 offen offset:0 lds
buffer_load_dwordx4 v16, s[48:51], s95 offen offset:1024 lds
v_mfma_f32_32x32x16_bf16 v[208:223], a[76:79], a[96:99], v[208:223]
buffer_load_dwordx4 v17, s[48:51], s95 offen offset:2048 lds
buffer_load_dwordx4 v18, s[48:51], s95 offen offset:3072 lds
s_waitcnt vmcnt(8)
ds_read_b64_tr_b16 a[64:65], v224 offset:0
ds_read_b64_tr_b16 a[66:67], v224 offset:1024
ds_read_b64_tr_b16 a[68:69], v225 offset:0
ds_read_b64_tr_b16 a[70:71], v225 offset:1024
ds_read_b64_tr_b16 a[72:73], v226 offset:0
ds_read_b64_tr_b16 a[74:75], v226 offset:1024
ds_read_b64_tr_b16 a[76:77], v227 offset:0
ds_read_b64_tr_b16 a[78:79], v227 offset:1024
ds_read_b128 a[96:99], v228 offset:768
v_mfma_f32_32x32x16_bf16 v[160:175], a[80:83], a[100:103], v[160:175]
v_mfma_f32_32x32x16_bf16 v[176:191], a[84:87], a[100:103], v[176:191]
v_mfma_f32_32x32x16_bf16 v[192:207], a[88:91], a[100:103], v[192:207]
s_waitcnt lgkmcnt(0)
s_add_u32 s95, s81, 3538944
s_add_u32 m0, s85, 0
s_nop 0
buffer_load_dwordx4 v15, s[48:51], s95 offen offset:0 lds
buffer_load_dwordx4 v16, s[48:51], s95 offen offset:1024 lds
v_mfma_f32_32x32x16_bf16 v[208:223], a[92:95], a[100:103], v[208:223]
buffer_load_dwordx4 v17, s[48:51], s95 offen offset:2048 lds
buffer_load_dwordx4 v18, s[48:51], s95 offen offset:3072 lds
s_waitcnt vmcnt(8)
ds_read_b64_tr_b16 a[80:81], v224 offset:4096
ds_read_b64_tr_b16 a[82:83], v224 offset:5120
ds_read_b64_tr_b16 a[84:85], v225 offset:4096
ds_read_b64_tr_b16 a[86:87], v225 offset:5120
ds_read_b64_tr_b16 a[88:89], v226 offset:4096
ds_read_b64_tr_b16 a[90:91], v226 offset:5120
ds_read_b64_tr_b16 a[92:93], v227 offset:4096
ds_read_b64_tr_b16 a[94:95], v227 offset:5120
ds_read_b128 a[100:103], v229 offset:768
v_mfma_f32_32x32x16_bf16 v[160:175], a[64:67], a[96:99], v[160:175]
v_mfma_f32_32x32x16_bf16 v[176:191], a[68:71], a[96:99], v[176:191]
v_mfma_f32_32x32x16_bf16 v[192:207], a[72:75], a[96:99], v[192:207]
s_waitcnt lgkmcnt(0)
s_add_u32 s95, s81, 3670016
s_add_u32 m0, s85, 4096
s_nop 0
buffer_load_dwordx4 v15, s[48:51], s95 offen offset:0 lds
buffer_load_dwordx4 v16, s[48:51], s95 offen offset:1024 lds
v_mfma_f32_32x32x16_bf16 v[208:223], a[76:79], a[96:99], v[208:223]
buffer_load_dwordx4 v17, s[48:51], s95 offen offset:2048 lds
buffer_load_dwordx4 v18, s[48:51], s95 offen offset:3072 lds
s_waitcnt vmcnt(8)
ds_read_b64_tr_b16 a[64:65], v224 offset:8192
ds_read_b64_tr_b16 a[66:67], v224 offset:9216
ds_read_b64_tr_b16 a[68:69], v225 offset:8192
ds_read_b64_tr_b16 a[70:71], v225 offset:9216
ds_read_b64_tr_b16 a[72:73], v226 offset:8192
ds_read_b64_tr_b16 a[74:75], v226 offset:9216
ds_read_b64_tr_b16 a[76:77], v227 offset:8192
ds_read_b64_tr_b16 a[78:79], v227 offset:9216
ds_read_b128 a[96:99], v230 offset:768
v_mfma_f32_32x32x16_bf16 v[160:175], a[80:83], a[100:103], v[160:175]
v_mfma_f32_32x32x16_bf16 v[176:191], a[84:87], a[100:103], v[176:191]
v_mfma_f32_32x32x16_bf16 v[192:207], a[88:91], a[100:103], v[192:207]
s_waitcnt lgkmcnt(0)
s_add_u32 s95, s81, 3801088
s_add_u32 m0, s85, 8192
s_nop 0
buffer_load_dwordx4 v15, s[48:51], s95 offen offset:0 lds
buffer_load_dwordx4 v16, s[48:51], s95 offen offset:1024 lds
v_mfma_f32_32x32x16_bf16 v[208:223], a[92:95], a[100:103], v[208:223]
buffer_load_dwordx4 v17, s[48:51], s95 offen offset:2048 lds
buffer_load_dwordx4 v18, s[48:51], s95 offen offset:3072 lds
s_waitcnt vmcnt(8)
ds_read_b64_tr_b16 a[80:81], v224 offset:0
ds_read_b64_tr_b16 a[82:83], v224 offset:1024
ds_read_b64_tr_b16 a[84:85], v225 offset:0
ds_read_b64_tr_b16 a[86:87], v225 offset:1024
ds_read_b64_tr_b16 a[88:89], v226 offset:0
ds_read_b64_tr_b16 a[90:91], v226 offset:1024
ds_read_b64_tr_b16 a[92:93], v227 offset:0
ds_read_b64_tr_b16 a[94:95], v227 offset:1024
ds_read_b128 a[100:103], v231 offset:768
v_mfma_f32_32x32x16_bf16 v[160:175], a[64:67], a[96:99], v[160:175]
v_mfma_f32_32x32x16_bf16 v[176:191], a[68:71], a[96:99], v[176:191]
v_mfma_f32_32x32x16_bf16 v[192:207], a[72:75], a[96:99], v[192:207]
s_waitcnt lgkmcnt(0)
s_add_u32 s95, s81, 3932160
s_add_u32 m0, s85, 0
s_nop 0
buffer_load_dwordx4 v15, s[48:51], s95 offen offset:0 lds
buffer_load_dwordx4 v16, s[48:51], s95 offen offset:1024 lds
v_mfma_f32_32x32x16_bf16 v[208:223], a[76:79], a[96:99], v[208:223]
buffer_load_dwordx4 v17, s[48:51], s95 offen offset:2048 lds
buffer_load_dwordx4 v18, s[48:51], s95 offen offset:3072 lds
s_waitcnt vmcnt(8)
ds_read_b64_tr_b16 a[64:65], v224 offset:4096
ds_read_b64_tr_b16 a[66:67], v224 offset:5120
ds_read_b64_tr_b16 a[68:69], v225 offset:4096
ds_read_b64_tr_b16 a[70:71], v225 offset:5120
ds_read_b64_tr_b16 a[72:73], v226 offset:4096
ds_read_b64_tr_b16 a[74:75], v226 offset:5120
ds_read_b64_tr_b16 a[76:77], v227 offset:4096
ds_read_b64_tr_b16 a[78:79], v227 offset:5120
ds_read_b128 a[96:99], v232 offset:768
v_mfma_f32_32x32x16_bf16 v[160:175], a[80:83], a[100:103], v[160:175]
v_mfma_f32_32x32x16_bf16 v[176:191], a[84:87], a[100:103], v[176:191]
v_mfma_f32_32x32x16_bf16 v[192:207], a[88:91], a[100:103], v[192:207]
s_waitcnt lgkmcnt(0)
s_add_u32 s95, s81, 4063232
s_add_u32 m0, s85, 4096
s_nop 0
buffer_load_dwordx4 v15, s[48:51], s95 offen offset:0 lds
buffer_load_dwordx4 v16, s[48:51], s95 offen offset:1024 lds
v_mfma_f32_32x32x16_bf16 v[208:223], a[92:95], a[100:103], v[208:223]
buffer_load_dwordx4 v17, s[48:51], s95 offen offset:2048 lds
buffer_load_dwordx4 v18, s[48:51], s95 offen offset:3072 lds
s_waitcnt vmcnt(8)
ds_read_b64_tr_b16 a[80:81], v224 offset:8192
ds_read_b64_tr_b16 a[82:83], v224 offset:9216
ds_read_b64_tr_b16 a[84:85], v225 offset:8192
ds_read_b64_tr_b16 a[86:87], v225 offset:9216
ds_read_b64_tr_b16 a[88:89], v226 offset:8192
ds_read_b64_tr_b16 a[90:91], v226 offset:9216
ds_read_b64_tr_b16 a[92:93], v227 offset:8192
ds_read_b64_tr_b16 a[94:95], v227 offset:9216
ds_read_b128 a[100:103], v233 offset:768
v_mfma_f32_32x32x16_bf16 v[160:175], a[64:67], a[96:99], v[160:175]
v_mfma_f32_32x32x16_bf16 v[176:191], a[68:71], a[96:99], v[176:191]
v_mfma_f32_32x32x16_bf16 v[192:207], a[72:75], a[96:99], v[192:207]
s_waitcnt lgkmcnt(0)
s_lshl_b32 s92, s30, 7
v_xor_b32 v15, s92, v6
v_xor_b32 v18, 64, v15
s_add_u32 s95, s3, 0
s_and_b32 s95, s95, 3
s_lshl_b32 s95, s95, 14
s_add_u32 s95, s95, s96
s_add_u32 s95, s95, 4259840
s_add_u32 m0, s31, 0
s_nop 0
buffer_load_dwordx4 v6, s[60:63], s95 offen offset:0 nt lds
v_mfma_f32_32x32x16_bf16 v[208:223], a[76:79], a[96:99], v[208:223]
buffer_load_dwordx4 v7, s[60:63], s95 offen offset:1024 nt lds
buffer_load_dwordx4 v8, s[60:63], s95 offen offset:2048 nt lds
s_waitcnt vmcnt(7)
ds_read_b64_tr_b16 a[64:65], v224 offset:0
ds_read_b64_tr_b16 a[66:67], v224 offset:1024
ds_read_b64_tr_b16 a[68:69], v225 offset:0
ds_read_b64_tr_b16 a[70:71], v225 offset:1024
ds_read_b64_tr_b16 a[72:73], v226 offset:0
ds_read_b64_tr_b16 a[74:75], v226 offset:1024
ds_read_b64_tr_b16 a[76:77], v227 offset:0
ds_read_b64_tr_b16 a[78:79], v227 offset:1024
ds_read_b128 a[96:99], v234 offset:768
v_mfma_f32_32x32x16_bf16 v[160:175], a[80:83], a[100:103], v[160:175]
v_mfma_f32_32x32x16_bf16 v[176:191], a[84:87], a[100:103], v[176:191]
v_mfma_f32_32x32x16_bf16 v[192:207], a[88:91], a[100:103], v[192:207]
s_waitcnt lgkmcnt(0)
buffer_load_dwordx4 v9, s[60:63], s95 offen offset:3072 nt lds
s_add_u32 s95, s95, 4096
s_add_u32 m0, s31, 4096
s_nop 0
buffer_load_dwordx4 v6, s[60:63], s95 offen offset:0 nt lds
v_mfma_f32_32x32x16_bf16 v[208:223], a[92:95], a[100:103], v[208:223]
buffer_load_dwordx4 v7, s[60:63], s95 offen offset:1024 nt lds
buffer_load_dwordx4 v8, s[60:63], s95 offen offset:2048 nt lds
s_waitcnt vmcnt(7)
ds_read_b64_tr_b16 a[80:81], v224 offset:4096
ds_read_b64_tr_b16 a[82:83], v224 offset:5120
ds_read_b64_tr_b16 a[84:85], v225 offset:4096
ds_read_b64_tr_b16 a[86:87], v225 offset:5120
ds_read_b64_tr_b16 a[88:89], v226 offset:4096
ds_read_b64_tr_b16 a[90:91], v226 offset:5120
ds_read_b64_tr_b16 a[92:93], v227 offset:4096
ds_read_b64_tr_b16 a[94:95], v227 offset:5120
ds_read_b128 a[100:103], v235 offset:768
v_mfma_f32_32x32x16_bf16 v[160:175], a[64:67], a[96:99], v[160:175]
v_mfma_f32_32x32x16_bf16 v[176:191], a[68:71], a[96:99], v[176:191]
v_mfma_f32_32x32x16_bf16 v[192:207], a[72:75], a[96:99], v[192:207]
s_waitcnt lgkmcnt(0)
buffer_load_dwordx4 v9, s[60:63], s95 offen offset:3072 nt lds
s_add_u32 s95, s3, 1
s_and_b32 s95, s95, 3
s_lshl_b32 s95, s95, 14
s_add_u32 s95, s95, s96
s_add_u32 s95, s95, 4259840
s_add_u32 m0, s31, 8192
s_nop 0
buffer_load_dwordx4 v6, s[60:63], s95 offen offset:0 nt lds
v_mfma_f32_32x32x16_bf16 v[208:223], a[76:79], a[96:99], v[208:223]
buffer_load_dwordx4 v7, s[60:63], s95 offen offset:1024 nt lds
buffer_load_dwordx4 v8, s[60:63], s95 offen offset:2048 nt lds
buffer_load_dwordx4 v9, s[60:63], s95 offen offset:3072 nt lds
s_add_u32 s95, s95, 4096
s_add_u32 m0, s31, 12288
s_nop 0
buffer_load_dwordx4 v6, s[60:63], s95 offen offset:0 nt lds
v_mfma_f32_32x32x16_bf16 v[160:175], a[80:83], a[100:103], v[160:175]
buffer_load_dwordx4 v7, s[60:63], s95 offen offset:1024 nt lds
buffer_load_dwordx4 v8, s[60:63], s95 offen offset:2048 nt lds
v_mfma_f32_32x32x16_bf16 v[176:191], a[84:87], a[100:103], v[176:191]
buffer_load_dwordx4 v9, s[60:63], s95 offen offset:3072 nt lds
v_mfma_f32_32x32x16_bf16 v[192:207], a[88:91], a[100:103], v[192:207]
v_mfma_f32_32x32x16_bf16 v[208:223], a[92:95], a[100:103], v[208:223]
s_nop 5
v_cvt_pk_bf16_f32 v32, v160, v161
v_cvt_pk_bf16_f32 v33, v162, v163
v_cvt_pk_bf16_f32 v34, v164, v165
v_cvt_pk_bf16_f32 v35, v166, v167
v_cvt_pk_bf16_f32 v36, v168, v169
v_cvt_pk_bf16_f32 v37, v170, v171
v_cvt_pk_bf16_f32 v38, v172, v173
v_cvt_pk_bf16_f32 v39, v174, v175
v_cvt_pk_bf16_f32 v40, v176, v177
v_cvt_pk_bf16_f32 v41, v178, v179
v_cvt_pk_bf16_f32 v42, v180, v181
v_cvt_pk_bf16_f32 v43, v182, v183
v_cvt_pk_bf16_f32 v44, v184, v185
v_cvt_pk_bf16_f32 v45, v186, v187
v_cvt_pk_bf16_f32 v46, v188, v189
v_cvt_pk_bf16_f32 v47, v190, v191
v_cvt_pk_bf16_f32 v48, v192, v193
v_cvt_pk_bf16_f32 v49, v194, v195
v_cvt_pk_bf16_f32 v50, v196, v197
v_cvt_pk_bf16_f32 v51, v198, v199
v_cvt_pk_bf16_f32 v52, v200, v201
v_cvt_pk_bf16_f32 v53, v202, v203
v_cvt_pk_bf16_f32 v54, v204, v205
v_cvt_pk_bf16_f32 v55, v206, v207
v_cvt_pk_bf16_f32 v56, v208, v209
v_cvt_pk_bf16_f32 v57, v210, v211
v_cvt_pk_bf16_f32 v58, v212, v213
v_cvt_pk_bf16_f32 v59, v214, v215
v_cvt_pk_bf16_f32 v60, v216, v217
v_cvt_pk_bf16_f32 v61, v218, v219
v_cvt_pk_bf16_f32 v62, v220, v221
v_cvt_pk_bf16_f32 v63, v222, v223
v_accvgpr_write_b32 a128, v32
v_accvgpr_write_b32 a129, v33
v_accvgpr_write_b32 a130, v34
v_accvgpr_write_b32 a131, v35
v_accvgpr_write_b32 a132, v36
v_accvgpr_write_b32 a133, v37
v_accvgpr_write_b32 a134, v38
v_accvgpr_write_b32 a135, v39
v_accvgpr_write_b32 a136, v40
v_accvgpr_write_b32 a137, v41
v_accvgpr_write_b32 a138, v42
v_accvgpr_write_b32 a139, v43
v_accvgpr_write_b32 a140, v44
v_accvgpr_write_b32 a141, v45
v_accvgpr_write_b32 a142, v46
v_accvgpr_write_b32 a143, v47
v_accvgpr_write_b32 a144, v48
v_accvgpr_write_b32 a145, v49
v_accvgpr_write_b32 a146, v50
v_accvgpr_write_b32 a147, v51
v_accvgpr_write_b32 a148, v52
v_accvgpr_write_b32 a149, v53
v_accvgpr_write_b32 a150, v54
v_accvgpr_write_b32 a151, v55
v_accvgpr_write_b32 a152, v56
v_accvgpr_write_b32 a153, v57
v_accvgpr_write_b32 a154, v58
v_accvgpr_write_b32 a155, v59
v_accvgpr_write_b32 a156, v60
v_accvgpr_write_b32 a157, v61
v_accvgpr_write_b32 a158, v62
v_accvgpr_write_b32 a159, v63
s_mov_b32 s93, 0
L_pollE0:
v_readfirstlane_b32 s100, v100
v_readfirstlane_b32 s101, v101
s_nop 0
s_cmp_lg_u32 s100, 0
s_cbranch_scc1 L_polledE0
s_add_u32 s93, s93, 1
s_cmp_ge_u32 s93, 400000
s_cbranch_scc1 L_polledE0
s_sleep 8
buffer_load_dwordx2 v[100:101], v102, s[32:35], 0 offen sc1
s_waitcnt vmcnt(0)
s_branch L_pollE0
L_polledE0:
s_lshl_b32 s89, s26, 3
s_add_u32 s89, s89, s99
v_and_b32 v98, 0, v0
v_lshlrev_b32 v98, 3, v98
buffer_load_dwordx2 v[96:97], v98, s[76:79], s89 offen offset:0 sc1
s_waitcnt vmcnt(0)
s_mov_b32 s93, 0
L_pollAq:
v_cmp_ne_u64 vcc, s[100:101], v[96:97]
s_nop 1
s_cmp_eq_u64 vcc, 0
s_cbranch_scc1 L_polledAq
s_add_u32 s93, s93, 1
s_cmp_ge_u32 s93, 400000
s_cbranch_scc1 L_polledAq
s_sleep 4
buffer_load_dwordx2 v[96:97], v98, s[76:79], s89 offen offset:0 sc1
s_waitcnt vmcnt(0)
s_branch L_pollAq
L_polledAq:
s_lshl_b32 s92, s97, 14
s_lshl_b32 s93, s26, 12
s_add_u32 s92, s92, s93
s_add_u32 s92, s92, 16777216
buffer_load_dwordx4 v[104:107], v1, s[76:79], s92 offen offset:0 sc1
buffer_load_dwordx4 v[108:111], v1, s[76:79], s92 offen offset:1024 sc1
buffer_load_dwordx4 v[112:115], v1, s[76:79], s92 offen offset:2048 sc1
buffer_load_dwordx4 v[116:119], v1, s[76:79], s92 offen offset:3072 sc1
s_lshl_b32 s93, s26, 12
s_add_u32 s93, s93, 147456
v_add_u32 v31, s93, v1
s_waitcnt vmcnt(0)
ds_write_b128 v31, v[104:107] offset:0
ds_write_b128 v31, v[108:111] offset:1024
ds_write_b128 v31, v[112:115] offset:2048
ds_write_b128 v31, v[116:119] offset:3072
s_waitcnt lgkmcnt(0)
s_barrier
s_lshl_b32 s93, s30, 13
s_add_u32 s93, s93, 147456
v_add_u32 v31, s93, v1
ds_read_b128 v[192:195], v31 offset:0
ds_read_b128 v[196:199], v31 offset:1024
ds_read_b128 v[200:203], v31 offset:2048
ds_read_b128 v[204:207], v31 offset:3072
ds_read_b128 v[208:211], v31 offset:4096
ds_read_b128 v[212:215], v31 offset:5120
ds_read_b128 v[216:219], v31 offset:6144
ds_read_b128 v[220:223], v31 offset:7168
v_add_u32 v19, s31, v2
v_xor_b32 v20, 32, v19
v_xor_b32 v21, 64, v19
v_xor_b32 v22, 96, v19
v_xor_b32 v23, 128, v19
v_xor_b32 v24, 160, v19
v_xor_b32 v25, 192, v19
v_xor_b32 v26, 224, v19
s_waitcnt lgkmcnt(0)
ds_read_b128 v[224:227], v19 offset:0
ds_read_b128 v[228:231], v20 offset:0
ds_read_b128 v[232:235], v21 offset:0
ds_read_b128 v[236:239], v22 offset:0
ds_read_b128 v[240:243], v23 offset:0
ds_read_b128 v[244:247], v24 offset:0
ds_read_b128 v[248:251], v25 offset:0
ds_read_b128 v[252:255], v26 offset:0
s_waitcnt lgkmcnt(0)
s_add_u32 s95, s3, 2
s_and_b32 s95, s95, 3
s_lshl_b32 s95, s95, 14
s_add_u32 s95, s95, s96
s_add_u32 s95, s95, 4259840
s_add_u32 m0, s31, 0
s_nop 0
buffer_load_dwordx4 v6, s[60:63], s95 offen offset:0 nt lds
v_mfma_f32_32x32x16_bf16 v[32:47], v[224:227], v[192:195], 0
buffer_load_dwordx4 v7, s[60:63], s95 offen offset:1024 nt lds
v_mfma_f32_32x32x16_bf16 v[32:47], v[228:231], v[196:199], v[32:47]
buffer_load_dwordx4 v8, s[60:63], s95 offen offset:2048 nt lds
v_mfma_f32_32x32x16_bf16 v[32:47], v[232:235], v[200:203], v[32:47]
buffer_load_dwordx4 v9, s[60:63], s95 offen offset:3072 nt lds
v_mfma_f32_32x32x16_bf16 v[32:47], v[236:239], v[204:207], v[32:47]
s_add_u32 s95, s95, 4096
s_add_u32 m0, s31, 4096
s_nop 0
buffer_load_dwordx4 v6, s[60:63], s95 offen offset:0 nt lds
v_mfma_f32_32x32x16_bf16 v[32:47], v[240:243], v[208:211], v[32:47]
buffer_load_dwordx4 v7, s[60:63], s95 offen offset:1024 nt lds
v_mfma_f32_32x32x16_bf16 v[32:47], v[244:247], v[212:215], v[32:47]
buffer_load_dwordx4 v8, s[60:63], s95 offen offset:2048 nt lds
v_mfma_f32_32x32x16_bf16 v[32:47], v[248:251], v[216:219], v[32:47]
buffer_load_dwordx4 v9, s[60:63], s95 offen offset:3072 nt lds
v_mfma_f32_32x32x16_bf16 v[32:47], v[252:255], v[220:223], v[32:47]
ds_read_b128 v[224:227], v19 offset:8192
ds_read_b128 v[228:231], v20 offset:8192
ds_read_b128 v[232:235], v21 offset:8192
ds_read_b128 v[236:239], v22 offset:8192
ds_read_b128 v[240:243], v23 offset:8192
ds_read_b128 v[244:247], v24 offset:8192
ds_read_b128 v[248:251], v25 offset:8192
ds_read_b128 v[252:255], v26 offset:8192
s_nop 3
v_max_f32 v27, v32, v33
v_max3_f32 v27, v27, v34, v35
v_max3_f32 v27, v27, v36, v37
v_max3_f32 v27, v27, v38, v39
v_max3_f32 v27, v27, v40, v41
v_max3_f32 v27, v27, v42, v43
v_max3_f32 v27, v27, v44, v45
v_max3_f32 v27, v27, v46, v47
s_waitcnt lgkmcnt(0)
s_add_u32 s95, s3, 3
s_and_b32 s95, s95, 3
s_lshl_b32 s95, s95, 14
s_add_u32 s95, s95, s96
s_add_u32 s95, s95, 4259840
s_add_u32 m0, s31, 8192
s_nop 0
buffer_load_dwordx4 v6, s[60:63], s95 offen offset:0 nt lds
v_mfma_f32_32x32x16_bf16 v[48:63], v[224:227], v[192:195], 0
buffer_load_dwordx4 v7, s[60:63], s95 offen offset:1024 nt lds
v_mfma_f32_32x32x16_bf16 v[48:63], v[228:231], v[196:199], v[48:63]
buffer_load_dwordx4 v8, s[60:63], s95 offen offset:2048 nt lds
v_mfma_f32_32x32x16_bf16 v[48:63], v[232:235], v[200:203], v[48:63]
buffer_load_dwordx4 v9, s[60:63], s95 offen offset:3072 nt lds
v_mfma_f32_32x32x16_bf16 v[48:63], v[236:239], v[204:207], v[48:63]
s_add_u32 s95, s95, 4096
s_add_u32 m0, s31, 12288
s_nop 0
buffer_load_dwordx4 v6, s[60:63], s95 offen offset:0 nt lds
v_mfma_f32_32x32x16_bf16 v[48:63], v[240:243], v[208:211], v[48:63]
buffer_load_dwordx4 v7, s[60:63], s95 offen offset:1024 nt lds
v_mfma_f32_32x32x16_bf16 v[48:63], v[244:247], v[212:215], v[48:63]
buffer_load_dwordx4 v8, s[60:63], s95 offen offset:2048 nt lds
v_mfma_f32_32x32x16_bf16 v[48:63], v[248:251], v[216:219], v[48:63]
buffer_load_dwordx4 v9, s[60:63], s95 offen offset:3072 nt lds
v_mfma_f32_32x32x16_bf16 v[48:63], v[252:255], v[220:223], v[48:63]
s_waitcnt vmcnt(8)
ds_read_b128 v[224:227], v19 offset:0
ds_read_b128 v[228:231], v20 offset:0
ds_read_b128 v[232:235], v21 offset:0
ds_read_b128 v[236:239], v22 offset:0
ds_read_b128 v[240:243], v23 offset:0
ds_read_b128 v[244:247], v24 offset:0
ds_read_b128 v[248:251], v25 offset:0
ds_read_b128 v[252:255], v26 offset:0
s_nop 2
v_max3_f32 v27, v27, v48, v49
v_max3_f32 v27, v27, v50, v51
v_max3_f32 v27, v27, v52, v53
v_max3_f32 v27, v27, v54, v55
v_max3_f32 v27, v27, v56, v57
v_max3_f32 v27, v27, v58, v59
v_max3_f32 v27, v27, v60, v61
v_max3_f32 v27, v27, v62, v63
s_waitcnt lgkmcnt(0)
s_add_u32 s95, s3, 0
s_and_b32 s95, s95, 3
s_lshl_b32 s95, s95, 14
s_add_u32 s95, s95, s96
s_add_u32 s95, s95, 4259840
s_add_u32 m0, s31, 0
s_nop 0
buffer_load_dwordx4 v10, s[64:67], s95 offen offset:0 nt lds
v_mfma_f32_32x32x16_bf16 v[64:79], v[224:227], v[192:195], 0
buffer_load_dwordx4 v10, s[64:67], s95 offen offset:1024 nt lds
v_mfma_f32_32x32x16_bf16 v[64:79], v[228:231], v[196:199], v[64:79]
buffer_load_dwordx4 v10, s[64:67], s95 offen offset:2048 nt lds
v_mfma_f32_32x32x16_bf16 v[64:79], v[232:235], v[200:203], v[64:79]
buffer_load_dwordx4 v10, s[64:67], s95 offen offset:3072 nt lds
v_mfma_f32_32x32x16_bf16 v[64:79], v[236:239], v[204:207], v[64:79]
s_add_u32 s95, s95, 4096
s_add_u32 m0, s31, 4096
s_nop 0
buffer_load_dwordx4 v10, s[64:67], s95 offen offset:0 nt lds
v_mfma_f32_32x32x16_bf16 v[64:79], v[240:243], v[208:211], v[64:79]
buffer_load_dwordx4 v10, s[64:67], s95 offen offset:1024 nt lds
v_mfma_f32_32x32x16_bf16 v[64:79], v[244:247], v[212:215], v[64:79]
buffer_load_dwordx4 v10, s[64:67], s95 offen offset:2048 nt lds
v_mfma_f32_32x32x16_bf16 v[64:79], v[248:251], v[216:219], v[64:79]
buffer_load_dwordx4 v10, s[64:67], s95 offen offset:3072 nt lds
v_mfma_f32_32x32x16_bf16 v[64:79], v[252:255], v[220:223], v[64:79]
s_waitcnt vmcnt(8)
ds_read_b128 v[224:227], v19 offset:8192
ds_read_b128 v[228:231], v20 offset:8192
ds_read_b128 v[232:235], v21 offset:8192
ds_read_b128 v[236:239], v22 offset:8192
ds_read_b128 v[240:243], v23 offset:8192
ds_read_b128 v[244:247], v24 offset:8192
ds_read_b128 v[248:251], v25 offset:8192
ds_read_b128 v[252:255], v26 offset:8192
s_nop 2
v_max3_f32 v27, v27, v64, v65
v_max3_f32 v27, v27, v66, v67
v_max3_f32 v27, v27, v68, v69
v_max3_f32 v27, v27, v70, v71
v_max3_f32 v27, v27, v72, v73
v_max3_f32 v27, v27, v74, v75
v_max3_f32 v27, v27, v76, v77
v_max3_f32 v27, v27, v78, v79
s_waitcnt lgkmcnt(0)
s_add_u32 s95, s3, 1
s_and_b32 s95, s95, 3
s_lshl_b32 s95, s95, 14
s_add_u32 s95, s95, s96
s_add_u32 s95, s95, 4259840
s_add_u32 m0, s31, 8192
s_nop 0
buffer_load_dwordx4 v10, s[64:67], s95 offen offset:0 nt lds
v_mfma_f32_32x32x16_bf16 v[80:95], v[224:227], v[192:195], 0
buffer_load_dwordx4 v10, s[64:67], s95 offen offset:1024 nt lds
v_mfma_f32_32x32x16_bf16 v[80:95], v[228:231], v[196:199], v[80:95]
buffer_load_dwordx4 v10, s[64:67], s95 offen offset:2048 nt lds
v_mfma_f32_32x32x16_bf16 v[80:95], v[232:235], v[200:203], v[80:95]
buffer_load_dwordx4 v10, s[64:67], s95 offen offset:3072 nt lds
v_mfma_f32_32x32x16_bf16 v[80:95], v[236:239], v[204:207], v[80:95]
s_add_u32 s95, s95, 4096
s_add_u32 m0, s31, 12288
s_nop 0
buffer_load_dwordx4 v10, s[64:67], s95 offen offset:0 nt lds
v_mfma_f32_32x32x16_bf16 v[80:95], v[240:243], v[208:211], v[80:95]
buffer_load_dwordx4 v10, s[64:67], s95 offen offset:1024 nt lds
v_mfma_f32_32x32x16_bf16 v[80:95], v[244:247], v[212:215], v[80:95]
buffer_load_dwordx4 v10, s[64:67], s95 offen offset:2048 nt lds
v_mfma_f32_32x32x16_bf16 v[80:95], v[248:251], v[216:219], v[80:95]
buffer_load_dwordx4 v10, s[64:67], s95 offen offset:3072 nt lds
v_mfma_f32_32x32x16_bf16 v[80:95], v[252:255], v[220:223], v[80:95]
s_lshl_b32 s93, s29, 7
v_xor_b32 v31, s93, v3
v_add_u32 v19, s31, v31
v_xor_b32 v20, 64, v19
v_xor_b32 v21, 128, v19
v_xor_b32 v22, 192, v19
s_nop 5
v_max3_f32 v27, v27, v80, v81
v_max3_f32 v27, v27, v82, v83
v_max3_f32 v27, v27, v84, v85
v_max3_f32 v27, v27, v86, v87
v_max3_f32 v27, v27, v88, v89
v_max3_f32 v27, v27, v90, v91
v_max3_f32 v27, v27, v92, v93
v_max3_f32 v27, v27, v94, v95
v_mov_b32 v31, v27
s_nop 1
v_permlane32_swap_b32 v27, v31
v_max_f32 v27, v27, v31
v_mul_f32 v28, s91, v27
v_sub_f32 v28, 0, v28
v_mov_b32 v29, 0
v_mov_b32 v30, 0
v_fma_f32 v32, v32, s91, v28
v_fma_f32 v33, v33, s91, v28
v_fma_f32 v34, v34, s91, v28
v_fma_f32 v35, v35, s91, v28
v_fma_f32 v36, v36, s91, v28
v_fma_f32 v37, v37, s91, v28
v_fma_f32 v38, v38, s91, v28
v_fma_f32 v39, v39, s91, v28
v_fma_f32 v40, v40, s91, v28
v_fma_f32 v41, v41, s91, v28
v_fma_f32 v42, v42, s91, v28
v_fma_f32 v43, v43, s91, v28
v_fma_f32 v44, v44, s91, v28
v_fma_f32 v45, v45, s91, v28
v_fma_f32 v46, v46, s91, v28
v_fma_f32 v47, v47, s91, v28
v_exp_f32 v32, v32
v_exp_f32 v33, v33
v_exp_f32 v34, v34
v_exp_f32 v35, v35
v_exp_f32 v36, v36
v_exp_f32 v37, v37
v_exp_f32 v38, v38
v_exp_f32 v39, v39
v_exp_f32 v40, v40
v_exp_f32 v41, v41
v_exp_f32 v42, v42
v_exp_f32 v43, v43
v_exp_f32 v44, v44
v_exp_f32 v45, v45
v_exp_f32 v46, v46
v_exp_f32 v47, v47
v_add_f32 v29, v29, v32
v_add_f32 v30, v30, v33
v_add_f32 v29, v29, v34
v_add_f32 v30, v30, v35
v_add_f32 v29, v29, v36
v_add_f32 v30, v30, v37
v_add_f32 v29, v29, v38
v_add_f32 v30, v30, v39
v_add_f32 v29, v29, v40
v_add_f32 v30, v30, v41
v_add_f32 v29, v29, v42
v_add_f32 v30, v30, v43
v_add_f32 v29, v29, v44
v_add_f32 v30, v30, v45
v_add_f32 v29, v29, v46
v_add_f32 v30, v30, v47
v_cvt_pk_bf16_f32 v32, v32, v33
v_cvt_pk_bf16_f32 v33, v34, v35
v_cvt_pk_bf16_f32 v34, v36, v37
v_cvt_pk_bf16_f32 v35, v38, v39
v_cvt_pk_bf16_f32 v36, v40, v41
v_cvt_pk_bf16_f32 v37, v42, v43
v_cvt_pk_bf16_f32 v38, v44, v45
v_cvt_pk_bf16_f32 v39, v46, v47
s_waitcnt vmcnt(8)
ds_read_b64_tr_b16 v[224:225], v19 offset:0
ds_read_b64_tr_b16 v[226:227], v19 offset:2048
ds_read_b64_tr_b16 v[228:229], v19 offset:4096
ds_read_b64_tr_b16 v[230:231], v19 offset:6144
ds_read_b64_tr_b16 v[232:233], v20 offset:0
ds_read_b64_tr_b16 v[234:235], v20 offset:2048
ds_read_b64_tr_b16 v[236:237], v20 offset:4096
ds_read_b64_tr_b16 v[238:239], v20 offset:6144
ds_read_b64_tr_b16 v[240:241], v21 offset:0
ds_read_b64_tr_b16 v[242:243], v21 offset:2048
ds_read_b64_tr_b16 v[244:245], v21 offset:4096
ds_read_b64_tr_b16 v[246:247], v21 offset:6144
ds_read_b64_tr_b16 v[248:249], v22 offset:0
ds_read_b64_tr_b16 v[250:251], v22 offset:2048
ds_read_b64_tr_b16 v[252:253], v22 offset:4096
ds_read_b64_tr_b16 v[254:255], v22 offset:6144
v_fma_f32 v48, v48, s91, v28
v_fma_f32 v49, v49, s91, v28
v_fma_f32 v50, v50, s91, v28
v_fma_f32 v51, v51, s91, v28
v_fma_f32 v52, v52, s91, v28
v_fma_f32 v53, v53, s91, v28
v_fma_f32 v54, v54, s91, v28
v_fma_f32 v55, v55, s91, v28
v_fma_f32 v56, v56, s91, v28
v_fma_f32 v57, v57, s91, v28
v_fma_f32 v58, v58, s91, v28
v_fma_f32 v59, v59, s91, v28
v_fma_f32 v60, v60, s91, v28
v_fma_f32 v61, v61, s91, v28
v_fma_f32 v62, v62, s91, v28
v_fma_f32 v63, v63, s91, v28
s_waitcnt lgkmcnt(0)
s_add_u32 s95, s3, 2
s_and_b32 s95, s95, 3
s_lshl_b32 s95, s95, 14
s_add_u32 s95, s95, s96
s_add_u32 s95, s95, 4259840
s_add_u32 m0, s31, 0
s_nop 0
buffer_load_dwordx4 v10, s[64:67], s95 offen offset:0 nt lds
v_mfma_f32_32x32x16_bf16 v[160:175], v[224:227], v[32:35], 0
v_exp_f32 v48, v48
v_exp_f32 v49, v49
v_exp_f32 v50, v50
v_exp_f32 v51, v51
v_exp_f32 v52, v52
buffer_load_dwordx4 v10, s[64:67], s95 offen offset:1024 nt lds
v_mfma_f32_32x32x16_bf16 v[176:191], v[232:235], v[32:35], 0
v_exp_f32 v53, v53
v_exp_f32 v54, v54
v_exp_f32 v55, v55
v_exp_f32 v56, v56
v_exp_f32 v57, v57
buffer_load_dwordx4 v10, s[64:67], s95 offen offset:2048 nt lds
v_mfma_f32_32x32x16_bf16 v[192:207], v[240:243], v[32:35], 0
v_exp_f32 v58, v58
v_exp_f32 v59, v59
v_exp_f32 v60, v60
v_exp_f32 v61, v61
v_exp_f32 v62, v62
buffer_load_dwordx4 v10, s[64:67], s95 offen offset:3072 nt lds
v_mfma_f32_32x32x16_bf16 v[208:223], v[248:251], v[32:35], 0
v_exp_f32 v63, v63
v_add_f32 v29, v29, v48
v_add_f32 v30, v30, v49
v_add_f32 v29, v29, v50
v_add_f32 v30, v30, v51
s_add_u32 s95, s95, 4096
s_add_u32 m0, s31, 4096
s_nop 0
buffer_load_dwordx4 v10, s[64:67], s95 offen offset:0 nt lds
v_mfma_f32_32x32x16_bf16 v[160:175], v[228:231], v[36:39], v[160:175]
v_add_f32 v29, v29, v52
v_add_f32 v30, v30, v53
v_add_f32 v29, v29, v54
v_add_f32 v30, v30, v55
v_add_f32 v29, v29, v56
buffer_load_dwordx4 v10, s[64:67], s95 offen offset:1024 nt lds
v_mfma_f32_32x32x16_bf16 v[176:191], v[236:239], v[36:39], v[176:191]
v_add_f32 v30, v30, v57
v_add_f32 v29, v29, v58
v_add_f32 v30, v30, v59
v_add_f32 v29, v29, v60
v_add_f32 v30, v30, v61
buffer_load_dwordx4 v10, s[64:67], s95 offen offset:2048 nt lds
v_mfma_f32_32x32x16_bf16 v[192:207], v[244:247], v[36:39], v[192:207]
v_add_f32 v29, v29, v62
v_add_f32 v30, v30, v63
v_cvt_pk_bf16_f32 v48, v48, v49
v_cvt_pk_bf16_f32 v49, v50, v51
v_cvt_pk_bf16_f32 v50, v52, v53
buffer_load_dwordx4 v10, s[64:67], s95 offen offset:3072 nt lds
v_mfma_f32_32x32x16_bf16 v[208:223], v[252:255], v[36:39], v[208:223]
v_cvt_pk_bf16_f32 v51, v54, v55
v_cvt_pk_bf16_f32 v52, v56, v57
v_cvt_pk_bf16_f32 v53, v58, v59
v_cvt_pk_bf16_f32 v54, v60, v61
v_cvt_pk_bf16_f32 v55, v62, v63
s_waitcnt vmcnt(8)
ds_read_b64_tr_b16 v[224:225], v19 offset:8192
ds_read_b64_tr_b16 v[226:227], v19 offset:10240
ds_read_b64_tr_b16 v[228:229], v19 offset:12288
ds_read_b64_tr_b16 v[230:231], v19 offset:14336
ds_read_b64_tr_b16 v[232:233], v20 offset:8192
ds_read_b64_tr_b16 v[234:235], v20 offset:10240
ds_read_b64_tr_b16 v[236:237], v20 offset:12288
ds_read_b64_tr_b16 v[238:239], v20 offset:14336
ds_read_b64_tr_b16 v[240:241], v21 offset:8192
ds_read_b64_tr_b16 v[242:243], v21 offset:10240
ds_read_b64_tr_b16 v[244:245], v21 offset:12288
ds_read_b64_tr_b16 v[246:247], v21 offset:14336
ds_read_b64_tr_b16 v[248:249], v22 offset:8192
ds_read_b64_tr_b16 v[250:251], v22 offset:10240
ds_read_b64_tr_b16 v[252:253], v22 offset:12288
ds_read_b64_tr_b16 v[254:255], v22 offset:14336
v_fma_f32 v64, v64, s91, v28
v_fma_f32 v65, v65, s91, v28
v_fma_f32 v66, v66, s91, v28
v_fma_f32 v67, v67, s91, v28
v_fma_f32 v68, v68, s91, v28
v_fma_f32 v69, v69, s91, v28
v_fma_f32 v70, v70, s91, v28
v_fma_f32 v71, v71, s91, v28
v_fma_f32 v72, v72, s91, v28
v_fma_f32 v73, v73, s91, v28
v_fma_f32 v74, v74, s91, v28
v_fma_f32 v75, v75, s91, v28
v_fma_f32 v76, v76, s91, v28
v_fma_f32 v77, v77, s91, v28
v_fma_f32 v78, v78, s91, v28
v_fma_f32 v79, v79, s91, v28
s_waitcnt lgkmcnt(0)
s_add_u32 s95, s3, 3
s_and_b32 s95, s95, 3
s_lshl_b32 s95, s95, 14
s_add_u32 s95, s95, s96
s_add_u32 s95, s95, 4259840
s_add_u32 m0, s31, 8192
s_nop 0
buffer_load_dwordx4 v10, s[64:67], s95 offen offset:0 nt lds
v_mfma_f32_32x32x16_bf16 v[160:175], v[224:227], v[48:51], v[160:175]
v_exp_f32 v64, v64
v_exp_f32 v65, v65
v_exp_f32 v66, v66
v_exp_f32 v67, v67
v_exp_f32 v68, v68
buffer_load_dwordx4 v10, s[64:67], s95 offen offset:1024 nt lds
v_mfma_f32_32x32x16_bf16 v[176:191], v[232:235], v[48:51], v[176:191]
v_exp_f32 v69, v69
v_exp_f32 v70, v70
v_exp_f32 v71, v71
v_exp_f32 v72, v72
v_exp_f32 v73, v73
buffer_load_dwordx4 v10, s[64:67], s95 offen offset:2048 nt lds
v_mfma_f32_32x32x16_bf16 v[192:207], v[240:243], v[48:51], v[192:207]
v_exp_f32 v74, v74
v_exp_f32 v75, v75
v_exp_f32 v76, v76
v_exp_f32 v77, v77
v_exp_f32 v78, v78
buffer_load_dwordx4 v10, s[64:67], s95 offen offset:3072 nt lds
v_mfma_f32_32x32x16_bf16 v[208:223], v[248:251], v[48:51], v[208:223]
v_exp_f32 v79, v79
v_add_f32 v29, v29, v64
v_add_f32 v30, v30, v65
v_add_f32 v29, v29, v66
v_add_f32 v30, v30, v67
s_add_u32 s95, s95, 4096
s_add_u32 m0, s31, 12288
s_nop 0
buffer_load_dwordx4 v10, s[64:67], s95 offen offset:0 nt lds
v_mfma_f32_32x32x16_bf16 v[160:175], v[228:231], v[52:55], v[160:175]
v_add_f32 v29, v29, v68
v_add_f32 v30, v30, v69
v_add_f32 v29, v29, v70
v_add_f32 v30, v30, v71
v_add_f32 v29, v29, v72
buffer_load_dwordx4 v10, s[64:67], s95 offen offset:1024 nt lds
v_mfma_f32_32x32x16_bf16 v[176:191], v[236:239], v[52:55], v[176:191]
v_add_f32 v30, v30, v73
v_add_f32 v29, v29, v74
v_add_f32 v30, v30, v75
v_add_f32 v29, v29, v76
v_add_f32 v30, v30, v77
buffer_load_dwordx4 v10, s[64:67], s95 offen offset:2048 nt lds
v_mfma_f32_32x32x16_bf16 v[192:207], v[244:247], v[52:55], v[192:207]
v_add_f32 v29, v29, v78
v_add_f32 v30, v30, v79
v_cvt_pk_bf16_f32 v64, v64, v65
v_cvt_pk_bf16_f32 v65, v66, v67
v_cvt_pk_bf16_f32 v66, v68, v69
buffer_load_dwordx4 v10, s[64:67], s95 offen offset:3072 nt lds
v_mfma_f32_32x32x16_bf16 v[208:223], v[252:255], v[52:55], v[208:223]
v_cvt_pk_bf16_f32 v67, v70, v71
v_cvt_pk_bf16_f32 v68, v72, v73
v_cvt_pk_bf16_f32 v69, v74, v75
v_cvt_pk_bf16_f32 v70, v76, v77
v_cvt_pk_bf16_f32 v71, v78, v79
s_add_u32 s95, s3, 0
s_and_b32 s95, s95, 15
s_lshl_b32 s95, s95, 13
s_add_u32 s95, s95, s83
s_add_u32 m0, s94, 65536
s_nop 0
buffer_load_dwordx4 v15, s[40:43], s95 offen offset:0 nt lds
buffer_load_dwordx4 v18, s[40:43], s95 offen offset:1024 nt lds
s_add_u32 s95, s3, 1
s_and_b32 s95, s95, 15
s_lshl_b32 s95, s95, 13
s_add_u32 s95, s95, s83
s_add_u32 m0, s94, 73728
s_nop 0
buffer_load_dwordx4 v15, s[40:43], s95 offen offset:0 nt lds
buffer_load_dwordx4 v18, s[40:43], s95 offen offset:1024 nt lds
s_add_u32 s95, s3, 2
s_and_b32 s95, s95, 15
s_lshl_b32 s95, s95, 13
s_add_u32 s95, s95, s83
s_add_u32 m0, s94, 81920
s_nop 0
buffer_load_dwordx4 v15, s[40:43], s95 offen offset:0 nt lds
buffer_load_dwordx4 v18, s[40:43], s95 offen offset:1024 nt lds
s_add_u32 s95, s3, 3
s_and_b32 s95, s95, 15
s_lshl_b32 s95, s95, 13
s_add_u32 s95, s95, s83
s_add_u32 m0, s94, 90112
s_nop 0
buffer_load_dwordx4 v15, s[40:43], s95 offen offset:0 nt lds
buffer_load_dwordx4 v18, s[40:43], s95 offen offset:1024 nt lds
s_add_u32 s95, s3, 4
s_and_b32 s95, s95, 15
s_lshl_b32 s95, s95, 13
s_add_u32 s95, s95, s83
s_add_u32 m0, s94, 98304
s_nop 0
buffer_load_dwordx4 v15, s[40:43], s95 offen offset:0 nt lds
buffer_load_dwordx4 v18, s[40:43], s95 offen offset:1024 nt lds
s_add_u32 s95, s3, 5
s_and_b32 s95, s95, 15
s_lshl_b32 s95, s95, 13
s_add_u32 s95, s95, s83
s_add_u32 m0, s94, 106496
s_nop 0
buffer_load_dwordx4 v15, s[40:43], s95 offen offset:0 nt lds
buffer_load_dwordx4 v18, s[40:43], s95 offen offset:1024 nt lds
s_waitcnt vmcnt(20)
ds_read_b64_tr_b16 v[224:225], v19 offset:0
ds_read_b64_tr_b16 v[226:227], v19 offset:2048
ds_read_b64_tr_b16 v[228:229], v19 offset:4096
ds_read_b64_tr_b16 v[230:231], v19 offset:6144
ds_read_b64_tr_b16 v[232:233], v20 offset:0
ds_read_b64_tr_b16 v[234:235], v20 offset:2048
ds_read_b64_tr_b16 v[236:237], v20 offset:4096
ds_read_b64_tr_b16 v[238:239], v20 offset:6144
ds_read_b64_tr_b16 v[240:241], v21 offset:0
ds_read_b64_tr_b16 v[242:243], v21 offset:2048
ds_read_b64_tr_b16 v[244:245], v21 offset:4096
ds_read_b64_tr_b16 v[246:247], v21 offset:6144
ds_read_b64_tr_b16 v[248:249], v22 offset:0
ds_read_b64_tr_b16 v[250:251], v22 offset:2048
ds_read_b64_tr_b16 v[252:253], v22 offset:4096
ds_read_b64_tr_b16 v[254:255], v22 offset:6144
v_fma_f32 v80, v80, s91, v28
v_fma_f32 v81, v81, s91, v28
v_fma_f32 v82, v82, s91, v28
v_fma_f32 v83, v83, s91, v28
v_fma_f32 v84, v84, s91, v28
v_fma_f32 v85, v85, s91, v28
v_fma_f32 v86, v86, s91, v28
v_fma_f32 v87, v87, s91, v28
v_fma_f32 v88, v88, s91, v28
v_fma_f32 v89, v89, s91, v28
v_fma_f32 v90, v90, s91, v28
v_fma_f32 v91, v91, s91, v28
v_fma_f32 v92, v92, s91, v28
v_fma_f32 v93, v93, s91, v28
v_fma_f32 v94, v94, s91, v28
v_fma_f32 v95, v95, s91, v28
s_waitcnt lgkmcnt(0)
v_mfma_f32_32x32x16_bf16 v[160:175], v[224:227], v[64:67], v[160:175]
v_exp_f32 v80, v80
v_exp_f32 v81, v81
v_exp_f32 v82, v82
v_exp_f32 v83, v83
v_exp_f32 v84, v84
v_mfma_f32_32x32x16_bf16 v[176:191], v[232:235], v[64:67], v[176:191]
v_exp_f32 v85, v85
v_exp_f32 v86, v86
v_exp_f32 v87, v87
v_exp_f32 v88, v88
v_exp_f32 v89, v89
v_mfma_f32_32x32x16_bf16 v[192:207], v[240:243], v[64:67], v[192:207]
v_exp_f32 v90, v90
v_exp_f32 v91, v91
v_exp_f32 v92, v92
v_exp_f32 v93, v93
v_exp_f32 v94, v94
v_mfma_f32_32x32x16_bf16 v[208:223], v[248:251], v[64:67], v[208:223]
v_exp_f32 v95, v95
v_add_f32 v29, v29, v80
v_add_f32 v30, v30, v81
v_add_f32 v29, v29, v82
v_add_f32 v30, v30, v83
v_mfma_f32_32x32x16_bf16 v[160:175], v[228:231], v[68:71], v[160:175]
v_add_f32 v29, v29, v84
v_add_f32 v30, v30, v85
v_add_f32 v29, v29, v86
v_add_f32 v30, v30, v87
v_add_f32 v29, v29, v88
v_mfma_f32_32x32x16_bf16 v[176:191], v[236:239], v[68:71], v[176:191]
v_add_f32 v30, v30, v89
v_add_f32 v29, v29, v90
v_add_f32 v30, v30, v91
v_add_f32 v29, v29, v92
v_add_f32 v30, v30, v93
v_mfma_f32_32x32x16_bf16 v[192:207], v[244:247], v[68:71], v[192:207]
v_add_f32 v29, v29, v94
v_add_f32 v30, v30, v95
v_cvt_pk_bf16_f32 v80, v80, v81
v_cvt_pk_bf16_f32 v81, v82, v83
v_cvt_pk_bf16_f32 v82, v84, v85
v_mfma_f32_32x32x16_bf16 v[208:223], v[252:255], v[68:71], v[208:223]
v_cvt_pk_bf16_f32 v83, v86, v87
v_cvt_pk_bf16_f32 v84, v88, v89
v_cvt_pk_bf16_f32 v85, v90, v91
v_cvt_pk_bf16_f32 v86, v92, v93
v_cvt_pk_bf16_f32 v87, v94, v95
s_waitcnt vmcnt(12)
ds_read_b64_tr_b16 v[224:225], v19 offset:8192
ds_read_b64_tr_b16 v[226:227], v19 offset:10240
ds_read_b64_tr_b16 v[228:229], v19 offset:12288
ds_read_b64_tr_b16 v[230:231], v19 offset:14336
ds_read_b64_tr_b16 v[232:233], v20 offset:8192
ds_read_b64_tr_b16 v[234:235], v20 offset:10240
ds_read_b64_tr_b16 v[236:237], v20 offset:12288
ds_read_b64_tr_b16 v[238:239], v20 offset:14336
ds_read_b64_tr_b16 v[240:241], v21 offset:8192
ds_read_b64_tr_b16 v[242:243], v21 offset:10240
ds_read_b64_tr_b16 v[244:245], v21 offset:12288
ds_read_b64_tr_b16 v[246:247], v21 offset:14336
ds_read_b64_tr_b16 v[248:249], v22 offset:8192
ds_read_b64_tr_b16 v[250:251], v22 offset:10240
ds_read_b64_tr_b16 v[252:253], v22 offset:12288
ds_read_b64_tr_b16 v[254:255], v22 offset:14336
s_waitcnt lgkmcnt(0)
v_mfma_f32_32x32x16_bf16 v[160:175], v[224:227], v[80:83], v[160:175]
v_mfma_f32_32x32x16_bf16 v[176:191], v[232:235], v[80:83], v[176:191]
v_mfma_f32_32x32x16_bf16 v[192:207], v[240:243], v[80:83], v[192:207]
v_mfma_f32_32x32x16_bf16 v[208:223], v[248:251], v[80:83], v[208:223]
v_mfma_f32_32x32x16_bf16 v[160:175], v[228:231], v[84:87], v[160:175]
v_mfma_f32_32x32x16_bf16 v[176:191], v[236:239], v[84:87], v[176:191]
v_mfma_f32_32x32x16_bf16 v[192:207], v[244:247], v[84:87], v[192:207]
v_mfma_f32_32x32x16_bf16 v[208:223], v[252:255], v[84:87], v[208:223]
s_barrier
s_add_u32 s95, s3, 6
s_and_b32 s95, s95, 15
s_lshl_b32 s95, s95, 13
s_add_u32 s95, s95, s83
s_add_u32 m0, s94, 0
s_nop 0
buffer_load_dwordx4 v15, s[40:43], s95 offen offset:0 nt lds
buffer_load_dwordx4 v18, s[40:43], s95 offen offset:1024 nt lds
s_add_u32 s95, s3, 7
s_and_b32 s95, s95, 15
s_lshl_b32 s95, s95, 13
s_add_u32 s95, s95, s83
s_add_u32 m0, s94, 8192
s_nop 0
buffer_load_dwordx4 v15, s[40:43], s95 offen offset:0 nt lds
buffer_load_dwordx4 v18, s[40:43], s95 offen offset:1024 nt lds
s_add_u32 s95, s3, 0
s_and_b32 s95, s95, 15
s_lshl_b32 s95, s95, 13
s_add_u32 s95, s95, s83
s_add_u32 m0, s94, 16384
s_nop 0
buffer_load_dwordx4 v10, s[44:47], s95 offen offset:0 nt lds
buffer_load_dwordx4 v10, s[44:47], s95 offen offset:1024 nt lds
s_add_u32 s95, s3, 1
s_and_b32 s95, s95, 15
s_lshl_b32 s95, s95, 13
s_add_u32 s95, s95, s83
s_add_u32 m0, s94, 24576
s_nop 0
buffer_load_dwordx4 v10, s[44:47], s95 offen offset:0 nt lds
buffer_load_dwordx4 v10, s[44:47], s95 offen offset:1024 nt lds
v_add_f32 v29, v29, v30
v_mov_b32 v31, v29
s_nop 1
v_permlane32_swap_b32 v29, v31
v_add_f32 v29, v29, v31
v_mov_b32 v224, v27
v_mov_b32 v225, v29
v_add_u32 v19, s86, v1
v_add_u32 v20, s87, v1
v_lshlrev_b32 v31, 3, v0
s_lshl_b32 s93, s26, 9
s_add_u32 s93, s93, 147456
s_xor_b32 s92, s93, 0x400
v_add_u32 v21, s93, v31
v_add_u32 v22, s92, v31
ds_write_b64 v21, v[224:225]
ds_write_b128 v19, v[192:195] offset:0
ds_write_b128 v19, v[196:199] offset:1024
ds_write_b128 v19, v[200:203] offset:2048
ds_write_b128 v19, v[204:207] offset:3072
ds_write_b128 v19, v[208:211] offset:4096
ds_write_b128 v19, v[212:215] offset:5120
ds_write_b128 v19, v[216:219] offset:6144
ds_write_b128 v19, v[220:223] offset:7168
s_waitcnt lgkmcnt(0)
s_barrier
ds_read_b64 v[226:227], v22
ds_read_b128 v[32:35], v20 offset:0
ds_read_b128 v[36:39], v20 offset:1024
ds_read_b128 v[40:43], v20 offset:2048
ds_read_b128 v[44:47], v20 offset:3072
ds_read_b128 v[48:51], v20 offset:4096
ds_read_b128 v[52:55], v20 offset:5120
ds_read_b128 v[56:59], v20 offset:6144
ds_read_b128 v[60:63], v20 offset:7168
s_waitcnt lgkmcnt(8)
s_add_u32 s95, s3, 2
s_and_b32 s95, s95, 15
s_lshl_b32 s95, s95, 13
s_add_u32 s95, s95, s83
s_add_u32 m0, s94, 32768
s_nop 0
buffer_load_dwordx4 v10, s[44:47], s95 offen offset:0 nt lds
buffer_load_dwordx4 v10, s[44:47], s95 offen offset:1024 nt lds
s_add_u32 s95, s3, 3
s_and_b32 s95, s95, 15
s_lshl_b32 s95, s95, 13
s_add_u32 s95, s95, s83
s_add_u32 m0, s94, 40960
s_nop 0
buffer_load_dwordx4 v10, s[44:47], s95 offen offset:0 nt lds
buffer_load_dwordx4 v10, s[44:47], s95 offen offset:1024 nt lds
s_add_u32 s95, s3, 4
s_and_b32 s95, s95, 15
s_lshl_b32 s95, s95, 13
s_add_u32 s95, s95, s83
s_add_u32 m0, s94, 49152
s_nop 0
buffer_load_dwordx4 v10, s[44:47], s95 offen offset:0 nt lds
buffer_load_dwordx4 v10, s[44:47], s95 offen offset:1024 nt lds
s_add_u32 s95, s3, 5
s_and_b32 s95, s95, 15
s_lshl_b32 s95, s95, 13
s_add_u32 s95, s95, s83
s_add_u32 m0, s94, 57344
s_nop 0
buffer_load_dwordx4 v10, s[44:47], s95 offen offset:0 nt lds
buffer_load_dwordx4 v10, s[44:47], s95 offen offset:1024 nt lds
v_max_f32 v228, v224, v226
v_sub_f32 v232, v224, v228
v_sub_f32 v233, v226, v228
v_mul_f32 v232, s91, v232
v_mul_f32 v233, s91, v233
v_exp_f32 v232, v232
v_exp_f32 v233, v233
v_mul_f32 v229, v225, v232
v_fma_f32 v229, v227, v233, v229
v_mov_b32 v230, v228
v_mov_b32 v231, v229
v_rcp_f32 v234, v229
s_nop 0
v_mul_f32 v232, v232, v234
v_mul_f32 v233, v233, v234
v_mul_f32 v160, v160, v232
v_mul_f32 v161, v161, v232
v_mul_f32 v162, v162, v232
v_mul_f32 v163, v163, v232
v_mul_f32 v164, v164, v232
v_mul_f32 v165, v165, v232
v_mul_f32 v166, v166, v232
v_mul_f32 v167, v167, v232
v_mul_f32 v168, v168, v232
v_mul_f32 v169, v169, v232
v_mul_f32 v170, v170, v232
v_mul_f32 v171, v171, v232
v_mul_f32 v172, v172, v232
v_mul_f32 v173, v173, v232
v_mul_f32 v174, v174, v232
v_mul_f32 v175, v175, v232
v_mul_f32 v176, v176, v232
v_mul_f32 v177, v177, v232
v_mul_f32 v178, v178, v232
v_mul_f32 v179, v179, v232
v_mul_f32 v180, v180, v232
v_mul_f32 v181, v181, v232
v_mul_f32 v182, v182, v232
v_mul_f32 v183, v183, v232
v_mul_f32 v184, v184, v232
v_mul_f32 v185, v185, v232
v_mul_f32 v186, v186, v232
v_mul_f32 v187, v187, v232
v_mul_f32 v188, v188, v232
v_mul_f32 v189, v189, v232
v_mul_f32 v190, v190, v232
v_mul_f32 v191, v191, v232
s_waitcnt lgkmcnt(0)
v_fma_f32 v160, v32, v233, v160
v_fma_f32 v161, v33, v233, v161
v_fma_f32 v162, v34, v233, v162
v_fma_f32 v163, v35, v233, v163
v_fma_f32 v164, v36, v233, v164
v_fma_f32 v165, v37, v233, v165
v_fma_f32 v166, v38, v233, v166
v_fma_f32 v167, v39, v233, v167
v_fma_f32 v168, v40, v233, v168
v_fma_f32 v169, v41, v233, v169
v_fma_f32 v170, v42, v233, v170
v_fma_f32 v171, v43, v233, v171
v_fma_f32 v172, v44, v233, v172
v_fma_f32 v173, v45, v233, v173
v_fma_f32 v174, v46, v233, v174
v_fma_f32 v175, v47, v233, v175
v_fma_f32 v176, v48, v233, v176
v_fma_f32 v177, v49, v233, v177
v_fma_f32 v178, v50, v233, v178
v_fma_f32 v179, v51, v233, v179
v_fma_f32 v180, v52, v233, v180
v_fma_f32 v181, v53, v233, v181
v_fma_f32 v182, v54, v233, v182
v_fma_f32 v183, v55, v233, v183
v_fma_f32 v184, v56, v233, v184
v_fma_f32 v185, v57, v233, v185
v_fma_f32 v186, v58, v233, v186
v_fma_f32 v187, v59, v233, v187
v_fma_f32 v188, v60, v233, v188
v_fma_f32 v189, v61, v233, v189
v_fma_f32 v190, v62, v233, v190
v_fma_f32 v191, v63, v233, v191
s_lshl_b32 s92, s97, 16
s_lshl_b32 s93, s26, 14
s_add_u32 s92, s92, s93
s_add_u32 s92, s92, 20971520
v_cvt_pk_bf16_f32 v192, v160, v161
v_cvt_pk_bf16_f32 v193, v162, v163
v_cvt_pk_bf16_f32 v194, v164, v165
v_cvt_pk_bf16_f32 v195, v166, v167
v_cvt_pk_bf16_f32 v196, v168, v169
v_cvt_pk_bf16_f32 v197, v170, v171
v_cvt_pk_bf16_f32 v198, v172, v173
v_cvt_pk_bf16_f32 v199, v174, v175
v_cvt_pk_bf16_f32 v200, v176, v177
v_cvt_pk_bf16_f32 v201, v178, v179
v_cvt_pk_bf16_f32 v202, v180, v181
v_cvt_pk_bf16_f32 v203, v182, v183
v_cvt_pk_bf16_f32 v204, v184, v185
v_cvt_pk_bf16_f32 v205, v186, v187
v_cvt_pk_bf16_f32 v206, v188, v189
v_cvt_pk_bf16_f32 v207, v190, v191
buffer_store_dwordx4 v[192:195], v1, s[76:79], s92 offen offset:0 sc1
buffer_store_dwordx4 v[196:199], v1, s[76:79], s92 offen offset:1024 sc1
buffer_store_dwordx4 v[200:203], v1, s[76:79], s92 offen offset:2048 sc1
buffer_store_dwordx4 v[204:207], v1, s[76:79], s92 offen offset:3072 sc1
s_add_u32 s92, s92, 4096
buffer_store_dwordx4 v[228:231], v1, s[76:79], s92 offen sc1
v_add_u32 v19, 65536, v2
v_xor_b32 v20, 32, v19
v_xor_b32 v21, 64, v19
v_xor_b32 v22, 96, v19
v_xor_b32 v23, 128, v19
v_xor_b32 v24, 160, v19
v_xor_b32 v25, 192, v19
v_xor_b32 v26, 224, v19
s_waitcnt vmcnt(31)
s_barrier
ds_read_b128 v[224:227], v19 offset:0
ds_read_b128 v[228:231], v20 offset:0
ds_read_b128 v[232:235], v21 offset:0
ds_read_b128 v[236:239], v22 offset:0
ds_read_b128 v[240:243], v23 offset:0
ds_read_b128 v[244:247], v24 offset:0
ds_read_b128 v[248:251], v25 offset:0
ds_read_b128 v[252:255], v26 offset:0
s_waitcnt lgkmcnt(0)
s_waitcnt vmcnt(29)
s_barrier
v_mfma_f32_32x32x16_bf16 v[32:47], v[224:227], a[128:131], 0
ds_read_b128 a[64:67], v19 offset:8192
ds_read_b128 a[68:71], v20 offset:8192
v_mfma_f32_32x32x16_bf16 v[32:47], v[228:231], a[132:135], v[32:47]
ds_read_b128 a[72:75], v21 offset:8192
ds_read_b128 a[76:79], v22 offset:8192
v_mfma_f32_32x32x16_bf16 v[32:47], v[232:235], a[136:139], v[32:47]
ds_read_b128 a[80:83], v23 offset:8192
ds_read_b128 a[84:87], v24 offset:8192
v_mfma_f32_32x32x16_bf16 v[32:47], v[236:239], a[140:143], v[32:47]
ds_read_b128 a[88:91], v25 offset:8192
ds_read_b128 a[92:95], v26 offset:8192
v_mfma_f32_32x32x16_bf16 v[32:47], v[240:243], a[144:147], v[32:47]
v_mfma_f32_32x32x16_bf16 v[32:47], v[244:247], a[148:151], v[32:47]
v_mfma_f32_32x32x16_bf16 v[32:47], v[248:251], a[152:155], v[32:47]
v_mfma_f32_32x32x16_bf16 v[32:47], v[252:255], a[156:159], v[32:47]
s_waitcnt lgkmcnt(0)
s_waitcnt vmcnt(27)
s_barrier
v_mfma_f32_32x32x16_bf16 v[48:63], a[64:67], a[128:131], 0
ds_read_b128 v[224:227], v19 offset:16384
ds_read_b128 v[228:231], v20 offset:16384
s_nop 5
v_max_f32 v27, v32, v33
v_mfma_f32_32x32x16_bf16 v[48:63], a[68:71], a[132:135], v[48:63]
ds_read_b128 v[232:235], v21 offset:16384
ds_read_b128 v[236:239], v22 offset:16384
v_max3_f32 v27, v27, v34, v35
v_mfma_f32_32x32x16_bf16 v[48:63], a[72:75], a[136:139], v[48:63]
ds_read_b128 v[240:243], v23 offset:16384
ds_read_b128 v[244:247], v24 offset:16384
v_max3_f32 v27, v27, v36, v37
v_mfma_f32_32x32x16_bf16 v[48:63], a[76:79], a[140:143], v[48:63]
ds_read_b128 v[248:251], v25 offset:16384
ds_read_b128 v[252:255], v26 offset:16384
v_max3_f32 v27, v27, v38, v39
v_mfma_f32_32x32x16_bf16 v[48:63], a[80:83], a[144:147], v[48:63]
v_max3_f32 v27, v27, v40, v41
v_mfma_f32_32x32x16_bf16 v[48:63], a[84:87], a[148:151], v[48:63]
v_max3_f32 v27, v27, v42, v43
v_mfma_f32_32x32x16_bf16 v[48:63], a[88:91], a[152:155], v[48:63]
v_max3_f32 v27, v27, v44, v45
v_mfma_f32_32x32x16_bf16 v[48:63], a[92:95], a[156:159], v[48:63]
v_max3_f32 v27, v27, v46, v47
s_waitcnt lgkmcnt(0)
s_waitcnt vmcnt(25)
s_barrier
v_mfma_f32_32x32x16_bf16 v[64:79], v[224:227], a[128:131], 0
ds_read_b128 a[64:67], v19 offset:24576
ds_read_b128 a[68:71], v20 offset:24576
s_nop 4
v_max3_f32 v27, v27, v48, v49
v_mfma_f32_32x32x16_bf16 v[64:79], v[228:231], a[132:135], v[64:79]
ds_read_b128 a[72:75], v21 offset:24576
ds_read_b128 a[76:79], v22 offset:24576
v_max3_f32 v27, v27, v50, v51
v_mfma_f32_32x32x16_bf16 v[64:79], v[232:235], a[136:139], v[64:79]
ds_read_b128 a[80:83], v23 offset:24576
ds_read_b128 a[84:87], v24 offset:24576
v_max3_f32 v27, v27, v52, v53
v_mfma_f32_32x32x16_bf16 v[64:79], v[236:239], a[140:143], v[64:79]
ds_read_b128 a[88:91], v25 offset:24576
ds_read_b128 a[92:95], v26 offset:24576
v_max3_f32 v27, v27, v54, v55
v_mfma_f32_32x32x16_bf16 v[64:79], v[240:243], a[144:147], v[64:79]
v_max3_f32 v27, v27, v56, v57
v_mfma_f32_32x32x16_bf16 v[64:79], v[244:247], a[148:151], v[64:79]
v_max3_f32 v27, v27, v58, v59
v_mfma_f32_32x32x16_bf16 v[64:79], v[248:251], a[152:155], v[64:79]
v_max3_f32 v27, v27, v60, v61
v_mfma_f32_32x32x16_bf16 v[64:79], v[252:255], a[156:159], v[64:79]
v_max3_f32 v27, v27, v62, v63
s_waitcnt lgkmcnt(0)
s_waitcnt vmcnt(23)
s_barrier
v_mfma_f32_32x32x16_bf16 v[80:95], a[64:67], a[128:131], 0
ds_read_b128 v[224:227], v19 offset:32768
ds_read_b128 v[228:231], v20 offset:32768
s_nop 4
v_max3_f32 v27, v27, v64, v65
v_mfma_f32_32x32x16_bf16 v[80:95], a[68:71], a[132:135], v[80:95]
ds_read_b128 v[232:235], v21 offset:32768
ds_read_b128 v[236:239], v22 offset:32768
v_max3_f32 v27, v27, v66, v67
v_mfma_f32_32x32x16_bf16 v[80:95], a[72:75], a[136:139], v[80:95]
ds_read_b128 v[240:243], v23 offset:32768
ds_read_b128 v[244:247], v24 offset:32768
v_max3_f32 v27, v27, v68, v69
v_mfma_f32_32x32x16_bf16 v[80:95], a[76:79], a[140:143], v[80:95]
ds_read_b128 v[248:251], v25 offset:32768
ds_read_b128 v[252:255], v26 offset:32768
v_max3_f32 v27, v27, v70, v71
v_mfma_f32_32x32x16_bf16 v[80:95], a[80:83], a[144:147], v[80:95]
v_max3_f32 v27, v27, v72, v73
v_mfma_f32_32x32x16_bf16 v[80:95], a[84:87], a[148:151], v[80:95]
v_max3_f32 v27, v27, v74, v75
v_mfma_f32_32x32x16_bf16 v[80:95], a[88:91], a[152:155], v[80:95]
v_max3_f32 v27, v27, v76, v77
v_mfma_f32_32x32x16_bf16 v[80:95], a[92:95], a[156:159], v[80:95]
v_max3_f32 v27, v27, v78, v79
s_waitcnt lgkmcnt(0)
s_waitcnt vmcnt(21)
s_barrier
v_mfma_f32_32x32x16_bf16 v[96:111], v[224:227], a[128:131], 0
ds_read_b128 a[64:67], v19 offset:40960
ds_read_b128 a[68:71], v20 offset:40960
s_nop 4
v_max3_f32 v27, v27, v80, v81
v_mfma_f32_32x32x16_bf16 v[96:111], v[228:231], a[132:135], v[96:111]
ds_read_b128 a[72:75], v21 offset:40960
ds_read_b128 a[76:79], v22 offset:40960
v_max3_f32 v27, v27, v82, v83
v_mfma_f32_32x32x16_bf16 v[96:111], v[232:235], a[136:139], v[96:111]
ds_read_b128 a[80:83], v23 offset:40960
ds_read_b128 a[84:87], v24 offset:40960
v_max3_f32 v27, v27, v84, v85
v_mfma_f32_32x32x16_bf16 v[96:111], v[236:239], a[140:143], v[96:111]
ds_read_b128 a[88:91], v25 offset:40960
ds_read_b128 a[92:95], v26 offset:40960
v_max3_f32 v27, v27, v86, v87
v_mfma_f32_32x32x16_bf16 v[96:111], v[240:243], a[144:147], v[96:111]
v_max3_f32 v27, v27, v88, v89
v_mfma_f32_32x32x16_bf16 v[96:111], v[244:247], a[148:151], v[96:111]
v_max3_f32 v27, v27, v90, v91
v_mfma_f32_32x32x16_bf16 v[96:111], v[248:251], a[152:155], v[96:111]
v_max3_f32 v27, v27, v92, v93
v_mfma_f32_32x32x16_bf16 v[96:111], v[252:255], a[156:159], v[96:111]
v_max3_f32 v27, v27, v94, v95
s_waitcnt lgkmcnt(0)
v_add_u32 v19, s84, v2
v_xor_b32 v20, 32, v19
v_xor_b32 v21, 64, v19
v_xor_b32 v22, 96, v19
v_xor_b32 v23, 128, v19
v_xor_b32 v24, 160, v19
v_xor_b32 v25, 192, v19
v_xor_b32 v26, 224, v19
s_waitcnt vmcnt(19)
s_barrier
v_mfma_f32_32x32x16_bf16 v[112:127], a[64:67], a[128:131], 0
ds_read_b128 v[224:227], v19 offset:0
ds_read_b128 v[228:231], v20 offset:0
v_max3_f32 v27, v27, v96, v97
v_mfma_f32_32x32x16_bf16 v[112:127], a[68:71], a[132:135], v[112:127]
ds_read_b128 v[232:235], v21 offset:0
ds_read_b128 v[236:239], v22 offset:0
v_max3_f32 v27, v27, v98, v99
v_mfma_f32_32x32x16_bf16 v[112:127], a[72:75], a[136:139], v[112:127]
ds_read_b128 v[240:243], v23 offset:0
ds_read_b128 v[244:247], v24 offset:0
v_max3_f32 v27, v27, v100, v101
v_mfma_f32_32x32x16_bf16 v[112:127], a[76:79], a[140:143], v[112:127]
ds_read_b128 v[248:251], v25 offset:0
ds_read_b128 v[252:255], v26 offset:0
v_max3_f32 v27, v27, v102, v103
v_mfma_f32_32x32x16_bf16 v[112:127], a[80:83], a[144:147], v[112:127]
v_max3_f32 v27, v27, v104, v105
v_mfma_f32_32x32x16_bf16 v[112:127], a[84:87], a[148:151], v[112:127]
v_max3_f32 v27, v27, v106, v107
v_mfma_f32_32x32x16_bf16 v[112:127], a[88:91], a[152:155], v[112:127]
v_max3_f32 v27, v27, v108, v109
v_mfma_f32_32x32x16_bf16 v[112:127], a[92:95], a[156:159], v[112:127]
v_max3_f32 v27, v27, v110, v111
s_waitcnt lgkmcnt(0)
s_waitcnt vmcnt(17)
s_barrier
v_mfma_f32_32x32x16_bf16 v[128:143], v[224:227], a[128:131], 0
ds_read_b128 a[64:67], v19 offset:8192
ds_read_b128 a[68:71], v20 offset:8192
s_nop 4
v_max3_f32 v27, v27, v112, v113
v_mfma_f32_32x32x16_bf16 v[128:143], v[228:231], a[132:135], v[128:143]
ds_read_b128 a[72:75], v21 offset:8192
ds_read_b128 a[76:79], v22 offset:8192
v_max3_f32 v27, v27, v114, v115
v_mfma_f32_32x32x16_bf16 v[128:143], v[232:235], a[136:139], v[128:143]
ds_read_b128 a[80:83], v23 offset:8192
ds_read_b128 a[84:87], v24 offset:8192
v_max3_f32 v27, v27, v116, v117
v_mfma_f32_32x32x16_bf16 v[128:143], v[236:239], a[140:143], v[128:143]
ds_read_b128 a[88:91], v25 offset:8192
ds_read_b128 a[92:95], v26 offset:8192
v_max3_f32 v27, v27, v118, v119
v_mfma_f32_32x32x16_bf16 v[128:143], v[240:243], a[144:147], v[128:143]
v_max3_f32 v27, v27, v120, v121
s_add_u32 s95, s3, 6
s_and_b32 s95, s95, 15
s_lshl_b32 s95, s95, 13
s_add_u32 s95, s95, s83
s_add_u32 m0, s94, 0
s_nop 0
buffer_load_dwordx4 v10, s[44:47], s95 offen offset:0 nt lds
v_mfma_f32_32x32x16_bf16 v[128:143], v[244:247], a[148:151], v[128:143]
v_max3_f32 v27, v27, v122, v123
buffer_load_dwordx4 v10, s[44:47], s95 offen offset:1024 nt lds
v_mfma_f32_32x32x16_bf16 v[128:143], v[248:251], a[152:155], v[128:143]
v_max3_f32 v27, v27, v124, v125
v_mfma_f32_32x32x16_bf16 v[128:143], v[252:255], a[156:159], v[128:143]
v_max3_f32 v27, v27, v126, v127
s_waitcnt lgkmcnt(0)
v_mov_b32 v19, v3
v_xor_b32 v20, 64, v19
v_xor_b32 v21, 128, v19
v_xor_b32 v22, 192, v19
s_waitcnt vmcnt(17)
s_barrier
v_mfma_f32_32x32x16_bf16 v[144:159], a[64:67], a[128:131], 0
ds_read_b64_tr_b16 v[224:225], v19 offset:16384
ds_read_b64_tr_b16 v[226:227], v19 offset:18432
ds_read_b64_tr_b16 v[232:233], v20 offset:16384
v_max3_f32 v27, v27, v128, v129
v_mfma_f32_32x32x16_bf16 v[144:159], a[68:71], a[132:135], v[144:159]
ds_read_b64_tr_b16 v[234:235], v20 offset:18432
ds_read_b64_tr_b16 v[240:241], v21 offset:16384
ds_read_b64_tr_b16 v[242:243], v21 offset:18432
v_max3_f32 v27, v27, v130, v131
v_mfma_f32_32x32x16_bf16 v[144:159], a[72:75], a[136:139], v[144:159]
ds_read_b64_tr_b16 v[248:249], v22 offset:16384
ds_read_b64_tr_b16 v[250:251], v22 offset:18432
ds_read_b64_tr_b16 v[228:229], v19 offset:20480
v_max3_f32 v27, v27, v132, v133
v_mfma_f32_32x32x16_bf16 v[144:159], a[76:79], a[140:143], v[144:159]
ds_read_b64_tr_b16 v[230:231], v19 offset:22528
ds_read_b64_tr_b16 v[236:237], v20 offset:20480
ds_read_b64_tr_b16 v[238:239], v20 offset:22528
v_max3_f32 v27, v27, v134, v135
v_mfma_f32_32x32x16_bf16 v[144:159], a[80:83], a[144:147], v[144:159]
ds_read_b64_tr_b16 v[244:245], v21 offset:20480
ds_read_b64_tr_b16 v[246:247], v21 offset:22528
ds_read_b64_tr_b16 v[252:253], v22 offset:20480
v_max3_f32 v27, v27, v136, v137
s_add_u32 s95, s3, 7
s_and_b32 s95, s95, 15
s_lshl_b32 s95, s95, 13
s_add_u32 s95, s95, s83
s_add_u32 m0, s94, 8192
s_nop 0
buffer_load_dwordx4 v10, s[44:47], s95 offen offset:0 nt lds
v_mfma_f32_32x32x16_bf16 v[144:159], a[84:87], a[148:151], v[144:159]
ds_read_b64_tr_b16 v[254:255], v22 offset:22528
v_max3_f32 v27, v27, v138, v139
buffer_load_dwordx4 v10, s[44:47], s95 offen offset:1024 nt lds
v_mfma_f32_32x32x16_bf16 v[144:159], a[88:91], a[152:155], v[144:159]
v_max3_f32 v27, v27, v140, v141
v_mfma_f32_32x32x16_bf16 v[144:159], a[92:95], a[156:159], v[144:159]
v_max3_f32 v27, v27, v142, v143
s_waitcnt lgkmcnt(0)
s_waitcnt vmcnt(17)
s_barrier
s_waitcnt vmcnt(4)
v_mov_b32 v24, s100
v_mov_b32 v25, s101
s_lshl_b32 s92, s26, 3
v_mov_b32 v26, s92
s_mov_b64 exec, 1
buffer_store_dwordx2 v[24:25], v26, s[76:79], s99 offen offset:128 sc1
s_mov_b64 exec, -1
v_max3_f32 v27, v27, v144, v145
v_max3_f32 v27, v27, v146, v147
v_max3_f32 v27, v27, v148, v149
v_max3_f32 v27, v27, v150, v151
v_max3_f32 v27, v27, v152, v153
v_max3_f32 v27, v27, v154, v155
v_max3_f32 v27, v27, v156, v157
v_max3_f32 v27, v27, v158, v159
v_mov_b32 v31, v27
s_nop 1
v_permlane32_swap_b32 v27, v31
v_max_f32 v27, v27, v31
v_mov_b32 v29, 0
v_mov_b32 v30, 0
v_mul_f32 v28, s91, v27
v_sub_f32 v28, 0, v28
v_fma_f32 v32, v32, s91, v28
v_fma_f32 v33, v33, s91, v28
v_fma_f32 v34, v34, s91, v28
v_fma_f32 v35, v35, s91, v28
v_fma_f32 v36, v36, s91, v28
v_fma_f32 v37, v37, s91, v28
v_fma_f32 v38, v38, s91, v28
v_fma_f32 v39, v39, s91, v28
v_fma_f32 v40, v40, s91, v28
v_fma_f32 v41, v41, s91, v28
v_fma_f32 v42, v42, s91, v28
v_fma_f32 v43, v43, s91, v28
v_fma_f32 v44, v44, s91, v28
v_fma_f32 v45, v45, s91, v28
v_fma_f32 v46, v46, s91, v28
v_fma_f32 v47, v47, s91, v28
v_exp_f32 v32, v32
v_exp_f32 v33, v33
v_exp_f32 v34, v34
v_exp_f32 v35, v35
v_exp_f32 v36, v36
v_exp_f32 v37, v37
v_exp_f32 v38, v38
v_exp_f32 v39, v39
v_exp_f32 v40, v40
v_exp_f32 v41, v41
v_exp_f32 v42, v42
v_exp_f32 v43, v43
v_exp_f32 v44, v44
v_exp_f32 v45, v45
v_exp_f32 v46, v46
v_exp_f32 v47, v47
v_add_f32 v29, v29, v32
v_add_f32 v30, v30, v33
v_add_f32 v29, v29, v34
v_add_f32 v30, v30, v35
v_add_f32 v29, v29, v36
v_add_f32 v30, v30, v37
v_add_f32 v29, v29, v38
v_add_f32 v30, v30, v39
v_add_f32 v29, v29, v40
v_add_f32 v30, v30, v41
v_add_f32 v29, v29, v42
v_add_f32 v30, v30, v43
v_add_f32 v29, v29, v44
v_add_f32 v30, v30, v45
v_add_f32 v29, v29, v46
v_add_f32 v30, v30, v47
v_cvt_pk_bf16_f32 v32, v32, v33
v_cvt_pk_bf16_f32 v33, v34, v35
v_cvt_pk_bf16_f32 v34, v36, v37
v_cvt_pk_bf16_f32 v35, v38, v39
v_cvt_pk_bf16_f32 v36, v40, v41
v_cvt_pk_bf16_f32 v37, v42, v43
v_cvt_pk_bf16_f32 v38, v44, v45
v_cvt_pk_bf16_f32 v39, v46, v47
v_mfma_f32_32x32x16_bf16 v[160:175], v[224:227], v[32:35], 0
ds_read_b64_tr_b16 a[64:65], v19 offset:24576
ds_read_b64_tr_b16 a[66:67], v19 offset:26624
ds_read_b64_tr_b16 a[72:73], v20 offset:24576
v_fma_f32 v48, v48, s91, v28
v_fma_f32 v49, v49, s91, v28
v_fma_f32 v50, v50, s91, v28
v_fma_f32 v51, v51, s91, v28
v_fma_f32 v52, v52, s91, v28
v_fma_f32 v53, v53, s91, v28
v_fma_f32 v54, v54, s91, v28
v_mfma_f32_32x32x16_bf16 v[176:191], v[232:235], v[32:35], 0
ds_read_b64_tr_b16 a[74:75], v20 offset:26624
ds_read_b64_tr_b16 a[80:81], v21 offset:24576
ds_read_b64_tr_b16 a[82:83], v21 offset:26624
v_fma_f32 v55, v55, s91, v28
v_fma_f32 v56, v56, s91, v28
v_fma_f32 v57, v57, s91, v28
v_fma_f32 v58, v58, s91, v28
v_fma_f32 v59, v59, s91, v28
v_fma_f32 v60, v60, s91, v28
v_fma_f32 v61, v61, s91, v28
v_mfma_f32_32x32x16_bf16 v[192:207], v[240:243], v[32:35], 0
ds_read_b64_tr_b16 a[88:89], v22 offset:24576
ds_read_b64_tr_b16 a[90:91], v22 offset:26624
ds_read_b64_tr_b16 a[68:69], v19 offset:28672
v_fma_f32 v62, v62, s91, v28
v_fma_f32 v63, v63, s91, v28
v_exp_f32 v48, v48
v_exp_f32 v49, v49
v_exp_f32 v50, v50
v_exp_f32 v51, v51
v_exp_f32 v52, v52
v_mfma_f32_32x32x16_bf16 v[208:223], v[248:251], v[32:35], 0
ds_read_b64_tr_b16 a[70:71], v19 offset:30720
ds_read_b64_tr_b16 a[76:77], v20 offset:28672
ds_read_b64_tr_b16 a[78:79], v20 offset:30720
v_exp_f32 v53, v53
v_exp_f32 v54, v54
v_exp_f32 v55, v55
v_exp_f32 v56, v56
v_exp_f32 v57, v57
v_exp_f32 v58, v58
v_exp_f32 v59, v59
v_mfma_f32_32x32x16_bf16 v[160:175], v[228:231], v[36:39], v[160:175]
ds_read_b64_tr_b16 a[84:85], v21 offset:28672
ds_read_b64_tr_b16 a[86:87], v21 offset:30720
ds_read_b64_tr_b16 a[92:93], v22 offset:28672
v_exp_f32 v60, v60
v_exp_f32 v61, v61
v_exp_f32 v62, v62
v_exp_f32 v63, v63
v_add_f32 v29, v29, v48
v_add_f32 v30, v30, v49
v_add_f32 v29, v29, v50
s_add_u32 s95, s3, 8
s_and_b32 s95, s95, 15
s_lshl_b32 s95, s95, 13
s_add_u32 s95, s95, s83
s_add_u32 m0, s94, 16384
s_nop 0
buffer_load_dwordx4 v15, s[40:43], s95 offen offset:0 nt lds
v_mfma_f32_32x32x16_bf16 v[176:191], v[236:239], v[36:39], v[176:191]
ds_read_b64_tr_b16 a[94:95], v22 offset:30720
v_add_f32 v30, v30, v51
v_add_f32 v29, v29, v52
v_add_f32 v30, v30, v53
v_add_f32 v29, v29, v54
v_add_f32 v30, v30, v55
v_add_f32 v29, v29, v56
v_add_f32 v30, v30, v57
buffer_load_dwordx4 v18, s[40:43], s95 offen offset:1024 nt lds
v_mfma_f32_32x32x16_bf16 v[192:207], v[244:247], v[36:39], v[192:207]
v_add_f32 v29, v29, v58
v_add_f32 v30, v30, v59
v_add_f32 v29, v29, v60
v_add_f32 v30, v30, v61
v_add_f32 v29, v29, v62
v_add_f32 v30, v30, v63
v_cvt_pk_bf16_f32 v48, v48, v49
v_mfma_f32_32x32x16_bf16 v[208:223], v[252:255], v[36:39], v[208:223]
v_cvt_pk_bf16_f32 v49, v50, v51
v_cvt_pk_bf16_f32 v50, v52, v53
v_cvt_pk_bf16_f32 v51, v54, v55
v_cvt_pk_bf16_f32 v52, v56, v57
v_cvt_pk_bf16_f32 v53, v58, v59
v_cvt_pk_bf16_f32 v54, v60, v61
v_cvt_pk_bf16_f32 v55, v62, v63
s_waitcnt lgkmcnt(0)
s_barrier
v_mfma_f32_32x32x16_bf16 v[160:175], a[64:67], v[48:51], v[160:175]
ds_read_b64_tr_b16 v[224:225], v19 offset:32768
ds_read_b64_tr_b16 v[226:227], v19 offset:34816
ds_read_b64_tr_b16 v[232:233], v20 offset:32768
v_fma_f32 v64, v64, s91, v28
v_fma_f32 v65, v65, s91, v28
v_fma_f32 v66, v66, s91, v28
v_fma_f32 v67, v67, s91, v28
v_fma_f32 v68, v68, s91, v28
v_fma_f32 v69, v69, s91, v28
v_fma_f32 v70, v70, s91, v28
v_mfma_f32_32x32x16_bf16 v[176:191], a[72:75], v[48:51], v[176:191]
ds_read_b64_tr_b16 v[234:235], v20 offset:34816
ds_read_b64_tr_b16 v[240:241], v21 offset:32768
ds_read_b64_tr_b16 v[242:243], v21 offset:34816
v_fma_f32 v71, v71, s91, v28
v_fma_f32 v72, v72, s91, v28
v_fma_f32 v73, v73, s91, v28
v_fma_f32 v74, v74, s91, v28
v_fma_f32 v75, v75, s91, v28
v_fma_f32 v76, v76, s91, v28
v_fma_f32 v77, v77, s91, v28
v_mfma_f32_32x32x16_bf16 v[192:207], a[80:83], v[48:51], v[192:207]
ds_read_b64_tr_b16 v[248:249], v22 offset:32768
ds_read_b64_tr_b16 v[250:251], v22 offset:34816
ds_read_b64_tr_b16 v[228:229], v19 offset:36864
v_fma_f32 v78, v78, s91, v28
v_fma_f32 v79, v79, s91, v28
v_exp_f32 v64, v64
v_exp_f32 v65, v65
v_exp_f32 v66, v66
v_exp_f32 v67, v67
v_exp_f32 v68, v68
v_mfma_f32_32x32x16_bf16 v[208:223], a[88:91], v[48:51], v[208:223]
ds_read_b64_tr_b16 v[230:231], v19 offset:38912
ds_read_b64_tr_b16 v[236:237], v20 offset:36864
ds_read_b64_tr_b16 v[238:239], v20 offset:38912
v_exp_f32 v69, v69
v_exp_f32 v70, v70
v_exp_f32 v71, v71
v_exp_f32 v72, v72
v_exp_f32 v73, v73
v_exp_f32 v74, v74
v_exp_f32 v75, v75
v_mfma_f32_32x32x16_bf16 v[160:175], a[68:71], v[52:55], v[160:175]
ds_read_b64_tr_b16 v[244:245], v21 offset:36864
ds_read_b64_tr_b16 v[246:247], v21 offset:38912
ds_read_b64_tr_b16 v[252:253], v22 offset:36864
v_exp_f32 v76, v76
v_exp_f32 v77, v77
v_exp_f32 v78, v78
v_exp_f32 v79, v79
v_add_f32 v29, v29, v64
v_add_f32 v30, v30, v65
v_add_f32 v29, v29, v66
s_add_u32 s95, s3, 9
s_and_b32 s95, s95, 15
s_lshl_b32 s95, s95, 13
s_add_u32 s95, s95, s83
s_add_u32 m0, s94, 24576
s_nop 0
buffer_load_dwordx4 v15, s[40:43], s95 offen offset:0 nt lds
v_mfma_f32_32x32x16_bf16 v[176:191], a[76:79], v[52:55], v[176:191]
ds_read_b64_tr_b16 v[254:255], v22 offset:38912
v_add_f32 v30, v30, v67
v_add_f32 v29, v29, v68
v_add_f32 v30, v30, v69
v_add_f32 v29, v29, v70
v_add_f32 v30, v30, v71
v_add_f32 v29, v29, v72
v_add_f32 v30, v30, v73
buffer_load_dwordx4 v18, s[40:43], s95 offen offset:1024 nt lds
v_mfma_f32_32x32x16_bf16 v[192:207], a[84:87], v[52:55], v[192:207]
v_add_f32 v29, v29, v74
v_add_f32 v30, v30, v75
v_add_f32 v29, v29, v76
v_add_f32 v30, v30, v77
v_add_f32 v29, v29, v78
v_add_f32 v30, v30, v79
v_cvt_pk_bf16_f32 v64, v64, v65
v_mfma_f32_32x32x16_bf16 v[208:223], a[92:95], v[52:55], v[208:223]
v_cvt_pk_bf16_f32 v65, v66, v67
v_cvt_pk_bf16_f32 v66, v68, v69
v_cvt_pk_bf16_f32 v67, v70, v71
v_cvt_pk_bf16_f32 v68, v72, v73
v_cvt_pk_bf16_f32 v69, v74, v75
v_cvt_pk_bf16_f32 v70, v76, v77
v_cvt_pk_bf16_f32 v71, v78, v79
s_waitcnt lgkmcnt(0)
s_barrier
v_mfma_f32_32x32x16_bf16 v[160:175], v[224:227], v[64:67], v[160:175]
ds_read_b64_tr_b16 a[64:65], v19 offset:40960
ds_read_b64_tr_b16 a[66:67], v19 offset:43008
ds_read_b64_tr_b16 a[72:73], v20 offset:40960
v_fma_f32 v80, v80, s91, v28
v_fma_f32 v81, v81, s91, v28
v_fma_f32 v82, v82, s91, v28
v_fma_f32 v83, v83, s91, v28
v_fma_f32 v84, v84, s91, v28
v_fma_f32 v85, v85, s91, v28
v_fma_f32 v86, v86, s91, v28
v_mfma_f32_32x32x16_bf16 v[176:191], v[232:235], v[64:67], v[176:191]
ds_read_b64_tr_b16 a[74:75], v20 offset:43008
ds_read_b64_tr_b16 a[80:81], v21 offset:40960
ds_read_b64_tr_b16 a[82:83], v21 offset:43008
v_fma_f32 v87, v87, s91, v28
v_fma_f32 v88, v88, s91, v28
v_fma_f32 v89, v89, s91, v28
v_fma_f32 v90, v90, s91, v28
v_fma_f32 v91, v91, s91, v28
v_fma_f32 v92, v92, s91, v28
v_fma_f32 v93, v93, s91, v28
v_mfma_f32_32x32x16_bf16 v[192:207], v[240:243], v[64:67], v[192:207]
ds_read_b64_tr_b16 a[88:89], v22 offset:40960
ds_read_b64_tr_b16 a[90:91], v22 offset:43008
ds_read_b64_tr_b16 a[68:69], v19 offset:45056
v_fma_f32 v94, v94, s91, v28
v_fma_f32 v95, v95, s91, v28
v_exp_f32 v80, v80
v_exp_f32 v81, v81
v_exp_f32 v82, v82
v_exp_f32 v83, v83
v_exp_f32 v84, v84
v_mfma_f32_32x32x16_bf16 v[208:223], v[248:251], v[64:67], v[208:223]
ds_read_b64_tr_b16 a[70:71], v19 offset:47104
ds_read_b64_tr_b16 a[76:77], v20 offset:45056
ds_read_b64_tr_b16 a[78:79], v20 offset:47104
v_exp_f32 v85, v85
v_exp_f32 v86, v86
v_exp_f32 v87, v87
v_exp_f32 v88, v88
v_exp_f32 v89, v89
v_exp_f32 v90, v90
v_exp_f32 v91, v91
v_mfma_f32_32x32x16_bf16 v[160:175], v[228:231], v[68:71], v[160:175]
ds_read_b64_tr_b16 a[84:85], v21 offset:45056
ds_read_b64_tr_b16 a[86:87], v21 offset:47104
ds_read_b64_tr_b16 a[92:93], v22 offset:45056
v_exp_f32 v92, v92
v_exp_f32 v93, v93
v_exp_f32 v94, v94
v_exp_f32 v95, v95
v_add_f32 v29, v29, v80
v_add_f32 v30, v30, v81
v_add_f32 v29, v29, v82
s_add_u32 s95, s3, 10
s_and_b32 s95, s95, 15
s_lshl_b32 s95, s95, 13
s_add_u32 s95, s95, s83
s_add_u32 m0, s94, 32768
s_nop 0
buffer_load_dwordx4 v15, s[40:43], s95 offen offset:0 nt lds
v_mfma_f32_32x32x16_bf16 v[176:191], v[236:239], v[68:71], v[176:191]
ds_read_b64_tr_b16 a[94:95], v22 offset:47104
v_add_f32 v30, v30, v83
v_add_f32 v29, v29, v84
v_add_f32 v30, v30, v85
v_add_f32 v29, v29, v86
v_add_f32 v30, v30, v87
v_add_f32 v29, v29, v88
v_add_f32 v30, v30, v89
buffer_load_dwordx4 v18, s[40:43], s95 offen offset:1024 nt lds
v_mfma_f32_32x32x16_bf16 v[192:207], v[244:247], v[68:71], v[192:207]
v_add_f32 v29, v29, v90
v_add_f32 v30, v30, v91
v_add_f32 v29, v29, v92
v_add_f32 v30, v30, v93
v_add_f32 v29, v29, v94
v_add_f32 v30, v30, v95
v_cvt_pk_bf16_f32 v80, v80, v81
v_mfma_f32_32x32x16_bf16 v[208:223], v[252:255], v[68:71], v[208:223]
v_cvt_pk_bf16_f32 v81, v82, v83
v_cvt_pk_bf16_f32 v82, v84, v85
v_cvt_pk_bf16_f32 v83, v86, v87
v_cvt_pk_bf16_f32 v84, v88, v89
v_cvt_pk_bf16_f32 v85, v90, v91
v_cvt_pk_bf16_f32 v86, v92, v93
v_cvt_pk_bf16_f32 v87, v94, v95
s_waitcnt lgkmcnt(0)
s_barrier
v_mfma_f32_32x32x16_bf16 v[160:175], a[64:67], v[80:83], v[160:175]
ds_read_b64_tr_b16 v[224:225], v19 offset:49152
ds_read_b64_tr_b16 v[226:227], v19 offset:51200
ds_read_b64_tr_b16 v[232:233], v20 offset:49152
v_fma_f32 v96, v96, s91, v28
v_fma_f32 v97, v97, s91, v28
v_fma_f32 v98, v98, s91, v28
v_fma_f32 v99, v99, s91, v28
v_fma_f32 v100, v100, s91, v28
v_fma_f32 v101, v101, s91, v28
v_fma_f32 v102, v102, s91, v28
v_mfma_f32_32x32x16_bf16 v[176:191], a[72:75], v[80:83], v[176:191]
ds_read_b64_tr_b16 v[234:235], v20 offset:51200
ds_read_b64_tr_b16 v[240:241], v21 offset:49152
ds_read_b64_tr_b16 v[242:243], v21 offset:51200
v_fma_f32 v103, v103, s91, v28
v_fma_f32 v104, v104, s91, v28
v_fma_f32 v105, v105, s91, v28
v_fma_f32 v106, v106, s91, v28
v_fma_f32 v107, v107, s91, v28
v_fma_f32 v108, v108, s91, v28
v_fma_f32 v109, v109, s91, v28
v_mfma_f32_32x32x16_bf16 v[192:207], a[80:83], v[80:83], v[192:207]
ds_read_b64_tr_b16 v[248:249], v22 offset:49152
ds_read_b64_tr_b16 v[250:251], v22 offset:51200
ds_read_b64_tr_b16 v[228:229], v19 offset:53248
v_fma_f32 v110, v110, s91, v28
v_fma_f32 v111, v111, s91, v28
v_exp_f32 v96, v96
v_exp_f32 v97, v97
v_exp_f32 v98, v98
v_exp_f32 v99, v99
v_exp_f32 v100, v100
v_mfma_f32_32x32x16_bf16 v[208:223], a[88:91], v[80:83], v[208:223]
ds_read_b64_tr_b16 v[230:231], v19 offset:55296
ds_read_b64_tr_b16 v[236:237], v20 offset:53248
ds_read_b64_tr_b16 v[238:239], v20 offset:55296
v_exp_f32 v101, v101
v_exp_f32 v102, v102
v_exp_f32 v103, v103
v_exp_f32 v104, v104
v_exp_f32 v105, v105
v_exp_f32 v106, v106
v_exp_f32 v107, v107
v_mfma_f32_32x32x16_bf16 v[160:175], a[68:71], v[84:87], v[160:175]
ds_read_b64_tr_b16 v[244:245], v21 offset:53248
ds_read_b64_tr_b16 v[246:247], v21 offset:55296
ds_read_b64_tr_b16 v[252:253], v22 offset:53248
v_exp_f32 v108, v108
v_exp_f32 v109, v109
v_exp_f32 v110, v110
v_exp_f32 v111, v111
v_add_f32 v29, v29, v96
v_add_f32 v30, v30, v97
v_add_f32 v29, v29, v98
s_add_u32 s95, s3, 11
s_and_b32 s95, s95, 15
s_lshl_b32 s95, s95, 13
s_add_u32 s95, s95, s83
s_add_u32 m0, s94, 40960
s_nop 0
buffer_load_dwordx4 v15, s[40:43], s95 offen offset:0 nt lds
v_mfma_f32_32x32x16_bf16 v[176:191], a[76:79], v[84:87], v[176:191]
ds_read_b64_tr_b16 v[254:255], v22 offset:55296
v_add_f32 v30, v30, v99
v_add_f32 v29, v29, v100
v_add_f32 v30, v30, v101
v_add_f32 v29, v29, v102
v_add_f32 v30, v30, v103
v_add_f32 v29, v29, v104
v_add_f32 v30, v30, v105
buffer_load_dwordx4 v18, s[40:43], s95 offen offset:1024 nt lds
v_mfma_f32_32x32x16_bf16 v[192:207], a[84:87], v[84:87], v[192:207]
v_add_f32 v29, v29, v106
v_add_f32 v30, v30, v107
v_add_f32 v29, v29, v108
v_add_f32 v30, v30, v109
v_add_f32 v29, v29, v110
v_add_f32 v30, v30, v111
v_cvt_pk_bf16_f32 v96, v96, v97
v_mfma_f32_32x32x16_bf16 v[208:223], a[92:95], v[84:87], v[208:223]
v_cvt_pk_bf16_f32 v97, v98, v99
v_cvt_pk_bf16_f32 v98, v100, v101
v_cvt_pk_bf16_f32 v99, v102, v103
v_cvt_pk_bf16_f32 v100, v104, v105
v_cvt_pk_bf16_f32 v101, v106, v107
v_cvt_pk_bf16_f32 v102, v108, v109
v_cvt_pk_bf16_f32 v103, v110, v111
s_waitcnt lgkmcnt(0)
s_barrier
v_mfma_f32_32x32x16_bf16 v[160:175], v[224:227], v[96:99], v[160:175]
ds_read_b64_tr_b16 a[64:65], v19 offset:57344
ds_read_b64_tr_b16 a[66:67], v19 offset:59392
ds_read_b64_tr_b16 a[72:73], v20 offset:57344
v_fma_f32 v112, v112, s91, v28
v_fma_f32 v113, v113, s91, v28
v_fma_f32 v114, v114, s91, v28
v_fma_f32 v115, v115, s91, v28
v_fma_f32 v116, v116, s91, v28
v_fma_f32 v117, v117, s91, v28
v_fma_f32 v118, v118, s91, v28
v_mfma_f32_32x32x16_bf16 v[176:191], v[232:235], v[96:99], v[176:191]
ds_read_b64_tr_b16 a[74:75], v20 offset:59392
ds_read_b64_tr_b16 a[80:81], v21 offset:57344
ds_read_b64_tr_b16 a[82:83], v21 offset:59392
v_fma_f32 v119, v119, s91, v28
v_fma_f32 v120, v120, s91, v28
v_fma_f32 v121, v121, s91, v28
v_fma_f32 v122, v122, s91, v28
v_fma_f32 v123, v123, s91, v28
v_fma_f32 v124, v124, s91, v28
v_fma_f32 v125, v125, s91, v28
v_mfma_f32_32x32x16_bf16 v[192:207], v[240:243], v[96:99], v[192:207]
ds_read_b64_tr_b16 a[88:89], v22 offset:57344
ds_read_b64_tr_b16 a[90:91], v22 offset:59392
ds_read_b64_tr_b16 a[68:69], v19 offset:61440
v_fma_f32 v126, v126, s91, v28
v_fma_f32 v127, v127, s91, v28
v_exp_f32 v112, v112
v_exp_f32 v113, v113
v_exp_f32 v114, v114
v_exp_f32 v115, v115
v_exp_f32 v116, v116
v_mfma_f32_32x32x16_bf16 v[208:223], v[248:251], v[96:99], v[208:223]
ds_read_b64_tr_b16 a[70:71], v19 offset:63488
ds_read_b64_tr_b16 a[76:77], v20 offset:61440
ds_read_b64_tr_b16 a[78:79], v20 offset:63488
v_exp_f32 v117, v117
v_exp_f32 v118, v118
v_exp_f32 v119, v119
v_exp_f32 v120, v120
v_exp_f32 v121, v121
v_exp_f32 v122, v122
v_exp_f32 v123, v123
v_mfma_f32_32x32x16_bf16 v[160:175], v[228:231], v[100:103], v[160:175]
ds_read_b64_tr_b16 a[84:85], v21 offset:61440
ds_read_b64_tr_b16 a[86:87], v21 offset:63488
ds_read_b64_tr_b16 a[92:93], v22 offset:61440
v_exp_f32 v124, v124
v_exp_f32 v125, v125
v_exp_f32 v126, v126
v_exp_f32 v127, v127
v_add_f32 v29, v29, v112
v_add_f32 v30, v30, v113
v_add_f32 v29, v29, v114
s_add_u32 s95, s3, 12
s_and_b32 s95, s95, 15
s_lshl_b32 s95, s95, 13
s_add_u32 s95, s95, s83
s_add_u32 m0, s94, 49152
s_nop 0
buffer_load_dwordx4 v15, s[40:43], s95 offen offset:0 nt lds
v_mfma_f32_32x32x16_bf16 v[176:191], v[236:239], v[100:103], v[176:191]
ds_read_b64_tr_b16 a[94:95], v22 offset:63488
v_add_f32 v30, v30, v115
v_add_f32 v29, v29, v116
v_add_f32 v30, v30, v117
v_add_f32 v29, v29, v118
v_add_f32 v30, v30, v119
v_add_f32 v29, v29, v120
v_add_f32 v30, v30, v121
buffer_load_dwordx4 v18, s[40:43], s95 offen offset:1024 nt lds
v_mfma_f32_32x32x16_bf16 v[192:207], v[244:247], v[100:103], v[192:207]
v_add_f32 v29, v29, v122
v_add_f32 v30, v30, v123
v_add_f32 v29, v29, v124
v_add_f32 v30, v30, v125
v_add_f32 v29, v29, v126
v_add_f32 v30, v30, v127
v_cvt_pk_bf16_f32 v112, v112, v113
v_mfma_f32_32x32x16_bf16 v[208:223], v[252:255], v[100:103], v[208:223]
v_cvt_pk_bf16_f32 v113, v114, v115
v_cvt_pk_bf16_f32 v114, v116, v117
v_cvt_pk_bf16_f32 v115, v118, v119
v_cvt_pk_bf16_f32 v116, v120, v121
v_cvt_pk_bf16_f32 v117, v122, v123
v_cvt_pk_bf16_f32 v118, v124, v125
v_cvt_pk_bf16_f32 v119, v126, v127
s_waitcnt lgkmcnt(0)
s_waitcnt vmcnt(13)
s_barrier
v_mfma_f32_32x32x16_bf16 v[160:175], a[64:67], v[112:115], v[160:175]
ds_read_b64_tr_b16 v[224:225], v19 offset:0
ds_read_b64_tr_b16 v[226:227], v19 offset:2048
ds_read_b64_tr_b16 v[232:233], v20 offset:0
v_fma_f32 v128, v128, s91, v28
v_fma_f32 v129, v129, s91, v28
v_fma_f32 v130, v130, s91, v28
v_fma_f32 v131, v131, s91, v28
v_fma_f32 v132, v132, s91, v28
v_fma_f32 v133, v133, s91, v28
v_fma_f32 v134, v134, s91, v28
v_mfma_f32_32x32x16_bf16 v[176:191], a[72:75], v[112:115], v[176:191]
ds_read_b64_tr_b16 v[234:235], v20 offset:2048
ds_read_b64_tr_b16 v[240:241], v21 offset:0
ds_read_b64_tr_b16 v[242:243], v21 offset:2048
v_fma_f32 v135, v135, s91, v28
v_fma_f32 v136, v136, s91, v28
v_fma_f32 v137, v137, s91, v28
v_fma_f32 v138, v138, s91, v28
v_fma_f32 v139, v139, s91, v28
v_fma_f32 v140, v140, s91, v28
v_fma_f32 v141, v141, s91, v28
v_mfma_f32_32x32x16_bf16 v[192:207], a[80:83], v[112:115], v[192:207]
ds_read_b64_tr_b16 v[248:249], v22 offset:0
ds_read_b64_tr_b16 v[250:251], v22 offset:2048
ds_read_b64_tr_b16 v[228:229], v19 offset:4096
v_fma_f32 v142, v142, s91, v28
v_fma_f32 v143, v143, s91, v28
v_exp_f32 v128, v128
v_exp_f32 v129, v129
v_exp_f32 v130, v130
v_exp_f32 v131, v131
v_exp_f32 v132, v132
v_mfma_f32_32x32x16_bf16 v[208:223], a[88:91], v[112:115], v[208:223]
ds_read_b64_tr_b16 v[230:231], v19 offset:6144
ds_read_b64_tr_b16 v[236:237], v20 offset:4096
ds_read_b64_tr_b16 v[238:239], v20 offset:6144
v_exp_f32 v133, v133
v_exp_f32 v134, v134
v_exp_f32 v135, v135
v_exp_f32 v136, v136
v_exp_f32 v137, v137
v_exp_f32 v138, v138
v_exp_f32 v139, v139
v_mfma_f32_32x32x16_bf16 v[160:175], a[68:71], v[116:119], v[160:175]
ds_read_b64_tr_b16 v[244:245], v21 offset:4096
ds_read_b64_tr_b16 v[246:247], v21 offset:6144
ds_read_b64_tr_b16 v[252:253], v22 offset:4096
v_exp_f32 v140, v140
v_exp_f32 v141, v141
v_exp_f32 v142, v142
v_exp_f32 v143, v143
v_add_f32 v29, v29, v128
v_add_f32 v30, v30, v129
v_add_f32 v29, v29, v130
s_add_u32 s95, s3, 13
s_and_b32 s95, s95, 15
s_lshl_b32 s95, s95, 13
s_add_u32 s95, s95, s83
s_add_u32 m0, s94, 57344
s_nop 0
buffer_load_dwordx4 v15, s[40:43], s95 offen offset:0 nt lds
v_mfma_f32_32x32x16_bf16 v[176:191], a[76:79], v[116:119], v[176:191]
ds_read_b64_tr_b16 v[254:255], v22 offset:6144
v_add_f32 v30, v30, v131
v_add_f32 v29, v29, v132
v_add_f32 v30, v30, v133
v_add_f32 v29, v29, v134
v_add_f32 v30, v30, v135
v_add_f32 v29, v29, v136
v_add_f32 v30, v30, v137
buffer_load_dwordx4 v18, s[40:43], s95 offen offset:1024 nt lds
v_mfma_f32_32x32x16_bf16 v[192:207], a[84:87], v[116:119], v[192:207]
v_add_f32 v29, v29, v138
v_add_f32 v30, v30, v139
v_add_f32 v29, v29, v140
v_add_f32 v30, v30, v141
v_add_f32 v29, v29, v142
v_add_f32 v30, v30, v143
v_cvt_pk_bf16_f32 v128, v128, v129
v_mfma_f32_32x32x16_bf16 v[208:223], a[92:95], v[116:119], v[208:223]
v_cvt_pk_bf16_f32 v129, v130, v131
v_cvt_pk_bf16_f32 v130, v132, v133
v_cvt_pk_bf16_f32 v131, v134, v135
v_cvt_pk_bf16_f32 v132, v136, v137
v_cvt_pk_bf16_f32 v133, v138, v139
v_cvt_pk_bf16_f32 v134, v140, v141
v_cvt_pk_bf16_f32 v135, v142, v143
s_waitcnt lgkmcnt(0)
s_waitcnt vmcnt(13)
s_barrier
v_mfma_f32_32x32x16_bf16 v[160:175], v[224:227], v[128:131], v[160:175]
ds_read_b64_tr_b16 a[64:65], v19 offset:8192
ds_read_b64_tr_b16 a[66:67], v19 offset:10240
ds_read_b64_tr_b16 a[72:73], v20 offset:8192
v_fma_f32 v144, v144, s91, v28
v_fma_f32 v145, v145, s91, v28
v_fma_f32 v146, v146, s91, v28
v_fma_f32 v147, v147, s91, v28
v_fma_f32 v148, v148, s91, v28
v_fma_f32 v149, v149, s91, v28
v_fma_f32 v150, v150, s91, v28
v_mfma_f32_32x32x16_bf16 v[176:191], v[232:235], v[128:131], v[176:191]
ds_read_b64_tr_b16 a[74:75], v20 offset:10240
ds_read_b64_tr_b16 a[80:81], v21 offset:8192
ds_read_b64_tr_b16 a[82:83], v21 offset:10240
v_fma_f32 v151, v151, s91, v28
v_fma_f32 v152, v152, s91, v28
v_fma_f32 v153, v153, s91, v28
v_fma_f32 v154, v154, s91, v28
v_fma_f32 v155, v155, s91, v28
v_fma_f32 v156, v156, s91, v28
v_fma_f32 v157, v157, s91, v28
v_mfma_f32_32x32x16_bf16 v[192:207], v[240:243], v[128:131], v[192:207]
ds_read_b64_tr_b16 a[88:89], v22 offset:8192
ds_read_b64_tr_b16 a[90:91], v22 offset:10240
ds_read_b64_tr_b16 a[68:69], v19 offset:12288
v_fma_f32 v158, v158, s91, v28
v_fma_f32 v159, v159, s91, v28
v_exp_f32 v144, v144
v_exp_f32 v145, v145
v_exp_f32 v146, v146
v_exp_f32 v147, v147
v_exp_f32 v148, v148
v_mfma_f32_32x32x16_bf16 v[208:223], v[248:251], v[128:131], v[208:223]
ds_read_b64_tr_b16 a[70:71], v19 offset:14336
ds_read_b64_tr_b16 a[76:77], v20 offset:12288
ds_read_b64_tr_b16 a[78:79], v20 offset:14336
v_exp_f32 v149, v149
v_exp_f32 v150, v150
v_exp_f32 v151, v151
v_exp_f32 v152, v152
v_exp_f32 v153, v153
v_exp_f32 v154, v154
v_exp_f32 v155, v155
v_mfma_f32_32x32x16_bf16 v[160:175], v[228:231], v[132:135], v[160:175]
ds_read_b64_tr_b16 a[84:85], v21 offset:12288
ds_read_b64_tr_b16 a[86:87], v21 offset:14336
ds_read_b64_tr_b16 a[92:93], v22 offset:12288
v_exp_f32 v156, v156
v_exp_f32 v157, v157
v_exp_f32 v158, v158
v_exp_f32 v159, v159
v_add_f32 v29, v29, v144
v_add_f32 v30, v30, v145
v_add_f32 v29, v29, v146
s_add_u32 s95, s3, 14
s_and_b32 s95, s95, 15
s_lshl_b32 s95, s95, 13
s_add_u32 s95, s95, s83
s_add_u32 m0, s94, 0
s_nop 0
buffer_load_dwordx4 v15, s[40:43], s95 offen offset:0 nt lds
v_mfma_f32_32x32x16_bf16 v[176:191], v[236:239], v[132:135], v[176:191]
ds_read_b64_tr_b16 a[94:95], v22 offset:14336
v_add_f32 v30, v30, v147
v_add_f32 v29, v29, v148
v_add_f32 v30, v30, v149
v_add_f32 v29, v29, v150
v_add_f32 v30, v30, v151
v_add_f32 v29, v29, v152
v_add_f32 v30, v30, v153
buffer_load_dwordx4 v18, s[40:43], s95 offen offset:1024 nt lds
v_mfma_f32_32x32x16_bf16 v[192:207], v[244:247], v[132:135], v[192:207]
v_add_f32 v29, v29, v154
v_add_f32 v30, v30, v155
v_add_f32 v29, v29, v156
v_add_f32 v30, v30, v157
v_add_f32 v29, v29, v158
v_add_f32 v30, v30, v159
v_cvt_pk_bf16_f32 v144, v144, v145
v_mfma_f32_32x32x16_bf16 v[208:223], v[252:255], v[132:135], v[208:223]
v_cvt_pk_bf16_f32 v145, v146, v147
v_cvt_pk_bf16_f32 v146, v148, v149
v_cvt_pk_bf16_f32 v147, v150, v151
v_cvt_pk_bf16_f32 v148, v152, v153
v_cvt_pk_bf16_f32 v149, v154, v155
v_cvt_pk_bf16_f32 v150, v156, v157
v_cvt_pk_bf16_f32 v151, v158, v159
s_waitcnt lgkmcnt(0)
v_add_u32 v19, s84, v2
v_xor_b32 v20, 32, v19
v_xor_b32 v21, 64, v19
v_xor_b32 v22, 96, v19
v_xor_b32 v23, 128, v19
v_xor_b32 v24, 160, v19
v_xor_b32 v25, 192, v19
v_xor_b32 v26, 224, v19
s_waitcnt vmcnt(12)
s_barrier
v_mfma_f32_32x32x16_bf16 v[160:175], a[64:67], v[144:147], v[160:175]
ds_read_b128 v[224:227], v19 offset:16384
ds_read_b128 v[228:231], v20 offset:16384
v_accvgpr_write_b32 a160, v27
v_mfma_f32_32x32x16_bf16 v[176:191], a[72:75], v[144:147], v[176:191]
ds_read_b128 v[232:235], v21 offset:16384
ds_read_b128 v[236:239], v22 offset:16384
v_mfma_f32_32x32x16_bf16 v[192:207], a[80:83], v[144:147], v[192:207]
ds_read_b128 v[240:243], v23 offset:16384
ds_read_b128 v[244:247], v24 offset:16384
v_mfma_f32_32x32x16_bf16 v[208:223], a[88:91], v[144:147], v[208:223]
ds_read_b128 v[248:251], v25 offset:16384
ds_read_b128 v[252:255], v26 offset:16384
v_mfma_f32_32x32x16_bf16 v[160:175], a[68:71], v[148:151], v[160:175]
s_add_u32 s95, s3, 15
s_and_b32 s95, s95, 15
s_lshl_b32 s95, s95, 13
s_add_u32 s95, s95, s83
s_add_u32 m0, s94, 8192
s_nop 0
buffer_load_dwordx4 v15, s[40:43], s95 offen offset:0 nt lds
v_mfma_f32_32x32x16_bf16 v[176:191], a[76:79], v[148:151], v[176:191]
buffer_load_dwordx4 v18, s[40:43], s95 offen offset:1024 nt lds
v_mfma_f32_32x32x16_bf16 v[192:207], a[84:87], v[148:151], v[192:207]
v_mfma_f32_32x32x16_bf16 v[208:223], a[92:95], v[148:151], v[208:223]
s_waitcnt lgkmcnt(0)
s_waitcnt vmcnt(12)
s_barrier
v_mfma_f32_32x32x16_bf16 v[32:47], v[224:227], a[128:131], 0
ds_read_b128 a[64:67], v19 offset:24576
ds_read_b128 a[68:71], v20 offset:24576
v_mfma_f32_32x32x16_bf16 v[32:47], v[228:231], a[132:135], v[32:47]
ds_read_b128 a[72:75], v21 offset:24576
ds_read_b128 a[76:79], v22 offset:24576
v_mfma_f32_32x32x16_bf16 v[32:47], v[232:235], a[136:139], v[32:47]
ds_read_b128 a[80:83], v23 offset:24576
ds_read_b128 a[84:87], v24 offset:24576
v_mfma_f32_32x32x16_bf16 v[32:47], v[236:239], a[140:143], v[32:47]
ds_read_b128 a[88:91], v25 offset:24576
ds_read_b128 a[92:95], v26 offset:24576
v_mfma_f32_32x32x16_bf16 v[32:47], v[240:243], a[144:147], v[32:47]
s_add_u32 s95, s3, 8
s_and_b32 s95, s95, 15
s_lshl_b32 s95, s95, 13
s_add_u32 s95, s95, s83
s_add_u32 m0, s94, 16384
s_nop 0
buffer_load_dwordx4 v10, s[44:47], s95 offen offset:0 nt lds
v_mfma_f32_32x32x16_bf16 v[32:47], v[244:247], a[148:151], v[32:47]
buffer_load_dwordx4 v10, s[44:47], s95 offen offset:1024 nt lds
v_mfma_f32_32x32x16_bf16 v[32:47], v[248:251], a[152:155], v[32:47]
v_mfma_f32_32x32x16_bf16 v[32:47], v[252:255], a[156:159], v[32:47]
s_waitcnt lgkmcnt(0)
s_waitcnt vmcnt(12)
s_barrier
v_mfma_f32_32x32x16_bf16 v[48:63], a[64:67], a[128:131], 0
ds_read_b128 v[224:227], v19 offset:32768
ds_read_b128 v[228:231], v20 offset:32768
s_nop 5
v_max3_f32 v27, v27, v32, v33
v_mfma_f32_32x32x16_bf16 v[48:63], a[68:71], a[132:135], v[48:63]
ds_read_b128 v[232:235], v21 offset:32768
ds_read_b128 v[236:239], v22 offset:32768
v_max3_f32 v27, v27, v34, v35
v_mfma_f32_32x32x16_bf16 v[48:63], a[72:75], a[136:139], v[48:63]
ds_read_b128 v[240:243], v23 offset:32768
ds_read_b128 v[244:247], v24 offset:32768
v_max3_f32 v27, v27, v36, v37
v_mfma_f32_32x32x16_bf16 v[48:63], a[76:79], a[140:143], v[48:63]
ds_read_b128 v[248:251], v25 offset:32768
ds_read_b128 v[252:255], v26 offset:32768
v_max3_f32 v27, v27, v38, v39
v_mfma_f32_32x32x16_bf16 v[48:63], a[80:83], a[144:147], v[48:63]
v_max3_f32 v27, v27, v40, v41
s_add_u32 s95, s3, 9
s_and_b32 s95, s95, 15
s_lshl_b32 s95, s95, 13
s_add_u32 s95, s95, s83
s_add_u32 m0, s94, 24576
s_nop 0
buffer_load_dwordx4 v10, s[44:47], s95 offen offset:0 nt lds
v_mfma_f32_32x32x16_bf16 v[48:63], a[84:87], a[148:151], v[48:63]
v_max3_f32 v27, v27, v42, v43
buffer_load_dwordx4 v10, s[44:47], s95 offen offset:1024 nt lds
v_mfma_f32_32x32x16_bf16 v[48:63], a[88:91], a[152:155], v[48:63]
v_max3_f32 v27, v27, v44, v45
v_mfma_f32_32x32x16_bf16 v[48:63], a[92:95], a[156:159], v[48:63]
v_max3_f32 v27, v27, v46, v47
s_waitcnt lgkmcnt(0)
s_waitcnt vmcnt(12)
s_barrier
v_mfma_f32_32x32x16_bf16 v[64:79], v[224:227], a[128:131], 0
ds_read_b128 a[64:67], v19 offset:40960
ds_read_b128 a[68:71], v20 offset:40960
s_nop 4
v_max3_f32 v27, v27, v48, v49
v_mfma_f32_32x32x16_bf16 v[64:79], v[228:231], a[132:135], v[64:79]
ds_read_b128 a[72:75], v21 offset:40960
ds_read_b128 a[76:79], v22 offset:40960
v_max3_f32 v27, v27, v50, v51
v_mfma_f32_32x32x16_bf16 v[64:79], v[232:235], a[136:139], v[64:79]
ds_read_b128 a[80:83], v23 offset:40960
ds_read_b128 a[84:87], v24 offset:40960
v_max3_f32 v27, v27, v52, v53
v_mfma_f32_32x32x16_bf16 v[64:79], v[236:239], a[140:143], v[64:79]
ds_read_b128 a[88:91], v25 offset:40960
ds_read_b128 a[92:95], v26 offset:40960
v_max3_f32 v27, v27, v54, v55
v_mfma_f32_32x32x16_bf16 v[64:79], v[240:243], a[144:147], v[64:79]
v_max3_f32 v27, v27, v56, v57
s_add_u32 s95, s3, 10
s_and_b32 s95, s95, 15
s_lshl_b32 s95, s95, 13
s_add_u32 s95, s95, s83
s_add_u32 m0, s94, 32768
s_nop 0
buffer_load_dwordx4 v10, s[44:47], s95 offen offset:0 nt lds
v_mfma_f32_32x32x16_bf16 v[64:79], v[244:247], a[148:151], v[64:79]
v_max3_f32 v27, v27, v58, v59
buffer_load_dwordx4 v10, s[44:47], s95 offen offset:1024 nt lds
v_mfma_f32_32x32x16_bf16 v[64:79], v[248:251], a[152:155], v[64:79]
v_max3_f32 v27, v27, v60, v61
v_mfma_f32_32x32x16_bf16 v[64:79], v[252:255], a[156:159], v[64:79]
v_max3_f32 v27, v27, v62, v63
s_waitcnt lgkmcnt(0)
s_waitcnt vmcnt(12)
s_barrier
v_mfma_f32_32x32x16_bf16 v[80:95], a[64:67], a[128:131], 0
ds_read_b128 v[224:227], v19 offset:49152
ds_read_b128 v[228:231], v20 offset:49152
s_nop 4
v_max3_f32 v27, v27, v64, v65
v_mfma_f32_32x32x16_bf16 v[80:95], a[68:71], a[132:135], v[80:95]
ds_read_b128 v[232:235], v21 offset:49152
ds_read_b128 v[236:239], v22 offset:49152
v_max3_f32 v27, v27, v66, v67
v_mfma_f32_32x32x16_bf16 v[80:95], a[72:75], a[136:139], v[80:95]
ds_read_b128 v[240:243], v23 offset:49152
ds_read_b128 v[244:247], v24 offset:49152
v_max3_f32 v27, v27, v68, v69
v_mfma_f32_32x32x16_bf16 v[80:95], a[76:79], a[140:143], v[80:95]
ds_read_b128 v[248:251], v25 offset:49152
ds_read_b128 v[252:255], v26 offset:49152
v_max3_f32 v27, v27, v70, v71
v_mfma_f32_32x32x16_bf16 v[80:95], a[80:83], a[144:147], v[80:95]
v_max3_f32 v27, v27, v72, v73
s_add_u32 s95, s3, 11
s_and_b32 s95, s95, 15
s_lshl_b32 s95, s95, 13
s_add_u32 s95, s95, s83
s_add_u32 m0, s94, 40960
s_nop 0
buffer_load_dwordx4 v10, s[44:47], s95 offen offset:0 nt lds
v_mfma_f32_32x32x16_bf16 v[80:95], a[84:87], a[148:151], v[80:95]
v_max3_f32 v27, v27, v74, v75
buffer_load_dwordx4 v10, s[44:47], s95 offen offset:1024 nt lds
v_mfma_f32_32x32x16_bf16 v[80:95], a[88:91], a[152:155], v[80:95]
v_max3_f32 v27, v27, v76, v77
v_mfma_f32_32x32x16_bf16 v[80:95], a[92:95], a[156:159], v[80:95]
v_max3_f32 v27, v27, v78, v79
s_waitcnt lgkmcnt(0)
s_waitcnt vmcnt(12)
s_barrier
v_mfma_f32_32x32x16_bf16 v[96:111], v[224:227], a[128:131], 0
ds_read_b128 a[64:67], v19 offset:57344
ds_read_b128 a[68:71], v20 offset:57344
s_nop 4
v_max3_f32 v27, v27, v80, v81
v_mfma_f32_32x32x16_bf16 v[96:111], v[228:231], a[132:135], v[96:111]
ds_read_b128 a[72:75], v21 offset:57344
ds_read_b128 a[76:79], v22 offset:57344
v_max3_f32 v27, v27, v82, v83
v_mfma_f32_32x32x16_bf16 v[96:111], v[232:235], a[136:139], v[96:111]
ds_read_b128 a[80:83], v23 offset:57344
ds_read_b128 a[84:87], v24 offset:57344
v_max3_f32 v27, v27, v84, v85
v_mfma_f32_32x32x16_bf16 v[96:111], v[236:239], a[140:143], v[96:111]
ds_read_b128 a[88:91], v25 offset:57344
ds_read_b128 a[92:95], v26 offset:57344
v_max3_f32 v27, v27, v86, v87
v_mfma_f32_32x32x16_bf16 v[96:111], v[240:243], a[144:147], v[96:111]
v_max3_f32 v27, v27, v88, v89
s_add_u32 s95, s3, 12
s_and_b32 s95, s95, 15
s_lshl_b32 s95, s95, 13
s_add_u32 s95, s95, s83
s_add_u32 m0, s94, 49152
s_nop 0
buffer_load_dwordx4 v10, s[44:47], s95 offen offset:0 nt lds
v_mfma_f32_32x32x16_bf16 v[96:111], v[244:247], a[148:151], v[96:111]
v_max3_f32 v27, v27, v90, v91
buffer_load_dwordx4 v10, s[44:47], s95 offen offset:1024 nt lds
v_mfma_f32_32x32x16_bf16 v[96:111], v[248:251], a[152:155], v[96:111]
v_max3_f32 v27, v27, v92, v93
v_mfma_f32_32x32x16_bf16 v[96:111], v[252:255], a[156:159], v[96:111]
v_max3_f32 v27, v27, v94, v95
s_waitcnt lgkmcnt(0)
s_waitcnt vmcnt(12)
s_barrier
v_mfma_f32_32x32x16_bf16 v[112:127], a[64:67], a[128:131], 0
ds_read_b128 v[224:227], v19 offset:0
ds_read_b128 v[228:231], v20 offset:0
s_nop 4
v_max3_f32 v27, v27, v96, v97
v_mfma_f32_32x32x16_bf16 v[112:127], a[68:71], a[132:135], v[112:127]
ds_read_b128 v[232:235], v21 offset:0
ds_read_b128 v[236:239], v22 offset:0
v_max3_f32 v27, v27, v98, v99
v_mfma_f32_32x32x16_bf16 v[112:127], a[72:75], a[136:139], v[112:127]
ds_read_b128 v[240:243], v23 offset:0
ds_read_b128 v[244:247], v24 offset:0
v_max3_f32 v27, v27, v100, v101
v_mfma_f32_32x32x16_bf16 v[112:127], a[76:79], a[140:143], v[112:127]
ds_read_b128 v[248:251], v25 offset:0
ds_read_b128 v[252:255], v26 offset:0
v_max3_f32 v27, v27, v102, v103
v_mfma_f32_32x32x16_bf16 v[112:127], a[80:83], a[144:147], v[112:127]
v_max3_f32 v27, v27, v104, v105
s_add_u32 s95, s3, 13
s_and_b32 s95, s95, 15
s_lshl_b32 s95, s95, 13
s_add_u32 s95, s95, s83
s_add_u32 m0, s94, 57344
s_nop 0
buffer_load_dwordx4 v10, s[44:47], s95 offen offset:0 nt lds
v_mfma_f32_32x32x16_bf16 v[112:127], a[84:87], a[148:151], v[112:127]
v_max3_f32 v27, v27, v106, v107
buffer_load_dwordx4 v10, s[44:47], s95 offen offset:1024 nt lds
v_mfma_f32_32x32x16_bf16 v[112:127], a[88:91], a[152:155], v[112:127]
v_max3_f32 v27, v27, v108, v109
v_mfma_f32_32x32x16_bf16 v[112:127], a[92:95], a[156:159], v[112:127]
v_max3_f32 v27, v27, v110, v111
s_waitcnt lgkmcnt(0)
s_waitcnt vmcnt(12)
s_barrier
v_mfma_f32_32x32x16_bf16 v[128:143], v[224:227], a[128:131], 0
ds_read_b128 a[64:67], v19 offset:8192
ds_read_b128 a[68:71], v20 offset:8192
s_nop 4
v_max3_f32 v27, v27, v112, v113
v_mfma_f32_32x32x16_bf16 v[128:143], v[228:231], a[132:135], v[128:143]
ds_read_b128 a[72:75], v21 offset:8192
ds_read_b128 a[76:79], v22 offset:8192
v_max3_f32 v27, v27, v114, v115
v_mfma_f32_32x32x16_bf16 v[128:143], v[232:235], a[136:139], v[128:143]
ds_read_b128 a[80:83], v23 offset:8192
ds_read_b128 a[84:87], v24 offset:8192
v_max3_f32 v27, v27, v116, v117
v_mfma_f32_32x32x16_bf16 v[128:143], v[236:239], a[140:143], v[128:143]
ds_read_b128 a[88:91], v25 offset:8192
ds_read_b128 a[92:95], v26 offset:8192
v_max3_f32 v27, v27, v118, v119
v_mfma_f32_32x32x16_bf16 v[128:143], v[240:243], a[144:147], v[128:143]
v_max3_f32 v27, v27, v120, v121
s_add_u32 s95, s3, 14
s_and_b32 s95, s95, 15
s_lshl_b32 s95, s95, 13
s_add_u32 s95, s95, s83
s_add_u32 m0, s94, 0
s_nop 0
buffer_load_dwordx4 v10, s[44:47], s95 offen offset:0 nt lds
v_mfma_f32_32x32x16_bf16 v[128:143], v[244:247], a[148:151], v[128:143]
v_max3_f32 v27, v27, v122, v123
buffer_load_dwordx4 v10, s[44:47], s95 offen offset:1024 nt lds
v_mfma_f32_32x32x16_bf16 v[128:143], v[248:251], a[152:155], v[128:143]
v_max3_f32 v27, v27, v124, v125
v_mfma_f32_32x32x16_bf16 v[128:143], v[252:255], a[156:159], v[128:143]
v_max3_f32 v27, v27, v126, v127
s_waitcnt lgkmcnt(0)
v_mov_b32 v19, v3
v_xor_b32 v20, 64, v19
v_xor_b32 v21, 128, v19
v_xor_b32 v22, 192, v19
s_waitcnt vmcnt(12)
s_barrier
v_mfma_f32_32x32x16_bf16 v[144:159], a[64:67], a[128:131], 0
ds_read_b64_tr_b16 v[224:225], v19 offset:16384
ds_read_b64_tr_b16 v[226:227], v19 offset:18432
ds_read_b64_tr_b16 v[232:233], v20 offset:16384
v_max3_f32 v27, v27, v128, v129
v_max3_f32 v27, v27, v130, v131
v_mfma_f32_32x32x16_bf16 v[144:159], a[68:71], a[132:135], v[144:159]
ds_read_b64_tr_b16 v[234:235], v20 offset:18432
ds_read_b64_tr_b16 v[240:241], v21 offset:16384
ds_read_b64_tr_b16 v[242:243], v21 offset:18432
v_max3_f32 v27, v27, v132, v133
v_max3_f32 v27, v27, v134, v135
v_mfma_f32_32x32x16_bf16 v[144:159], a[72:75], a[136:139], v[144:159]
ds_read_b64_tr_b16 v[248:249], v22 offset:16384
ds_read_b64_tr_b16 v[250:251], v22 offset:18432
ds_read_b64_tr_b16 v[228:229], v19 offset:20480
v_max3_f32 v27, v27, v136, v137
v_max3_f32 v27, v27, v138, v139
v_mfma_f32_32x32x16_bf16 v[144:159], a[76:79], a[140:143], v[144:159]
ds_read_b64_tr_b16 v[230:231], v19 offset:22528
ds_read_b64_tr_b16 v[236:237], v20 offset:20480
ds_read_b64_tr_b16 v[238:239], v20 offset:22528
v_max3_f32 v27, v27, v140, v141
v_max3_f32 v27, v27, v142, v143
v_mfma_f32_32x32x16_bf16 v[144:159], a[80:83], a[144:147], v[144:159]
ds_read_b64_tr_b16 v[244:245], v21 offset:20480
ds_read_b64_tr_b16 v[246:247], v21 offset:22528
ds_read_b64_tr_b16 v[252:253], v22 offset:20480
v_accvgpr_read_b32 v24, a160
s_add_u32 s95, s3, 15
s_and_b32 s95, s95, 15
s_lshl_b32 s95, s95, 13
s_add_u32 s95, s95, s83
s_add_u32 m0, s94, 8192
s_nop 0
buffer_load_dwordx4 v10, s[44:47], s95 offen offset:0 nt lds
v_mfma_f32_32x32x16_bf16 v[144:159], a[84:87], a[148:151], v[144:159]
ds_read_b64_tr_b16 v[254:255], v22 offset:22528
buffer_load_dwordx4 v10, s[44:47], s95 offen offset:1024 nt lds
v_mfma_f32_32x32x16_bf16 v[144:159], a[88:91], a[152:155], v[144:159]
s_add_u32 s95, s82, 0
s_add_u32 m0, s85, 8192
s_nop 0
buffer_load_dwordx4 v11, s[52:55], s95 offen offset:0 lds
v_mfma_f32_32x32x16_bf16 v[144:159], a[92:95], a[156:159], v[144:159]
buffer_load_dwordx4 v12, s[52:55], s95 offen offset:1024 lds
s_waitcnt lgkmcnt(0)
s_waitcnt vmcnt(14)
s_barrier
s_nop 7
v_max3_f32 v27, v27, v144, v145
v_max3_f32 v27, v27, v146, v147
v_max3_f32 v27, v27, v148, v149
v_max3_f32 v27, v27, v150, v151
v_max3_f32 v27, v27, v152, v153
v_max3_f32 v27, v27, v154, v155
v_max3_f32 v27, v27, v156, v157
v_max3_f32 v27, v27, v158, v159
v_mov_b32 v31, v27
s_nop 1
v_permlane32_swap_b32 v27, v31
v_max_f32 v27, v27, v31
v_sub_f32 v23, v24, v27
v_mul_f32 v23, s91, v23
v_exp_f32 v23, v23
s_nop 0
v_mul_f32 v29, v29, v23
v_mul_f32 v30, v30, v23
v_mul_f32 v160, v160, v23
v_mul_f32 v161, v161, v23
v_mul_f32 v162, v162, v23
v_mul_f32 v163, v163, v23
v_mul_f32 v164, v164, v23
v_mul_f32 v165, v165, v23
v_mul_f32 v166, v166, v23
v_mul_f32 v167, v167, v23
v_mul_f32 v168, v168, v23
v_mul_f32 v169, v169, v23
v_mul_f32 v170, v170, v23
v_mul_f32 v171, v171, v23
v_mul_f32 v172, v172, v23
v_mul_f32 v173, v173, v23
v_mul_f32 v174, v174, v23
v_mul_f32 v175, v175, v23
v_mul_f32 v176, v176, v23
v_mul_f32 v177, v177, v23
v_mul_f32 v178, v178, v23
v_mul_f32 v179, v179, v23
v_mul_f32 v180, v180, v23
v_mul_f32 v181, v181, v23
v_mul_f32 v182, v182, v23
v_mul_f32 v183, v183, v23
v_mul_f32 v184, v184, v23
v_mul_f32 v185, v185, v23
v_mul_f32 v186, v186, v23
v_mul_f32 v187, v187, v23
v_mul_f32 v188, v188, v23
v_mul_f32 v189, v189, v23
v_mul_f32 v190, v190, v23
v_mul_f32 v191, v191, v23
v_mul_f32 v192, v192, v23
v_mul_f32 v193, v193, v23
v_mul_f32 v194, v194, v23
v_mul_f32 v195, v195, v23
v_mul_f32 v196, v196, v23
v_mul_f32 v197, v197, v23
v_mul_f32 v198, v198, v23
v_mul_f32 v199, v199, v23
v_mul_f32 v200, v200, v23
v_mul_f32 v201, v201, v23
v_mul_f32 v202, v202, v23
v_mul_f32 v203, v203, v23
v_mul_f32 v204, v204, v23
v_mul_f32 v205, v205, v23
v_mul_f32 v206, v206, v23
v_mul_f32 v207, v207, v23
v_mul_f32 v208, v208, v23
v_mul_f32 v209, v209, v23
v_mul_f32 v210, v210, v23
v_mul_f32 v211, v211, v23
v_mul_f32 v212, v212, v23
v_mul_f32 v213, v213, v23
v_mul_f32 v214, v214, v23
v_mul_f32 v215, v215, v23
v_mul_f32 v216, v216, v23
v_mul_f32 v217, v217, v23
v_mul_f32 v218, v218, v23
v_mul_f32 v219, v219, v23
v_mul_f32 v220, v220, v23
v_mul_f32 v221, v221, v23
v_mul_f32 v222, v222, v23
v_mul_f32 v223, v223, v23
v_mul_f32 v28, s91, v27
v_sub_f32 v28, 0, v28
v_fma_f32 v32, v32, s91, v28
v_fma_f32 v33, v33, s91, v28
v_fma_f32 v34, v34, s91, v28
v_fma_f32 v35, v35, s91, v28
v_fma_f32 v36, v36, s91, v28
v_fma_f32 v37, v37, s91, v28
v_fma_f32 v38, v38, s91, v28
v_fma_f32 v39, v39, s91, v28
v_fma_f32 v40, v40, s91, v28
v_fma_f32 v41, v41, s91, v28
v_fma_f32 v42, v42, s91, v28
v_fma_f32 v43, v43, s91, v28
v_fma_f32 v44, v44, s91, v28
v_fma_f32 v45, v45, s91, v28
v_fma_f32 v46, v46, s91, v28
v_fma_f32 v47, v47, s91, v28
v_exp_f32 v32, v32
v_exp_f32 v33, v33
v_exp_f32 v34, v34
v_exp_f32 v35, v35
v_exp_f32 v36, v36
v_exp_f32 v37, v37
v_exp_f32 v38, v38
v_exp_f32 v39, v39
v_exp_f32 v40, v40
v_exp_f32 v41, v41
v_exp_f32 v42, v42
v_exp_f32 v43, v43
v_exp_f32 v44, v44
v_exp_f32 v45, v45
v_exp_f32 v46, v46
v_exp_f32 v47, v47
v_add_f32 v29, v29, v32
v_add_f32 v30, v30, v33
v_add_f32 v29, v29, v34
v_add_f32 v30, v30, v35
v_add_f32 v29, v29, v36
v_add_f32 v30, v30, v37
v_add_f32 v29, v29, v38
v_add_f32 v30, v30, v39
v_add_f32 v29, v29, v40
v_add_f32 v30, v30, v41
v_add_f32 v29, v29, v42
v_add_f32 v30, v30, v43
v_add_f32 v29, v29, v44
v_add_f32 v30, v30, v45
v_add_f32 v29, v29, v46
v_add_f32 v30, v30, v47
v_cvt_pk_bf16_f32 v32, v32, v33
v_cvt_pk_bf16_f32 v33, v34, v35
v_cvt_pk_bf16_f32 v34, v36, v37
v_cvt_pk_bf16_f32 v35, v38, v39
v_cvt_pk_bf16_f32 v36, v40, v41
v_cvt_pk_bf16_f32 v37, v42, v43
v_cvt_pk_bf16_f32 v38, v44, v45
v_cvt_pk_bf16_f32 v39, v46, v47
v_mfma_f32_32x32x16_bf16 v[160:175], v[224:227], v[32:35], v[160:175]
ds_read_b64_tr_b16 a[64:65], v19 offset:24576
ds_read_b64_tr_b16 a[66:67], v19 offset:26624
ds_read_b64_tr_b16 a[72:73], v20 offset:24576
v_fma_f32 v48, v48, s91, v28
v_fma_f32 v49, v49, s91, v28
v_fma_f32 v50, v50, s91, v28
v_fma_f32 v51, v51, s91, v28
v_fma_f32 v52, v52, s91, v28
v_fma_f32 v53, v53, s91, v28
v_fma_f32 v54, v54, s91, v28
v_mfma_f32_32x32x16_bf16 v[176:191], v[232:235], v[32:35], v[176:191]
ds_read_b64_tr_b16 a[74:75], v20 offset:26624
ds_read_b64_tr_b16 a[80:81], v21 offset:24576
ds_read_b64_tr_b16 a[82:83], v21 offset:26624
v_fma_f32 v55, v55, s91, v28
v_fma_f32 v56, v56, s91, v28
v_fma_f32 v57, v57, s91, v28
v_fma_f32 v58, v58, s91, v28
v_fma_f32 v59, v59, s91, v28
v_fma_f32 v60, v60, s91, v28
v_fma_f32 v61, v61, s91, v28
v_mfma_f32_32x32x16_bf16 v[192:207], v[240:243], v[32:35], v[192:207]
ds_read_b64_tr_b16 a[88:89], v22 offset:24576
ds_read_b64_tr_b16 a[90:91], v22 offset:26624
ds_read_b64_tr_b16 a[68:69], v19 offset:28672
v_fma_f32 v62, v62, s91, v28
v_fma_f32 v63, v63, s91, v28
v_exp_f32 v48, v48
v_exp_f32 v49, v49
v_exp_f32 v50, v50
v_exp_f32 v51, v51
v_exp_f32 v52, v52
v_mfma_f32_32x32x16_bf16 v[208:223], v[248:251], v[32:35], v[208:223]
ds_read_b64_tr_b16 a[70:71], v19 offset:30720
ds_read_b64_tr_b16 a[76:77], v20 offset:28672
ds_read_b64_tr_b16 a[78:79], v20 offset:30720
v_exp_f32 v53, v53
v_exp_f32 v54, v54
v_exp_f32 v55, v55
v_exp_f32 v56, v56
v_exp_f32 v57, v57
v_exp_f32 v58, v58
v_exp_f32 v59, v59
v_mfma_f32_32x32x16_bf16 v[160:175], v[228:231], v[36:39], v[160:175]
ds_read_b64_tr_b16 a[84:85], v21 offset:28672
ds_read_b64_tr_b16 a[86:87], v21 offset:30720
ds_read_b64_tr_b16 a[92:93], v22 offset:28672
v_exp_f32 v60, v60
v_exp_f32 v61, v61
v_exp_f32 v62, v62
v_exp_f32 v63, v63
v_add_f32 v29, v29, v48
v_add_f32 v30, v30, v49
v_add_f32 v29, v29, v50
buffer_load_dwordx4 v13, s[52:55], s95 offen offset:2048 lds
v_mfma_f32_32x32x16_bf16 v[176:191], v[236:239], v[36:39], v[176:191]
ds_read_b64_tr_b16 a[94:95], v22 offset:30720
v_add_f32 v30, v30, v51
v_add_f32 v29, v29, v52
v_add_f32 v30, v30, v53
v_add_f32 v29, v29, v54
v_add_f32 v30, v30, v55
v_add_f32 v29, v29, v56
v_add_f32 v30, v30, v57
buffer_load_dwordx4 v14, s[52:55], s95 offen offset:3072 lds
v_mfma_f32_32x32x16_bf16 v[192:207], v[244:247], v[36:39], v[192:207]
v_add_f32 v29, v29, v58
v_add_f32 v30, v30, v59
v_add_f32 v29, v29, v60
v_add_f32 v30, v30, v61
v_add_f32 v29, v29, v62
v_add_f32 v30, v30, v63
v_cvt_pk_bf16_f32 v48, v48, v49
s_add_u32 s95, s82, 16384
s_add_u32 m0, s85, 0
s_nop 0
buffer_load_dwordx4 v11, s[52:55], s95 offen offset:0 lds
v_mfma_f32_32x32x16_bf16 v[208:223], v[252:255], v[36:39], v[208:223]
v_cvt_pk_bf16_f32 v49, v50, v51
v_cvt_pk_bf16_f32 v50, v52, v53
v_cvt_pk_bf16_f32 v51, v54, v55
v_cvt_pk_bf16_f32 v52, v56, v57
v_cvt_pk_bf16_f32 v53, v58, v59
v_cvt_pk_bf16_f32 v54, v60, v61
v_cvt_pk_bf16_f32 v55, v62, v63
buffer_load_dwordx4 v12, s[52:55], s95 offen offset:1024 lds
s_waitcnt lgkmcnt(0)
s_waitcnt vmcnt(16)
s_barrier
v_mfma_f32_32x32x16_bf16 v[160:175], a[64:67], v[48:51], v[160:175]
ds_read_b64_tr_b16 v[224:225], v19 offset:32768
ds_read_b64_tr_b16 v[226:227], v19 offset:34816
ds_read_b64_tr_b16 v[232:233], v20 offset:32768
v_fma_f32 v64, v64, s91, v28
v_fma_f32 v65, v65, s91, v28
v_fma_f32 v66, v66, s91, v28
v_fma_f32 v67, v67, s91, v28
v_fma_f32 v68, v68, s91, v28
v_fma_f32 v69, v69, s91, v28
v_fma_f32 v70, v70, s91, v28
v_mfma_f32_32x32x16_bf16 v[176:191], a[72:75], v[48:51], v[176:191]
ds_read_b64_tr_b16 v[234:235], v20 offset:34816
ds_read_b64_tr_b16 v[240:241], v21 offset:32768
ds_read_b64_tr_b16 v[242:243], v21 offset:34816
v_fma_f32 v71, v71, s91, v28
v_fma_f32 v72, v72, s91, v28
v_fma_f32 v73, v73, s91, v28
v_fma_f32 v74, v74, s91, v28
v_fma_f32 v75, v75, s91, v28
v_fma_f32 v76, v76, s91, v28
v_fma_f32 v77, v77, s91, v28
v_mfma_f32_32x32x16_bf16 v[192:207], a[80:83], v[48:51], v[192:207]
ds_read_b64_tr_b16 v[248:249], v22 offset:32768
ds_read_b64_tr_b16 v[250:251], v22 offset:34816
ds_read_b64_tr_b16 v[228:229], v19 offset:36864
v_fma_f32 v78, v78, s91, v28
v_fma_f32 v79, v79, s91, v28
v_exp_f32 v64, v64
v_exp_f32 v65, v65
v_exp_f32 v66, v66
v_exp_f32 v67, v67
v_exp_f32 v68, v68
v_mfma_f32_32x32x16_bf16 v[208:223], a[88:91], v[48:51], v[208:223]
ds_read_b64_tr_b16 v[230:231], v19 offset:38912
ds_read_b64_tr_b16 v[236:237], v20 offset:36864
ds_read_b64_tr_b16 v[238:239], v20 offset:38912
v_exp_f32 v69, v69
v_exp_f32 v70, v70
v_exp_f32 v71, v71
v_exp_f32 v72, v72
v_exp_f32 v73, v73
v_exp_f32 v74, v74
v_exp_f32 v75, v75
v_mfma_f32_32x32x16_bf16 v[160:175], a[68:71], v[52:55], v[160:175]
ds_read_b64_tr_b16 v[244:245], v21 offset:36864
ds_read_b64_tr_b16 v[246:247], v21 offset:38912
ds_read_b64_tr_b16 v[252:253], v22 offset:36864
v_exp_f32 v76, v76
v_exp_f32 v77, v77
v_exp_f32 v78, v78
v_exp_f32 v79, v79
v_add_f32 v29, v29, v64
v_add_f32 v30, v30, v65
v_add_f32 v29, v29, v66
buffer_load_dwordx4 v13, s[52:55], s95 offen offset:2048 lds
v_mfma_f32_32x32x16_bf16 v[176:191], a[76:79], v[52:55], v[176:191]
ds_read_b64_tr_b16 v[254:255], v22 offset:38912
v_add_f32 v30, v30, v67
v_add_f32 v29, v29, v68
v_add_f32 v30, v30, v69
v_add_f32 v29, v29, v70
v_add_f32 v30, v30, v71
v_add_f32 v29, v29, v72
v_add_f32 v30, v30, v73
buffer_load_dwordx4 v14, s[52:55], s95 offen offset:3072 lds
v_mfma_f32_32x32x16_bf16 v[192:207], a[84:87], v[52:55], v[192:207]
v_add_f32 v29, v29, v74
v_add_f32 v30, v30, v75
v_add_f32 v29, v29, v76
v_add_f32 v30, v30, v77
v_add_f32 v29, v29, v78
v_add_f32 v30, v30, v79
v_cvt_pk_bf16_f32 v64, v64, v65
s_add_u32 s95, s82, 32768
s_add_u32 m0, s85, 4096
s_nop 0
buffer_load_dwordx4 v11, s[52:55], s95 offen offset:0 lds
v_mfma_f32_32x32x16_bf16 v[208:223], a[92:95], v[52:55], v[208:223]
v_cvt_pk_bf16_f32 v65, v66, v67
v_cvt_pk_bf16_f32 v66, v68, v69
v_cvt_pk_bf16_f32 v67, v70, v71
v_cvt_pk_bf16_f32 v68, v72, v73
v_cvt_pk_bf16_f32 v69, v74, v75
v_cvt_pk_bf16_f32 v70, v76, v77
v_cvt_pk_bf16_f32 v71, v78, v79
buffer_load_dwordx4 v12, s[52:55], s95 offen offset:1024 lds
s_waitcnt lgkmcnt(0)
s_waitcnt vmcnt(18)
s_barrier
v_mfma_f32_32x32x16_bf16 v[160:175], v[224:227], v[64:67], v[160:175]
ds_read_b64_tr_b16 a[64:65], v19 offset:40960
ds_read_b64_tr_b16 a[66:67], v19 offset:43008
ds_read_b64_tr_b16 a[72:73], v20 offset:40960
v_fma_f32 v80, v80, s91, v28
v_fma_f32 v81, v81, s91, v28
v_fma_f32 v82, v82, s91, v28
v_fma_f32 v83, v83, s91, v28
v_fma_f32 v84, v84, s91, v28
v_fma_f32 v85, v85, s91, v28
v_fma_f32 v86, v86, s91, v28
v_mfma_f32_32x32x16_bf16 v[176:191], v[232:235], v[64:67], v[176:191]
ds_read_b64_tr_b16 a[74:75], v20 offset:43008
ds_read_b64_tr_b16 a[80:81], v21 offset:40960
ds_read_b64_tr_b16 a[82:83], v21 offset:43008
v_fma_f32 v87, v87, s91, v28
v_fma_f32 v88, v88, s91, v28
v_fma_f32 v89, v89, s91, v28
v_fma_f32 v90, v90, s91, v28
v_fma_f32 v91, v91, s91, v28
v_fma_f32 v92, v92, s91, v28
v_fma_f32 v93, v93, s91, v28
v_mfma_f32_32x32x16_bf16 v[192:207], v[240:243], v[64:67], v[192:207]
ds_read_b64_tr_b16 a[88:89], v22 offset:40960
ds_read_b64_tr_b16 a[90:91], v22 offset:43008
ds_read_b64_tr_b16 a[68:69], v19 offset:45056
v_fma_f32 v94, v94, s91, v28
v_fma_f32 v95, v95, s91, v28
v_exp_f32 v80, v80
v_exp_f32 v81, v81
v_exp_f32 v82, v82
v_exp_f32 v83, v83
v_exp_f32 v84, v84
v_mfma_f32_32x32x16_bf16 v[208:223], v[248:251], v[64:67], v[208:223]
ds_read_b64_tr_b16 a[70:71], v19 offset:47104
ds_read_b64_tr_b16 a[76:77], v20 offset:45056
ds_read_b64_tr_b16 a[78:79], v20 offset:47104
v_exp_f32 v85, v85
v_exp_f32 v86, v86
v_exp_f32 v87, v87
v_exp_f32 v88, v88
v_exp_f32 v89, v89
v_exp_f32 v90, v90
v_exp_f32 v91, v91
v_mfma_f32_32x32x16_bf16 v[160:175], v[228:231], v[68:71], v[160:175]
ds_read_b64_tr_b16 a[84:85], v21 offset:45056
ds_read_b64_tr_b16 a[86:87], v21 offset:47104
ds_read_b64_tr_b16 a[92:93], v22 offset:45056
v_exp_f32 v92, v92
v_exp_f32 v93, v93
v_exp_f32 v94, v94
v_exp_f32 v95, v95
v_add_f32 v29, v29, v80
v_add_f32 v30, v30, v81
v_add_f32 v29, v29, v82
buffer_load_dwordx4 v13, s[52:55], s95 offen offset:2048 lds
v_mfma_f32_32x32x16_bf16 v[176:191], v[236:239], v[68:71], v[176:191]
ds_read_b64_tr_b16 a[94:95], v22 offset:47104
v_add_f32 v30, v30, v83
v_add_f32 v29, v29, v84
v_add_f32 v30, v30, v85
v_add_f32 v29, v29, v86
v_add_f32 v30, v30, v87
v_add_f32 v29, v29, v88
v_add_f32 v30, v30, v89
buffer_load_dwordx4 v14, s[52:55], s95 offen offset:3072 lds
v_mfma_f32_32x32x16_bf16 v[192:207], v[244:247], v[68:71], v[192:207]
v_add_f32 v29, v29, v90
v_add_f32 v30, v30, v91
v_add_f32 v29, v29, v92
v_add_f32 v30, v30, v93
v_add_f32 v29, v29, v94
v_add_f32 v30, v30, v95
v_cvt_pk_bf16_f32 v80, v80, v81
v_mfma_f32_32x32x16_bf16 v[208:223], v[252:255], v[68:71], v[208:223]
v_cvt_pk_bf16_f32 v81, v82, v83
v_cvt_pk_bf16_f32 v82, v84, v85
v_cvt_pk_bf16_f32 v83, v86, v87
v_cvt_pk_bf16_f32 v84, v88, v89
v_cvt_pk_bf16_f32 v85, v90, v91
v_cvt_pk_bf16_f32 v86, v92, v93
v_cvt_pk_bf16_f32 v87, v94, v95
s_waitcnt lgkmcnt(0)
s_waitcnt vmcnt(18)
s_barrier
v_mfma_f32_32x32x16_bf16 v[160:175], a[64:67], v[80:83], v[160:175]
ds_read_b64_tr_b16 v[224:225], v19 offset:49152
ds_read_b64_tr_b16 v[226:227], v19 offset:51200
ds_read_b64_tr_b16 v[232:233], v20 offset:49152
v_fma_f32 v96, v96, s91, v28
v_fma_f32 v97, v97, s91, v28
v_fma_f32 v98, v98, s91, v28
v_fma_f32 v99, v99, s91, v28
v_fma_f32 v100, v100, s91, v28
v_fma_f32 v101, v101, s91, v28
v_fma_f32 v102, v102, s91, v28
v_mfma_f32_32x32x16_bf16 v[176:191], a[72:75], v[80:83], v[176:191]
ds_read_b64_tr_b16 v[234:235], v20 offset:51200
ds_read_b64_tr_b16 v[240:241], v21 offset:49152
ds_read_b64_tr_b16 v[242:243], v21 offset:51200
v_fma_f32 v103, v103, s91, v28
v_fma_f32 v104, v104, s91, v28
v_fma_f32 v105, v105, s91, v28
v_fma_f32 v106, v106, s91, v28
v_fma_f32 v107, v107, s91, v28
v_fma_f32 v108, v108, s91, v28
v_fma_f32 v109, v109, s91, v28
v_mfma_f32_32x32x16_bf16 v[192:207], a[80:83], v[80:83], v[192:207]
ds_read_b64_tr_b16 v[248:249], v22 offset:49152
ds_read_b64_tr_b16 v[250:251], v22 offset:51200
ds_read_b64_tr_b16 v[228:229], v19 offset:53248
v_fma_f32 v110, v110, s91, v28
v_fma_f32 v111, v111, s91, v28
v_exp_f32 v96, v96
v_exp_f32 v97, v97
v_exp_f32 v98, v98
v_exp_f32 v99, v99
v_exp_f32 v100, v100
v_mfma_f32_32x32x16_bf16 v[208:223], a[88:91], v[80:83], v[208:223]
ds_read_b64_tr_b16 v[230:231], v19 offset:55296
ds_read_b64_tr_b16 v[236:237], v20 offset:53248
ds_read_b64_tr_b16 v[238:239], v20 offset:55296
v_exp_f32 v101, v101
v_exp_f32 v102, v102
v_exp_f32 v103, v103
v_exp_f32 v104, v104
v_exp_f32 v105, v105
v_exp_f32 v106, v106
v_exp_f32 v107, v107
v_mfma_f32_32x32x16_bf16 v[160:175], a[68:71], v[84:87], v[160:175]
ds_read_b64_tr_b16 v[244:245], v21 offset:53248
ds_read_b64_tr_b16 v[246:247], v21 offset:55296
ds_read_b64_tr_b16 v[252:253], v22 offset:53248
v_exp_f32 v108, v108
v_exp_f32 v109, v109
v_exp_f32 v110, v110
v_exp_f32 v111, v111
v_add_f32 v29, v29, v96
v_add_f32 v30, v30, v97
v_add_f32 v29, v29, v98
v_mfma_f32_32x32x16_bf16 v[176:191], a[76:79], v[84:87], v[176:191]
ds_read_b64_tr_b16 v[254:255], v22 offset:55296
v_add_f32 v30, v30, v99
v_add_f32 v29, v29, v100
v_add_f32 v30, v30, v101
v_add_f32 v29, v29, v102
v_add_f32 v30, v30, v103
v_add_f32 v29, v29, v104
v_add_f32 v30, v30, v105
v_mfma_f32_32x32x16_bf16 v[192:207], a[84:87], v[84:87], v[192:207]
v_add_f32 v29, v29, v106
v_add_f32 v30, v30, v107
v_add_f32 v29, v29, v108
v_add_f32 v30, v30, v109
v_add_f32 v29, v29, v110
v_add_f32 v30, v30, v111
v_cvt_pk_bf16_f32 v96, v96, v97
v_mfma_f32_32x32x16_bf16 v[208:223], a[92:95], v[84:87], v[208:223]
v_cvt_pk_bf16_f32 v97, v98, v99
v_cvt_pk_bf16_f32 v98, v100, v101
v_cvt_pk_bf16_f32 v99, v102, v103
v_cvt_pk_bf16_f32 v100, v104, v105
v_cvt_pk_bf16_f32 v101, v106, v107
v_cvt_pk_bf16_f32 v102, v108, v109
v_cvt_pk_bf16_f32 v103, v110, v111
s_waitcnt lgkmcnt(0)
s_waitcnt vmcnt(16)
s_barrier
v_mfma_f32_32x32x16_bf16 v[160:175], v[224:227], v[96:99], v[160:175]
ds_read_b64_tr_b16 a[64:65], v19 offset:57344
ds_read_b64_tr_b16 a[66:67], v19 offset:59392
ds_read_b64_tr_b16 a[72:73], v20 offset:57344
v_fma_f32 v112, v112, s91, v28
v_fma_f32 v113, v113, s91, v28
v_fma_f32 v114, v114, s91, v28
v_fma_f32 v115, v115, s91, v28
v_fma_f32 v116, v116, s91, v28
v_fma_f32 v117, v117, s91, v28
v_fma_f32 v118, v118, s91, v28
v_mfma_f32_32x32x16_bf16 v[176:191], v[232:235], v[96:99], v[176:191]
ds_read_b64_tr_b16 a[74:75], v20 offset:59392
ds_read_b64_tr_b16 a[80:81], v21 offset:57344
ds_read_b64_tr_b16 a[82:83], v21 offset:59392
v_fma_f32 v119, v119, s91, v28
v_fma_f32 v120, v120, s91, v28
v_fma_f32 v121, v121, s91, v28
v_fma_f32 v122, v122, s91, v28
v_fma_f32 v123, v123, s91, v28
v_fma_f32 v124, v124, s91, v28
v_fma_f32 v125, v125, s91, v28
v_mfma_f32_32x32x16_bf16 v[192:207], v[240:243], v[96:99], v[192:207]
ds_read_b64_tr_b16 a[88:89], v22 offset:57344
ds_read_b64_tr_b16 a[90:91], v22 offset:59392
ds_read_b64_tr_b16 a[68:69], v19 offset:61440
v_fma_f32 v126, v126, s91, v28
v_fma_f32 v127, v127, s91, v28
v_exp_f32 v112, v112
v_exp_f32 v113, v113
v_exp_f32 v114, v114
v_exp_f32 v115, v115
v_exp_f32 v116, v116
v_mfma_f32_32x32x16_bf16 v[208:223], v[248:251], v[96:99], v[208:223]
ds_read_b64_tr_b16 a[70:71], v19 offset:63488
ds_read_b64_tr_b16 a[76:77], v20 offset:61440
ds_read_b64_tr_b16 a[78:79], v20 offset:63488
v_exp_f32 v117, v117
v_exp_f32 v118, v118
v_exp_f32 v119, v119
v_exp_f32 v120, v120
v_exp_f32 v121, v121
v_exp_f32 v122, v122
v_exp_f32 v123, v123
v_mfma_f32_32x32x16_bf16 v[160:175], v[228:231], v[100:103], v[160:175]
ds_read_b64_tr_b16 a[84:85], v21 offset:61440
ds_read_b64_tr_b16 a[86:87], v21 offset:63488
ds_read_b64_tr_b16 a[92:93], v22 offset:61440
v_exp_f32 v124, v124
v_exp_f32 v125, v125
v_exp_f32 v126, v126
v_exp_f32 v127, v127
v_add_f32 v29, v29, v112
v_add_f32 v30, v30, v113
v_add_f32 v29, v29, v114
v_mfma_f32_32x32x16_bf16 v[176:191], v[236:239], v[100:103], v[176:191]
ds_read_b64_tr_b16 a[94:95], v22 offset:63488
v_add_f32 v30, v30, v115
v_add_f32 v29, v29, v116
v_add_f32 v30, v30, v117
v_add_f32 v29, v29, v118
v_add_f32 v30, v30, v119
v_add_f32 v29, v29, v120
v_add_f32 v30, v30, v121
v_mfma_f32_32x32x16_bf16 v[192:207], v[244:247], v[100:103], v[192:207]
v_add_f32 v29, v29, v122
v_add_f32 v30, v30, v123
v_add_f32 v29, v29, v124
v_add_f32 v30, v30, v125
v_add_f32 v29, v29, v126
v_add_f32 v30, v30, v127
v_cvt_pk_bf16_f32 v112, v112, v113
v_mfma_f32_32x32x16_bf16 v[208:223], v[252:255], v[100:103], v[208:223]
v_cvt_pk_bf16_f32 v113, v114, v115
v_cvt_pk_bf16_f32 v114, v116, v117
v_cvt_pk_bf16_f32 v115, v118, v119
v_cvt_pk_bf16_f32 v116, v120, v121
v_cvt_pk_bf16_f32 v117, v122, v123
v_cvt_pk_bf16_f32 v118, v124, v125
v_cvt_pk_bf16_f32 v119, v126, v127
s_waitcnt lgkmcnt(0)
s_waitcnt vmcnt(14)
s_barrier
v_mfma_f32_32x32x16_bf16 v[160:175], a[64:67], v[112:115], v[160:175]
ds_read_b64_tr_b16 v[224:225], v19 offset:0
ds_read_b64_tr_b16 v[226:227], v19 offset:2048
ds_read_b64_tr_b16 v[232:233], v20 offset:0
v_fma_f32 v128, v128, s91, v28
v_fma_f32 v129, v129, s91, v28
v_fma_f32 v130, v130, s91, v28
v_fma_f32 v131, v131, s91, v28
v_fma_f32 v132, v132, s91, v28
v_fma_f32 v133, v133, s91, v28
v_fma_f32 v134, v134, s91, v28
v_mfma_f32_32x32x16_bf16 v[176:191], a[72:75], v[112:115], v[176:191]
ds_read_b64_tr_b16 v[234:235], v20 offset:2048
ds_read_b64_tr_b16 v[240:241], v21 offset:0
ds_read_b64_tr_b16 v[242:243], v21 offset:2048
v_fma_f32 v135, v135, s91, v28
v_fma_f32 v136, v136, s91, v28
v_fma_f32 v137, v137, s91, v28
v_fma_f32 v138, v138, s91, v28
v_fma_f32 v139, v139, s91, v28
v_fma_f32 v140, v140, s91, v28
v_fma_f32 v141, v141, s91, v28
v_mfma_f32_32x32x16_bf16 v[192:207], a[80:83], v[112:115], v[192:207]
ds_read_b64_tr_b16 v[248:249], v22 offset:0
ds_read_b64_tr_b16 v[250:251], v22 offset:2048
ds_read_b64_tr_b16 v[228:229], v19 offset:4096
v_fma_f32 v142, v142, s91, v28
v_fma_f32 v143, v143, s91, v28
v_exp_f32 v128, v128
v_exp_f32 v129, v129
v_exp_f32 v130, v130
v_exp_f32 v131, v131
v_exp_f32 v132, v132
v_mfma_f32_32x32x16_bf16 v[208:223], a[88:91], v[112:115], v[208:223]
ds_read_b64_tr_b16 v[230:231], v19 offset:6144
ds_read_b64_tr_b16 v[236:237], v20 offset:4096
ds_read_b64_tr_b16 v[238:239], v20 offset:6144
v_exp_f32 v133, v133
v_exp_f32 v134, v134
v_exp_f32 v135, v135
v_exp_f32 v136, v136
v_exp_f32 v137, v137
v_exp_f32 v138, v138
v_exp_f32 v139, v139
v_mfma_f32_32x32x16_bf16 v[160:175], a[68:71], v[116:119], v[160:175]
ds_read_b64_tr_b16 v[244:245], v21 offset:4096
ds_read_b64_tr_b16 v[246:247], v21 offset:6144
ds_read_b64_tr_b16 v[252:253], v22 offset:4096
v_exp_f32 v140, v140
v_exp_f32 v141, v141
v_exp_f32 v142, v142
v_exp_f32 v143, v143
v_add_f32 v29, v29, v128
v_add_f32 v30, v30, v129
v_add_f32 v29, v29, v130
v_mfma_f32_32x32x16_bf16 v[176:191], a[76:79], v[116:119], v[176:191]
ds_read_b64_tr_b16 v[254:255], v22 offset:6144
v_add_f32 v30, v30, v131
v_add_f32 v29, v29, v132
v_add_f32 v30, v30, v133
v_add_f32 v29, v29, v134
v_add_f32 v30, v30, v135
v_add_f32 v29, v29, v136
v_add_f32 v30, v30, v137
v_mfma_f32_32x32x16_bf16 v[192:207], a[84:87], v[116:119], v[192:207]
v_add_f32 v29, v29, v138
v_add_f32 v30, v30, v139
v_add_f32 v29, v29, v140
v_add_f32 v30, v30, v141
v_add_f32 v29, v29, v142
v_add_f32 v30, v30, v143
v_cvt_pk_bf16_f32 v128, v128, v129
v_mfma_f32_32x32x16_bf16 v[208:223], a[92:95], v[116:119], v[208:223]
v_cvt_pk_bf16_f32 v129, v130, v131
v_cvt_pk_bf16_f32 v130, v132, v133
v_cvt_pk_bf16_f32 v131, v134, v135
v_cvt_pk_bf16_f32 v132, v136, v137
v_cvt_pk_bf16_f32 v133, v138, v139
v_cvt_pk_bf16_f32 v134, v140, v141
v_cvt_pk_bf16_f32 v135, v142, v143
s_waitcnt lgkmcnt(0)
s_waitcnt vmcnt(12)
s_barrier
v_mfma_f32_32x32x16_bf16 v[160:175], v[224:227], v[128:131], v[160:175]
ds_read_b64_tr_b16 a[64:65], v19 offset:8192
ds_read_b64_tr_b16 a[66:67], v19 offset:10240
ds_read_b64_tr_b16 a[72:73], v20 offset:8192
v_fma_f32 v144, v144, s91, v28
v_fma_f32 v145, v145, s91, v28
v_fma_f32 v146, v146, s91, v28
v_fma_f32 v147, v147, s91, v28
v_fma_f32 v148, v148, s91, v28
v_fma_f32 v149, v149, s91, v28
v_fma_f32 v150, v150, s91, v28
v_mfma_f32_32x32x16_bf16 v[176:191], v[232:235], v[128:131], v[176:191]
ds_read_b64_tr_b16 a[74:75], v20 offset:10240
ds_read_b64_tr_b16 a[80:81], v21 offset:8192
ds_read_b64_tr_b16 a[82:83], v21 offset:10240
v_fma_f32 v151, v151, s91, v28
v_fma_f32 v152, v152, s91, v28
v_fma_f32 v153, v153, s91, v28
v_fma_f32 v154, v154, s91, v28
v_fma_f32 v155, v155, s91, v28
v_fma_f32 v156, v156, s91, v28
v_fma_f32 v157, v157, s91, v28
v_mfma_f32_32x32x16_bf16 v[192:207], v[240:243], v[128:131], v[192:207]
ds_read_b64_tr_b16 a[88:89], v22 offset:8192
ds_read_b64_tr_b16 a[90:91], v22 offset:10240
ds_read_b64_tr_b16 a[68:69], v19 offset:12288
v_fma_f32 v158, v158, s91, v28
v_fma_f32 v159, v159, s91, v28
v_exp_f32 v144, v144
v_exp_f32 v145, v145
v_exp_f32 v146, v146
v_exp_f32 v147, v147
v_exp_f32 v148, v148
v_mfma_f32_32x32x16_bf16 v[208:223], v[248:251], v[128:131], v[208:223]
ds_read_b64_tr_b16 a[70:71], v19 offset:14336
ds_read_b64_tr_b16 a[76:77], v20 offset:12288
ds_read_b64_tr_b16 a[78:79], v20 offset:14336
v_exp_f32 v149, v149
v_exp_f32 v150, v150
v_exp_f32 v151, v151
v_exp_f32 v152, v152
v_exp_f32 v153, v153
v_exp_f32 v154, v154
v_exp_f32 v155, v155
v_mfma_f32_32x32x16_bf16 v[160:175], v[228:231], v[132:135], v[160:175]
ds_read_b64_tr_b16 a[84:85], v21 offset:12288
ds_read_b64_tr_b16 a[86:87], v21 offset:14336
ds_read_b64_tr_b16 a[92:93], v22 offset:12288
v_exp_f32 v156, v156
v_exp_f32 v157, v157
v_exp_f32 v158, v158
v_exp_f32 v159, v159
v_add_f32 v29, v29, v144
v_add_f32 v30, v30, v145
v_add_f32 v29, v29, v146
v_mfma_f32_32x32x16_bf16 v[176:191], v[236:239], v[132:135], v[176:191]
ds_read_b64_tr_b16 a[94:95], v22 offset:14336
v_add_f32 v30, v30, v147
v_add_f32 v29, v29, v148
v_add_f32 v30, v30, v149
v_add_f32 v29, v29, v150
v_add_f32 v30, v30, v151
v_add_f32 v29, v29, v152
v_add_f32 v30, v30, v153
v_mfma_f32_32x32x16_bf16 v[192:207], v[244:247], v[132:135], v[192:207]
v_add_f32 v29, v29, v154
v_add_f32 v30, v30, v155
v_add_f32 v29, v29, v156
v_add_f32 v30, v30, v157
v_add_f32 v29, v29, v158
v_add_f32 v30, v30, v159
v_cvt_pk_bf16_f32 v144, v144, v145
v_mfma_f32_32x32x16_bf16 v[208:223], v[252:255], v[132:135], v[208:223]
v_cvt_pk_bf16_f32 v145, v146, v147
v_cvt_pk_bf16_f32 v146, v148, v149
v_cvt_pk_bf16_f32 v147, v150, v151
v_cvt_pk_bf16_f32 v148, v152, v153
v_cvt_pk_bf16_f32 v149, v154, v155
v_cvt_pk_bf16_f32 v150, v156, v157
v_cvt_pk_bf16_f32 v151, v158, v159
s_waitcnt lgkmcnt(0)
v_mfma_f32_32x32x16_bf16 v[160:175], a[64:67], v[144:147], v[160:175]
v_mfma_f32_32x32x16_bf16 v[176:191], a[72:75], v[144:147], v[176:191]
v_mfma_f32_32x32x16_bf16 v[192:207], a[80:83], v[144:147], v[192:207]
v_mfma_f32_32x32x16_bf16 v[208:223], a[88:91], v[144:147], v[208:223]
v_mfma_f32_32x32x16_bf16 v[160:175], a[68:71], v[148:151], v[160:175]
v_mfma_f32_32x32x16_bf16 v[176:191], a[76:79], v[148:151], v[176:191]
v_mfma_f32_32x32x16_bf16 v[192:207], a[84:87], v[148:151], v[192:207]
v_mfma_f32_32x32x16_bf16 v[208:223], a[92:95], v[148:151], v[208:223]
v_add_f32 v29, v29, v30
v_mov_b32 v31, v29
s_nop 1
v_permlane32_swap_b32 v29, v31
v_add_f32 v29, v29, v31
v_rcp_f32 v29, v29
s_nop 1
v_mul_f32 v160, v160, v29
v_mul_f32 v161, v161, v29
v_mul_f32 v162, v162, v29
v_mul_f32 v163, v163, v29
v_mul_f32 v164, v164, v29
v_mul_f32 v165, v165, v29
v_mul_f32 v166, v166, v29
v_mul_f32 v167, v167, v29
v_mul_f32 v168, v168, v29
v_mul_f32 v169, v169, v29
v_mul_f32 v170, v170, v29
v_mul_f32 v171, v171, v29
v_mul_f32 v172, v172, v29
v_mul_f32 v173, v173, v29
v_mul_f32 v174, v174, v29
v_mul_f32 v175, v175, v29
v_mul_f32 v176, v176, v29
v_mul_f32 v177, v177, v29
v_mul_f32 v178, v178, v29
v_mul_f32 v179, v179, v29
v_mul_f32 v180, v180, v29
v_mul_f32 v181, v181, v29
v_mul_f32 v182, v182, v29
v_mul_f32 v183, v183, v29
v_mul_f32 v184, v184, v29
v_mul_f32 v185, v185, v29
v_mul_f32 v186, v186, v29
v_mul_f32 v187, v187, v29
v_mul_f32 v188, v188, v29
v_mul_f32 v189, v189, v29
v_mul_f32 v190, v190, v29
v_mul_f32 v191, v191, v29
v_mul_f32 v192, v192, v29
v_mul_f32 v193, v193, v29
v_mul_f32 v194, v194, v29
v_mul_f32 v195, v195, v29
v_mul_f32 v196, v196, v29
v_mul_f32 v197, v197, v29
v_mul_f32 v198, v198, v29
v_mul_f32 v199, v199, v29
v_mul_f32 v200, v200, v29
v_mul_f32 v201, v201, v29
v_mul_f32 v202, v202, v29
v_mul_f32 v203, v203, v29
v_mul_f32 v204, v204, v29
v_mul_f32 v205, v205, v29
v_mul_f32 v206, v206, v29
v_mul_f32 v207, v207, v29
v_mul_f32 v208, v208, v29
v_mul_f32 v209, v209, v29
v_mul_f32 v210, v210, v29
v_mul_f32 v211, v211, v29
v_mul_f32 v212, v212, v29
v_mul_f32 v213, v213, v29
v_mul_f32 v214, v214, v29
v_mul_f32 v215, v215, v29
v_mul_f32 v216, v216, v29
v_mul_f32 v217, v217, v29
v_mul_f32 v218, v218, v29
v_mul_f32 v219, v219, v29
v_mul_f32 v220, v220, v29
v_mul_f32 v221, v221, v29
v_mul_f32 v222, v222, v29
v_mul_f32 v223, v223, v29
v_cvt_pk_bf16_f32 v32, v160, v161
v_cvt_pk_bf16_f32 v33, v162, v163
v_cvt_pk_bf16_f32 v34, v164, v165
v_cvt_pk_bf16_f32 v35, v166, v167
v_cvt_pk_bf16_f32 v36, v168, v169
v_cvt_pk_bf16_f32 v37, v170, v171
v_cvt_pk_bf16_f32 v38, v172, v173
v_cvt_pk_bf16_f32 v39, v174, v175
v_cvt_pk_bf16_f32 v40, v176, v177
v_cvt_pk_bf16_f32 v41, v178, v179
v_cvt_pk_bf16_f32 v42, v180, v181
v_cvt_pk_bf16_f32 v43, v182, v183
v_cvt_pk_bf16_f32 v44, v184, v185
v_cvt_pk_bf16_f32 v45, v186, v187
v_cvt_pk_bf16_f32 v46, v188, v189
v_cvt_pk_bf16_f32 v47, v190, v191
v_cvt_pk_bf16_f32 v48, v192, v193
v_cvt_pk_bf16_f32 v49, v194, v195
v_cvt_pk_bf16_f32 v50, v196, v197
v_cvt_pk_bf16_f32 v51, v198, v199
v_cvt_pk_bf16_f32 v52, v200, v201
v_cvt_pk_bf16_f32 v53, v202, v203
v_cvt_pk_bf16_f32 v54, v204, v205
v_cvt_pk_bf16_f32 v55, v206, v207
v_cvt_pk_bf16_f32 v56, v208, v209
v_cvt_pk_bf16_f32 v57, v210, v211
v_cvt_pk_bf16_f32 v58, v212, v213
v_cvt_pk_bf16_f32 v59, v214, v215
v_cvt_pk_bf16_f32 v60, v216, v217
v_cvt_pk_bf16_f32 v61, v218, v219
v_cvt_pk_bf16_f32 v62, v220, v221
v_cvt_pk_bf16_f32 v63, v222, v223
v_add_u32 v31, s86, v1
ds_write_b128 v31, v[32:35] offset:0
ds_write_b128 v31, v[36:39] offset:1024
ds_write_b128 v31, v[40:43] offset:2048
ds_write_b128 v31, v[44:47] offset:3072
ds_write_b128 v31, v[48:51] offset:4096
ds_write_b128 v31, v[52:55] offset:5120
ds_write_b128 v31, v[56:59] offset:6144
ds_write_b128 v31, v[60:63] offset:7168
s_waitcnt lgkmcnt(0)
s_barrier
v_add_u32 v228, 114688, v1
v_xor_b32 v224, 0, v4
v_add_u32 v236, s31, v224
v_add_u32 v224, s85, v224
v_xor_b32 v225, 64, v4
v_add_u32 v237, s31, v225
v_add_u32 v225, s85, v225
v_xor_b32 v226, 128, v4
v_add_u32 v238, s31, v226
v_add_u32 v226, s85, v226
v_xor_b32 v227, 192, v4
v_add_u32 v239, s31, v227
v_add_u32 v227, s85, v227
s_waitcnt vmcnt(8)
ds_read_b64_tr_b16 a[64:65], v224 offset:8192
ds_read_b64_tr_b16 a[66:67], v224 offset:10240
ds_read_b64_tr_b16 a[68:69], v225 offset:8192
ds_read_b64_tr_b16 a[70:71], v225 offset:10240
ds_read_b64_tr_b16 a[72:73], v226 offset:8192
ds_read_b64_tr_b16 a[74:75], v226 offset:10240
ds_read_b64_tr_b16 a[76:77], v227 offset:8192
ds_read_b64_tr_b16 a[78:79], v227 offset:10240
ds_read_b128 a[96:99], v228 offset:0
s_waitcnt lgkmcnt(0)
s_add_u32 s95, s82, 49152
s_add_u32 m0, s85, 8192
s_nop 0
buffer_load_dwordx4 v11, s[52:55], s95 offen offset:0 lds
buffer_load_dwordx4 v12, s[52:55], s95 offen offset:1024 lds
buffer_load_dwordx4 v13, s[52:55], s95 offen offset:2048 lds
buffer_load_dwordx4 v14, s[52:55], s95 offen offset:3072 lds
s_waitcnt vmcnt(8)
ds_read_b64_tr_b16 a[80:81], v224 offset:0
ds_read_b64_tr_b16 a[82:83], v224 offset:2048
ds_read_b64_tr_b16 a[84:85], v225 offset:0
ds_read_b64_tr_b16 a[86:87], v225 offset:2048
ds_read_b64_tr_b16 a[88:89], v226 offset:0
ds_read_b64_tr_b16 a[90:91], v226 offset:2048
ds_read_b64_tr_b16 a[92:93], v227 offset:0
ds_read_b64_tr_b16 a[94:95], v227 offset:2048
ds_read_b128 a[100:103], v228 offset:1024
v_mfma_f32_32x32x16_bf16 v[160:175], a[64:67], a[96:99], 0
v_mfma_f32_32x32x16_bf16 v[176:191], a[68:71], a[96:99], 0
v_mfma_f32_32x32x16_bf16 v[192:207], a[72:75], a[96:99], 0
s_waitcnt lgkmcnt(0)
s_add_u32 s95, s82, 65536
s_add_u32 m0, s85, 0
s_nop 0
buffer_load_dwordx4 v11, s[52:55], s95 offen offset:0 lds
buffer_load_dwordx4 v12, s[52:55], s95 offen offset:1024 lds
v_mfma_f32_32x32x16_bf16 v[208:223], a[76:79], a[96:99], 0
buffer_load_dwordx4 v13, s[52:55], s95 offen offset:2048 lds
buffer_load_dwordx4 v14, s[52:55], s95 offen offset:3072 lds
s_waitcnt vmcnt(8)
ds_read_b64_tr_b16 a[64:65], v224 offset:4096
ds_read_b64_tr_b16 a[66:67], v224 offset:6144
ds_read_b64_tr_b16 a[68:69], v225 offset:4096
ds_read_b64_tr_b16 a[70:71], v225 offset:6144
ds_read_b64_tr_b16 a[72:73], v226 offset:4096
ds_read_b64_tr_b16 a[74:75], v226 offset:6144
ds_read_b64_tr_b16 a[76:77], v227 offset:4096
ds_read_b64_tr_b16 a[78:79], v227 offset:6144
ds_read_b128 a[96:99], v228 offset:2048
v_mfma_f32_32x32x16_bf16 v[160:175], a[80:83], a[100:103], v[160:175]
v_mfma_f32_32x32x16_bf16 v[176:191], a[84:87], a[100:103], v[176:191]
v_mfma_f32_32x32x16_bf16 v[192:207], a[88:91], a[100:103], v[192:207]
s_waitcnt lgkmcnt(0)
s_add_u32 s95, s82, 81920
s_add_u32 m0, s85, 4096
s_nop 0
buffer_load_dwordx4 v11, s[52:55], s95 offen offset:0 lds
buffer_load_dwordx4 v12, s[52:55], s95 offen offset:1024 lds
v_mfma_f32_32x32x16_bf16 v[208:223], a[92:95], a[100:103], v[208:223]
buffer_load_dwordx4 v13, s[52:55], s95 offen offset:2048 lds
buffer_load_dwordx4 v14, s[52:55], s95 offen offset:3072 lds
s_waitcnt vmcnt(8)
ds_read_b64_tr_b16 a[80:81], v224 offset:8192
ds_read_b64_tr_b16 a[82:83], v224 offset:10240
ds_read_b64_tr_b16 a[84:85], v225 offset:8192
ds_read_b64_tr_b16 a[86:87], v225 offset:10240
ds_read_b64_tr_b16 a[88:89], v226 offset:8192
ds_read_b64_tr_b16 a[90:91], v226 offset:10240
ds_read_b64_tr_b16 a[92:93], v227 offset:8192
ds_read_b64_tr_b16 a[94:95], v227 offset:10240
ds_read_b128 a[100:103], v228 offset:3072
v_mfma_f32_32x32x16_bf16 v[160:175], a[64:67], a[96:99], v[160:175]
v_mfma_f32_32x32x16_bf16 v[176:191], a[68:71], a[96:99], v[176:191]
v_mfma_f32_32x32x16_bf16 v[192:207], a[72:75], a[96:99], v[192:207]
s_waitcnt lgkmcnt(0)
s_add_u32 s95, s82, 98304
s_add_u32 m0, s85, 8192
s_nop 0
buffer_load_dwordx4 v11, s[52:55], s95 offen offset:0 lds
buffer_load_dwordx4 v12, s[52:55], s95 offen offset:1024 lds
v_mfma_f32_32x32x16_bf16 v[208:223], a[76:79], a[96:99], v[208:223]
buffer_load_dwordx4 v13, s[52:55], s95 offen offset:2048 lds
buffer_load_dwordx4 v14, s[52:55], s95 offen offset:3072 lds
s_waitcnt vmcnt(8)
ds_read_b64_tr_b16 a[64:65], v224 offset:0
ds_read_b64_tr_b16 a[66:67], v224 offset:2048
ds_read_b64_tr_b16 a[68:69], v225 offset:0
ds_read_b64_tr_b16 a[70:71], v225 offset:2048
ds_read_b64_tr_b16 a[72:73], v226 offset:0
ds_read_b64_tr_b16 a[74:75], v226 offset:2048
ds_read_b64_tr_b16 a[76:77], v227 offset:0
ds_read_b64_tr_b16 a[78:79], v227 offset:2048
ds_read_b128 a[96:99], v228 offset:4096
v_mfma_f32_32x32x16_bf16 v[160:175], a[80:83], a[100:103], v[160:175]
v_mfma_f32_32x32x16_bf16 v[176:191], a[84:87], a[100:103], v[176:191]
v_mfma_f32_32x32x16_bf16 v[192:207], a[88:91], a[100:103], v[192:207]
s_waitcnt lgkmcnt(0)
s_add_u32 s95, s82, 114688
s_add_u32 m0, s85, 0
s_nop 0
buffer_load_dwordx4 v11, s[52:55], s95 offen offset:0 lds
buffer_load_dwordx4 v12, s[52:55], s95 offen offset:1024 lds
v_mfma_f32_32x32x16_bf16 v[208:223], a[92:95], a[100:103], v[208:223]
buffer_load_dwordx4 v13, s[52:55], s95 offen offset:2048 lds
buffer_load_dwordx4 v14, s[52:55], s95 offen offset:3072 lds
s_waitcnt vmcnt(8)
ds_read_b64_tr_b16 a[80:81], v224 offset:4096
ds_read_b64_tr_b16 a[82:83], v224 offset:6144
ds_read_b64_tr_b16 a[84:85], v225 offset:4096
ds_read_b64_tr_b16 a[86:87], v225 offset:6144
ds_read_b64_tr_b16 a[88:89], v226 offset:4096
ds_read_b64_tr_b16 a[90:91], v226 offset:6144
ds_read_b64_tr_b16 a[92:93], v227 offset:4096
ds_read_b64_tr_b16 a[94:95], v227 offset:6144
ds_read_b128 a[100:103], v228 offset:5120
v_mfma_f32_32x32x16_bf16 v[160:175], a[64:67], a[96:99], v[160:175]
v_mfma_f32_32x32x16_bf16 v[176:191], a[68:71], a[96:99], v[176:191]
v_mfma_f32_32x32x16_bf16 v[192:207], a[72:75], a[96:99], v[192:207]
s_waitcnt lgkmcnt(0)
s_add_u32 s95, s82, 131072
s_add_u32 m0, s85, 4096
s_nop 0
buffer_load_dwordx4 v11, s[52:55], s95 offen offset:0 lds
buffer_load_dwordx4 v12, s[52:55], s95 offen offset:1024 lds
v_mfma_f32_32x32x16_bf16 v[208:223], a[76:79], a[96:99], v[208:223]
buffer_load_dwordx4 v13, s[52:55], s95 offen offset:2048 lds
buffer_load_dwordx4 v14, s[52:55], s95 offen offset:3072 lds
s_waitcnt vmcnt(8)
ds_read_b64_tr_b16 a[64:65], v224 offset:8192
ds_read_b64_tr_b16 a[66:67], v224 offset:10240
ds_read_b64_tr_b16 a[68:69], v225 offset:8192
ds_read_b64_tr_b16 a[70:71], v225 offset:10240
ds_read_b64_tr_b16 a[72:73], v226 offset:8192
ds_read_b64_tr_b16 a[74:75], v226 offset:10240
ds_read_b64_tr_b16 a[76:77], v227 offset:8192
ds_read_b64_tr_b16 a[78:79], v227 offset:10240
ds_read_b128 a[96:99], v228 offset:6144
v_mfma_f32_32x32x16_bf16 v[160:175], a[80:83], a[100:103], v[160:175]
v_mfma_f32_32x32x16_bf16 v[176:191], a[84:87], a[100:103], v[176:191]
v_mfma_f32_32x32x16_bf16 v[192:207], a[88:91], a[100:103], v[192:207]
s_waitcnt lgkmcnt(0)
s_add_u32 s95, s82, 147456
s_add_u32 m0, s85, 8192
s_nop 0
buffer_load_dwordx4 v11, s[52:55], s95 offen offset:0 lds
buffer_load_dwordx4 v12, s[52:55], s95 offen offset:1024 lds
v_mfma_f32_32x32x16_bf16 v[208:223], a[92:95], a[100:103], v[208:223]
buffer_load_dwordx4 v13, s[52:55], s95 offen offset:2048 lds
buffer_load_dwordx4 v14, s[52:55], s95 offen offset:3072 lds
s_waitcnt vmcnt(8)
ds_read_b64_tr_b16 a[80:81], v224 offset:0
ds_read_b64_tr_b16 a[82:83], v224 offset:2048
ds_read_b64_tr_b16 a[84:85], v225 offset:0
ds_read_b64_tr_b16 a[86:87], v225 offset:2048
ds_read_b64_tr_b16 a[88:89], v226 offset:0
ds_read_b64_tr_b16 a[90:91], v226 offset:2048
ds_read_b64_tr_b16 a[92:93], v227 offset:0
ds_read_b64_tr_b16 a[94:95], v227 offset:2048
ds_read_b128 a[100:103], v228 offset:7168
v_mfma_f32_32x32x16_bf16 v[160:175], a[64:67], a[96:99], v[160:175]
v_mfma_f32_32x32x16_bf16 v[176:191], a[68:71], a[96:99], v[176:191]
v_mfma_f32_32x32x16_bf16 v[192:207], a[72:75], a[96:99], v[192:207]
s_waitcnt lgkmcnt(0)
s_add_u32 s95, s82, 163840
s_add_u32 m0, s85, 0
s_nop 0
buffer_load_dwordx4 v11, s[52:55], s95 offen offset:0 lds
buffer_load_dwordx4 v12, s[52:55], s95 offen offset:1024 lds
v_mfma_f32_32x32x16_bf16 v[208:223], a[76:79], a[96:99], v[208:223]
buffer_load_dwordx4 v13, s[52:55], s95 offen offset:2048 lds
buffer_load_dwordx4 v14, s[52:55], s95 offen offset:3072 lds
s_waitcnt vmcnt(8)
ds_read_b64_tr_b16 a[64:65], v224 offset:4096
ds_read_b64_tr_b16 a[66:67], v224 offset:6144
ds_read_b64_tr_b16 a[68:69], v225 offset:4096
ds_read_b64_tr_b16 a[70:71], v225 offset:6144
ds_read_b64_tr_b16 a[72:73], v226 offset:4096
ds_read_b64_tr_b16 a[74:75], v226 offset:6144
ds_read_b64_tr_b16 a[76:77], v227 offset:4096
ds_read_b64_tr_b16 a[78:79], v227 offset:6144
ds_read_b128 a[96:99], v228 offset:8192
v_mfma_f32_32x32x16_bf16 v[160:175], a[80:83], a[100:103], v[160:175]
v_mfma_f32_32x32x16_bf16 v[176:191], a[84:87], a[100:103], v[176:191]
v_mfma_f32_32x32x16_bf16 v[192:207], a[88:91], a[100:103], v[192:207]
s_waitcnt lgkmcnt(0)
s_add_u32 s95, s82, 180224
s_add_u32 m0, s85, 4096
s_nop 0
buffer_load_dwordx4 v11, s[52:55], s95 offen offset:0 lds
buffer_load_dwordx4 v12, s[52:55], s95 offen offset:1024 lds
v_mfma_f32_32x32x16_bf16 v[208:223], a[92:95], a[100:103], v[208:223]
buffer_load_dwordx4 v13, s[52:55], s95 offen offset:2048 lds
buffer_load_dwordx4 v14, s[52:55], s95 offen offset:3072 lds
s_waitcnt vmcnt(8)
ds_read_b64_tr_b16 a[80:81], v224 offset:8192
ds_read_b64_tr_b16 a[82:83], v224 offset:10240
ds_read_b64_tr_b16 a[84:85], v225 offset:8192
ds_read_b64_tr_b16 a[86:87], v225 offset:10240
ds_read_b64_tr_b16 a[88:89], v226 offset:8192
ds_read_b64_tr_b16 a[90:91], v226 offset:10240
ds_read_b64_tr_b16 a[92:93], v227 offset:8192
ds_read_b64_tr_b16 a[94:95], v227 offset:10240
ds_read_b128 a[100:103], v228 offset:9216
v_mfma_f32_32x32x16_bf16 v[160:175], a[64:67], a[96:99], v[160:175]
v_mfma_f32_32x32x16_bf16 v[176:191], a[68:71], a[96:99], v[176:191]
v_mfma_f32_32x32x16_bf16 v[192:207], a[72:75], a[96:99], v[192:207]
s_waitcnt lgkmcnt(0)
s_add_u32 s95, s82, 196608
s_add_u32 m0, s85, 8192
s_nop 0
buffer_load_dwordx4 v11, s[52:55], s95 offen offset:0 lds
buffer_load_dwordx4 v12, s[52:55], s95 offen offset:1024 lds
v_mfma_f32_32x32x16_bf16 v[208:223], a[76:79], a[96:99], v[208:223]
buffer_load_dwordx4 v13, s[52:55], s95 offen offset:2048 lds
buffer_load_dwordx4 v14, s[52:55], s95 offen offset:3072 lds
s_waitcnt vmcnt(8)
ds_read_b64_tr_b16 a[64:65], v224 offset:0
ds_read_b64_tr_b16 a[66:67], v224 offset:2048
ds_read_b64_tr_b16 a[68:69], v225 offset:0
ds_read_b64_tr_b16 a[70:71], v225 offset:2048
ds_read_b64_tr_b16 a[72:73], v226 offset:0
ds_read_b64_tr_b16 a[74:75], v226 offset:2048
ds_read_b64_tr_b16 a[76:77], v227 offset:0
ds_read_b64_tr_b16 a[78:79], v227 offset:2048
ds_read_b128 a[96:99], v228 offset:10240
v_mfma_f32_32x32x16_bf16 v[160:175], a[80:83], a[100:103], v[160:175]
v_mfma_f32_32x32x16_bf16 v[176:191], a[84:87], a[100:103], v[176:191]
v_mfma_f32_32x32x16_bf16 v[192:207], a[88:91], a[100:103], v[192:207]
s_waitcnt lgkmcnt(0)
s_add_u32 s95, s82, 212992
s_add_u32 m0, s85, 0
s_nop 0
buffer_load_dwordx4 v11, s[52:55], s95 offen offset:0 lds
buffer_load_dwordx4 v12, s[52:55], s95 offen offset:1024 lds
v_mfma_f32_32x32x16_bf16 v[208:223], a[92:95], a[100:103], v[208:223]
buffer_load_dwordx4 v13, s[52:55], s95 offen offset:2048 lds
buffer_load_dwordx4 v14, s[52:55], s95 offen offset:3072 lds
s_waitcnt vmcnt(8)
ds_read_b64_tr_b16 a[80:81], v224 offset:4096
ds_read_b64_tr_b16 a[82:83], v224 offset:6144
ds_read_b64_tr_b16 a[84:85], v225 offset:4096
ds_read_b64_tr_b16 a[86:87], v225 offset:6144
ds_read_b64_tr_b16 a[88:89], v226 offset:4096
ds_read_b64_tr_b16 a[90:91], v226 offset:6144
ds_read_b64_tr_b16 a[92:93], v227 offset:4096
ds_read_b64_tr_b16 a[94:95], v227 offset:6144
ds_read_b128 a[100:103], v228 offset:11264
v_mfma_f32_32x32x16_bf16 v[160:175], a[64:67], a[96:99], v[160:175]
v_mfma_f32_32x32x16_bf16 v[176:191], a[68:71], a[96:99], v[176:191]
v_mfma_f32_32x32x16_bf16 v[192:207], a[72:75], a[96:99], v[192:207]
s_waitcnt lgkmcnt(0)
s_add_u32 s95, s82, 229376
s_add_u32 m0, s85, 4096
s_nop 0
buffer_load_dwordx4 v11, s[52:55], s95 offen offset:0 lds
buffer_load_dwordx4 v12, s[52:55], s95 offen offset:1024 lds
v_mfma_f32_32x32x16_bf16 v[208:223], a[76:79], a[96:99], v[208:223]
buffer_load_dwordx4 v13, s[52:55], s95 offen offset:2048 lds
buffer_load_dwordx4 v14, s[52:55], s95 offen offset:3072 lds
s_waitcnt vmcnt(8)
ds_read_b64_tr_b16 a[64:65], v224 offset:8192
ds_read_b64_tr_b16 a[66:67], v224 offset:10240
ds_read_b64_tr_b16 a[68:69], v225 offset:8192
ds_read_b64_tr_b16 a[70:71], v225 offset:10240
ds_read_b64_tr_b16 a[72:73], v226 offset:8192
ds_read_b64_tr_b16 a[74:75], v226 offset:10240
ds_read_b64_tr_b16 a[76:77], v227 offset:8192
ds_read_b64_tr_b16 a[78:79], v227 offset:10240
ds_read_b128 a[96:99], v228 offset:12288
v_mfma_f32_32x32x16_bf16 v[160:175], a[80:83], a[100:103], v[160:175]
v_mfma_f32_32x32x16_bf16 v[176:191], a[84:87], a[100:103], v[176:191]
v_mfma_f32_32x32x16_bf16 v[192:207], a[88:91], a[100:103], v[192:207]
s_waitcnt lgkmcnt(0)
s_add_u32 s95, s82, 245760
s_add_u32 m0, s85, 8192
s_nop 0
buffer_load_dwordx4 v11, s[52:55], s95 offen offset:0 lds
buffer_load_dwordx4 v12, s[52:55], s95 offen offset:1024 lds
v_mfma_f32_32x32x16_bf16 v[208:223], a[92:95], a[100:103], v[208:223]
buffer_load_dwordx4 v13, s[52:55], s95 offen offset:2048 lds
buffer_load_dwordx4 v14, s[52:55], s95 offen offset:3072 lds
s_waitcnt vmcnt(8)
ds_read_b64_tr_b16 a[80:81], v224 offset:0
ds_read_b64_tr_b16 a[82:83], v224 offset:2048
ds_read_b64_tr_b16 a[84:85], v225 offset:0
ds_read_b64_tr_b16 a[86:87], v225 offset:2048
ds_read_b64_tr_b16 a[88:89], v226 offset:0
ds_read_b64_tr_b16 a[90:91], v226 offset:2048
ds_read_b64_tr_b16 a[92:93], v227 offset:0
ds_read_b64_tr_b16 a[94:95], v227 offset:2048
ds_read_b128 a[100:103], v228 offset:13312
v_mfma_f32_32x32x16_bf16 v[160:175], a[64:67], a[96:99], v[160:175]
v_mfma_f32_32x32x16_bf16 v[176:191], a[68:71], a[96:99], v[176:191]
v_mfma_f32_32x32x16_bf16 v[192:207], a[72:75], a[96:99], v[192:207]
s_waitcnt lgkmcnt(0)
s_add_u32 s95, s82, 262144
s_add_u32 m0, s85, 0
s_nop 0
buffer_load_dwordx4 v11, s[52:55], s95 offen offset:0 lds
buffer_load_dwordx4 v12, s[52:55], s95 offen offset:1024 lds
v_mfma_f32_32x32x16_bf16 v[208:223], a[76:79], a[96:99], v[208:223]
buffer_load_dwordx4 v13, s[52:55], s95 offen offset:2048 lds
buffer_load_dwordx4 v14, s[52:55], s95 offen offset:3072 lds
s_waitcnt vmcnt(8)
ds_read_b64_tr_b16 a[64:65], v224 offset:4096
ds_read_b64_tr_b16 a[66:67], v224 offset:6144
ds_read_b64_tr_b16 a[68:69], v225 offset:4096
ds_read_b64_tr_b16 a[70:71], v225 offset:6144
ds_read_b64_tr_b16 a[72:73], v226 offset:4096
ds_read_b64_tr_b16 a[74:75], v226 offset:6144
ds_read_b64_tr_b16 a[76:77], v227 offset:4096
ds_read_b64_tr_b16 a[78:79], v227 offset:6144
ds_read_b128 a[96:99], v228 offset:14336
v_mfma_f32_32x32x16_bf16 v[160:175], a[80:83], a[100:103], v[160:175]
v_mfma_f32_32x32x16_bf16 v[176:191], a[84:87], a[100:103], v[176:191]
v_mfma_f32_32x32x16_bf16 v[192:207], a[88:91], a[100:103], v[192:207]
s_waitcnt lgkmcnt(0)
s_add_u32 s95, s82, 278528
s_add_u32 m0, s85, 4096
s_nop 0
buffer_load_dwordx4 v11, s[52:55], s95 offen offset:0 lds
buffer_load_dwordx4 v12, s[52:55], s95 offen offset:1024 lds
v_mfma_f32_32x32x16_bf16 v[208:223], a[92:95], a[100:103], v[208:223]
buffer_load_dwordx4 v13, s[52:55], s95 offen offset:2048 lds
buffer_load_dwordx4 v14, s[52:55], s95 offen offset:3072 lds
s_waitcnt vmcnt(8)
ds_read_b64_tr_b16 a[80:81], v224 offset:8192
ds_read_b64_tr_b16 a[82:83], v224 offset:10240
ds_read_b64_tr_b16 a[84:85], v225 offset:8192
ds_read_b64_tr_b16 a[86:87], v225 offset:10240
ds_read_b64_tr_b16 a[88:89], v226 offset:8192
ds_read_b64_tr_b16 a[90:91], v226 offset:10240
ds_read_b64_tr_b16 a[92:93], v227 offset:8192
ds_read_b64_tr_b16 a[94:95], v227 offset:10240
ds_read_b128 a[100:103], v228 offset:15360
v_mfma_f32_32x32x16_bf16 v[160:175], a[64:67], a[96:99], v[160:175]
v_mfma_f32_32x32x16_bf16 v[176:191], a[68:71], a[96:99], v[176:191]
v_mfma_f32_32x32x16_bf16 v[192:207], a[72:75], a[96:99], v[192:207]
s_waitcnt lgkmcnt(0)
s_add_u32 s95, s82, 294912
s_add_u32 m0, s85, 8192
s_nop 0
buffer_load_dwordx4 v11, s[52:55], s95 offen offset:0 lds
buffer_load_dwordx4 v12, s[52:55], s95 offen offset:1024 lds
v_mfma_f32_32x32x16_bf16 v[208:223], a[76:79], a[96:99], v[208:223]
buffer_load_dwordx4 v13, s[52:55], s95 offen offset:2048 lds
buffer_load_dwordx4 v14, s[52:55], s95 offen offset:3072 lds
s_waitcnt vmcnt(8)
ds_read_b64_tr_b16 a[64:65], v224 offset:0
ds_read_b64_tr_b16 a[66:67], v224 offset:2048
ds_read_b64_tr_b16 a[68:69], v225 offset:0
ds_read_b64_tr_b16 a[70:71], v225 offset:2048
ds_read_b64_tr_b16 a[72:73], v226 offset:0
ds_read_b64_tr_b16 a[74:75], v226 offset:2048
ds_read_b64_tr_b16 a[76:77], v227 offset:0
ds_read_b64_tr_b16 a[78:79], v227 offset:2048
ds_read_b128 a[96:99], v228 offset:16384
v_mfma_f32_32x32x16_bf16 v[160:175], a[80:83], a[100:103], v[160:175]
v_mfma_f32_32x32x16_bf16 v[176:191], a[84:87], a[100:103], v[176:191]
v_mfma_f32_32x32x16_bf16 v[192:207], a[88:91], a[100:103], v[192:207]
s_waitcnt lgkmcnt(0)
s_add_u32 s95, s82, 311296
s_add_u32 m0, s85, 0
s_nop 0
buffer_load_dwordx4 v11, s[52:55], s95 offen offset:0 lds
buffer_load_dwordx4 v12, s[52:55], s95 offen offset:1024 lds
v_mfma_f32_32x32x16_bf16 v[208:223], a[92:95], a[100:103], v[208:223]
buffer_load_dwordx4 v13, s[52:55], s95 offen offset:2048 lds
buffer_load_dwordx4 v14, s[52:55], s95 offen offset:3072 lds
s_waitcnt vmcnt(8)
ds_read_b64_tr_b16 a[80:81], v224 offset:4096
ds_read_b64_tr_b16 a[82:83], v224 offset:6144
ds_read_b64_tr_b16 a[84:85], v225 offset:4096
ds_read_b64_tr_b16 a[86:87], v225 offset:6144
ds_read_b64_tr_b16 a[88:89], v226 offset:4096
ds_read_b64_tr_b16 a[90:91], v226 offset:6144
ds_read_b64_tr_b16 a[92:93], v227 offset:4096
ds_read_b64_tr_b16 a[94:95], v227 offset:6144
ds_read_b128 a[100:103], v228 offset:17408
v_mfma_f32_32x32x16_bf16 v[160:175], a[64:67], a[96:99], v[160:175]
v_mfma_f32_32x32x16_bf16 v[176:191], a[68:71], a[96:99], v[176:191]
v_mfma_f32_32x32x16_bf16 v[192:207], a[72:75], a[96:99], v[192:207]
s_waitcnt lgkmcnt(0)
s_add_u32 s95, s82, 327680
s_add_u32 m0, s85, 4096
s_nop 0
buffer_load_dwordx4 v11, s[52:55], s95 offen offset:0 lds
buffer_load_dwordx4 v12, s[52:55], s95 offen offset:1024 lds
v_mfma_f32_32x32x16_bf16 v[208:223], a[76:79], a[96:99], v[208:223]
buffer_load_dwordx4 v13, s[52:55], s95 offen offset:2048 lds
buffer_load_dwordx4 v14, s[52:55], s95 offen offset:3072 lds
s_waitcnt vmcnt(8)
ds_read_b64_tr_b16 a[64:65], v224 offset:8192
ds_read_b64_tr_b16 a[66:67], v224 offset:10240
ds_read_b64_tr_b16 a[68:69], v225 offset:8192
ds_read_b64_tr_b16 a[70:71], v225 offset:10240
ds_read_b64_tr_b16 a[72:73], v226 offset:8192
ds_read_b64_tr_b16 a[74:75], v226 offset:10240
ds_read_b64_tr_b16 a[76:77], v227 offset:8192
ds_read_b64_tr_b16 a[78:79], v227 offset:10240
ds_read_b128 a[96:99], v228 offset:18432
v_mfma_f32_32x32x16_bf16 v[160:175], a[80:83], a[100:103], v[160:175]
v_mfma_f32_32x32x16_bf16 v[176:191], a[84:87], a[100:103], v[176:191]
v_mfma_f32_32x32x16_bf16 v[192:207], a[88:91], a[100:103], v[192:207]
s_waitcnt lgkmcnt(0)
s_add_u32 s95, s82, 344064
s_add_u32 m0, s85, 8192
s_nop 0
buffer_load_dwordx4 v11, s[52:55], s95 offen offset:0 lds
buffer_load_dwordx4 v12, s[52:55], s95 offen offset:1024 lds
v_mfma_f32_32x32x16_bf16 v[208:223], a[92:95], a[100:103], v[208:223]
buffer_load_dwordx4 v13, s[52:55], s95 offen offset:2048 lds
buffer_load_dwordx4 v14, s[52:55], s95 offen offset:3072 lds
s_waitcnt vmcnt(8)
ds_read_b64_tr_b16 a[80:81], v224 offset:0
ds_read_b64_tr_b16 a[82:83], v224 offset:2048
ds_read_b64_tr_b16 a[84:85], v225 offset:0
ds_read_b64_tr_b16 a[86:87], v225 offset:2048
ds_read_b64_tr_b16 a[88:89], v226 offset:0
ds_read_b64_tr_b16 a[90:91], v226 offset:2048
ds_read_b64_tr_b16 a[92:93], v227 offset:0
ds_read_b64_tr_b16 a[94:95], v227 offset:2048
ds_read_b128 a[100:103], v228 offset:19456
v_mfma_f32_32x32x16_bf16 v[160:175], a[64:67], a[96:99], v[160:175]
v_mfma_f32_32x32x16_bf16 v[176:191], a[68:71], a[96:99], v[176:191]
v_mfma_f32_32x32x16_bf16 v[192:207], a[72:75], a[96:99], v[192:207]
s_waitcnt lgkmcnt(0)
s_add_u32 s95, s82, 360448
s_add_u32 m0, s85, 0
s_nop 0
buffer_load_dwordx4 v11, s[52:55], s95 offen offset:0 lds
buffer_load_dwordx4 v12, s[52:55], s95 offen offset:1024 lds
v_mfma_f32_32x32x16_bf16 v[208:223], a[76:79], a[96:99], v[208:223]
buffer_load_dwordx4 v13, s[52:55], s95 offen offset:2048 lds
buffer_load_dwordx4 v14, s[52:55], s95 offen offset:3072 lds
s_waitcnt vmcnt(8)
ds_read_b64_tr_b16 a[64:65], v224 offset:4096
ds_read_b64_tr_b16 a[66:67], v224 offset:6144
ds_read_b64_tr_b16 a[68:69], v225 offset:4096
ds_read_b64_tr_b16 a[70:71], v225 offset:6144
ds_read_b64_tr_b16 a[72:73], v226 offset:4096
ds_read_b64_tr_b16 a[74:75], v226 offset:6144
ds_read_b64_tr_b16 a[76:77], v227 offset:4096
ds_read_b64_tr_b16 a[78:79], v227 offset:6144
ds_read_b128 a[96:99], v228 offset:20480
v_mfma_f32_32x32x16_bf16 v[160:175], a[80:83], a[100:103], v[160:175]
v_mfma_f32_32x32x16_bf16 v[176:191], a[84:87], a[100:103], v[176:191]
v_mfma_f32_32x32x16_bf16 v[192:207], a[88:91], a[100:103], v[192:207]
s_waitcnt lgkmcnt(0)
s_add_u32 s95, s82, 376832
s_add_u32 m0, s85, 4096
s_nop 0
buffer_load_dwordx4 v11, s[52:55], s95 offen offset:0 lds
buffer_load_dwordx4 v12, s[52:55], s95 offen offset:1024 lds
v_mfma_f32_32x32x16_bf16 v[208:223], a[92:95], a[100:103], v[208:223]
buffer_load_dwordx4 v13, s[52:55], s95 offen offset:2048 lds
buffer_load_dwordx4 v14, s[52:55], s95 offen offset:3072 lds
s_waitcnt vmcnt(8)
ds_read_b64_tr_b16 a[80:81], v224 offset:8192
ds_read_b64_tr_b16 a[82:83], v224 offset:10240
ds_read_b64_tr_b16 a[84:85], v225 offset:8192
ds_read_b64_tr_b16 a[86:87], v225 offset:10240
ds_read_b64_tr_b16 a[88:89], v226 offset:8192
ds_read_b64_tr_b16 a[90:91], v226 offset:10240
ds_read_b64_tr_b16 a[92:93], v227 offset:8192
ds_read_b64_tr_b16 a[94:95], v227 offset:10240
ds_read_b128 a[100:103], v228 offset:21504
v_mfma_f32_32x32x16_bf16 v[160:175], a[64:67], a[96:99], v[160:175]
v_mfma_f32_32x32x16_bf16 v[176:191], a[68:71], a[96:99], v[176:191]
v_mfma_f32_32x32x16_bf16 v[192:207], a[72:75], a[96:99], v[192:207]
s_waitcnt lgkmcnt(0)
s_add_u32 s95, s82, 393216
s_add_u32 m0, s85, 8192
s_nop 0
buffer_load_dwordx4 v11, s[52:55], s95 offen offset:0 lds
buffer_load_dwordx4 v12, s[52:55], s95 offen offset:1024 lds
v_mfma_f32_32x32x16_bf16 v[208:223], a[76:79], a[96:99], v[208:223]
buffer_load_dwordx4 v13, s[52:55], s95 offen offset:2048 lds
buffer_load_dwordx4 v14, s[52:55], s95 offen offset:3072 lds
s_waitcnt vmcnt(8)
ds_read_b64_tr_b16 a[64:65], v224 offset:0
ds_read_b64_tr_b16 a[66:67], v224 offset:2048
ds_read_b64_tr_b16 a[68:69], v225 offset:0
ds_read_b64_tr_b16 a[70:71], v225 offset:2048
ds_read_b64_tr_b16 a[72:73], v226 offset:0
ds_read_b64_tr_b16 a[74:75], v226 offset:2048
ds_read_b64_tr_b16 a[76:77], v227 offset:0
ds_read_b64_tr_b16 a[78:79], v227 offset:2048
ds_read_b128 a[96:99], v228 offset:22528
v_mfma_f32_32x32x16_bf16 v[160:175], a[80:83], a[100:103], v[160:175]
v_mfma_f32_32x32x16_bf16 v[176:191], a[84:87], a[100:103], v[176:191]
v_mfma_f32_32x32x16_bf16 v[192:207], a[88:91], a[100:103], v[192:207]
s_waitcnt lgkmcnt(0)
s_add_u32 s95, s82, 409600
s_add_u32 m0, s85, 0
s_nop 0
buffer_load_dwordx4 v11, s[52:55], s95 offen offset:0 lds
buffer_load_dwordx4 v12, s[52:55], s95 offen offset:1024 lds
v_mfma_f32_32x32x16_bf16 v[208:223], a[92:95], a[100:103], v[208:223]
buffer_load_dwordx4 v13, s[52:55], s95 offen offset:2048 lds
buffer_load_dwordx4 v14, s[52:55], s95 offen offset:3072 lds
s_waitcnt vmcnt(8)
ds_read_b64_tr_b16 a[80:81], v224 offset:4096
ds_read_b64_tr_b16 a[82:83], v224 offset:6144
ds_read_b64_tr_b16 a[84:85], v225 offset:4096
ds_read_b64_tr_b16 a[86:87], v225 offset:6144
ds_read_b64_tr_b16 a[88:89], v226 offset:4096
ds_read_b64_tr_b16 a[90:91], v226 offset:6144
ds_read_b64_tr_b16 a[92:93], v227 offset:4096
ds_read_b64_tr_b16 a[94:95], v227 offset:6144
ds_read_b128 a[100:103], v228 offset:23552
v_mfma_f32_32x32x16_bf16 v[160:175], a[64:67], a[96:99], v[160:175]
v_mfma_f32_32x32x16_bf16 v[176:191], a[68:71], a[96:99], v[176:191]
v_mfma_f32_32x32x16_bf16 v[192:207], a[72:75], a[96:99], v[192:207]
s_waitcnt lgkmcnt(0)
s_add_u32 s95, s82, 425984
s_add_u32 m0, s85, 4096
s_nop 0
buffer_load_dwordx4 v11, s[52:55], s95 offen offset:0 lds
buffer_load_dwordx4 v12, s[52:55], s95 offen offset:1024 lds
v_mfma_f32_32x32x16_bf16 v[208:223], a[76:79], a[96:99], v[208:223]
buffer_load_dwordx4 v13, s[52:55], s95 offen offset:2048 lds
buffer_load_dwordx4 v14, s[52:55], s95 offen offset:3072 lds
s_waitcnt vmcnt(8)
ds_read_b64_tr_b16 a[64:65], v224 offset:8192
ds_read_b64_tr_b16 a[66:67], v224 offset:10240
ds_read_b64_tr_b16 a[68:69], v225 offset:8192
ds_read_b64_tr_b16 a[70:71], v225 offset:10240
ds_read_b64_tr_b16 a[72:73], v226 offset:8192
ds_read_b64_tr_b16 a[74:75], v226 offset:10240
ds_read_b64_tr_b16 a[76:77], v227 offset:8192
ds_read_b64_tr_b16 a[78:79], v227 offset:10240
ds_read_b128 a[96:99], v228 offset:24576
v_mfma_f32_32x32x16_bf16 v[160:175], a[80:83], a[100:103], v[160:175]
v_mfma_f32_32x32x16_bf16 v[176:191], a[84:87], a[100:103], v[176:191]
v_mfma_f32_32x32x16_bf16 v[192:207], a[88:91], a[100:103], v[192:207]
s_waitcnt lgkmcnt(0)
s_add_u32 s95, s82, 442368
s_add_u32 m0, s85, 8192
s_nop 0
buffer_load_dwordx4 v11, s[52:55], s95 offen offset:0 lds
buffer_load_dwordx4 v12, s[52:55], s95 offen offset:1024 lds
v_mfma_f32_32x32x16_bf16 v[208:223], a[92:95], a[100:103], v[208:223]
buffer_load_dwordx4 v13, s[52:55], s95 offen offset:2048 lds
buffer_load_dwordx4 v14, s[52:55], s95 offen offset:3072 lds
s_waitcnt vmcnt(8)
ds_read_b64_tr_b16 a[80:81], v224 offset:0
ds_read_b64_tr_b16 a[82:83], v224 offset:2048
ds_read_b64_tr_b16 a[84:85], v225 offset:0
ds_read_b64_tr_b16 a[86:87], v225 offset:2048
ds_read_b64_tr_b16 a[88:89], v226 offset:0
ds_read_b64_tr_b16 a[90:91], v226 offset:2048
ds_read_b64_tr_b16 a[92:93], v227 offset:0
ds_read_b64_tr_b16 a[94:95], v227 offset:2048
ds_read_b128 a[100:103], v228 offset:25600
v_mfma_f32_32x32x16_bf16 v[160:175], a[64:67], a[96:99], v[160:175]
v_mfma_f32_32x32x16_bf16 v[176:191], a[68:71], a[96:99], v[176:191]
v_mfma_f32_32x32x16_bf16 v[192:207], a[72:75], a[96:99], v[192:207]
s_waitcnt lgkmcnt(0)
s_add_u32 s95, s82, 458752
s_add_u32 m0, s85, 0
s_nop 0
buffer_load_dwordx4 v11, s[52:55], s95 offen offset:0 lds
buffer_load_dwordx4 v12, s[52:55], s95 offen offset:1024 lds
v_mfma_f32_32x32x16_bf16 v[208:223], a[76:79], a[96:99], v[208:223]
buffer_load_dwordx4 v13, s[52:55], s95 offen offset:2048 lds
buffer_load_dwordx4 v14, s[52:55], s95 offen offset:3072 lds
s_waitcnt vmcnt(8)
ds_read_b64_tr_b16 a[64:65], v224 offset:4096
ds_read_b64_tr_b16 a[66:67], v224 offset:6144
ds_read_b64_tr_b16 a[68:69], v225 offset:4096
ds_read_b64_tr_b16 a[70:71], v225 offset:6144
ds_read_b64_tr_b16 a[72:73], v226 offset:4096
ds_read_b64_tr_b16 a[74:75], v226 offset:6144
ds_read_b64_tr_b16 a[76:77], v227 offset:4096
ds_read_b64_tr_b16 a[78:79], v227 offset:6144
ds_read_b128 a[96:99], v228 offset:26624
v_mfma_f32_32x32x16_bf16 v[160:175], a[80:83], a[100:103], v[160:175]
v_mfma_f32_32x32x16_bf16 v[176:191], a[84:87], a[100:103], v[176:191]
v_mfma_f32_32x32x16_bf16 v[192:207], a[88:91], a[100:103], v[192:207]
s_waitcnt lgkmcnt(0)
s_add_u32 s95, s82, 475136
s_add_u32 m0, s85, 4096
s_nop 0
buffer_load_dwordx4 v11, s[52:55], s95 offen offset:0 lds
buffer_load_dwordx4 v12, s[52:55], s95 offen offset:1024 lds
v_mfma_f32_32x32x16_bf16 v[208:223], a[92:95], a[100:103], v[208:223]
buffer_load_dwordx4 v13, s[52:55], s95 offen offset:2048 lds
buffer_load_dwordx4 v14, s[52:55], s95 offen offset:3072 lds
s_waitcnt vmcnt(8)
ds_read_b64_tr_b16 a[80:81], v224 offset:8192
ds_read_b64_tr_b16 a[82:83], v224 offset:10240
ds_read_b64_tr_b16 a[84:85], v225 offset:8192
ds_read_b64_tr_b16 a[86:87], v225 offset:10240
ds_read_b64_tr_b16 a[88:89], v226 offset:8192
ds_read_b64_tr_b16 a[90:91], v226 offset:10240
ds_read_b64_tr_b16 a[92:93], v227 offset:8192
ds_read_b64_tr_b16 a[94:95], v227 offset:10240
ds_read_b128 a[100:103], v228 offset:27648
v_mfma_f32_32x32x16_bf16 v[160:175], a[64:67], a[96:99], v[160:175]
v_mfma_f32_32x32x16_bf16 v[176:191], a[68:71], a[96:99], v[176:191]
v_mfma_f32_32x32x16_bf16 v[192:207], a[72:75], a[96:99], v[192:207]
s_waitcnt lgkmcnt(0)
s_add_u32 s95, s82, 491520
s_add_u32 m0, s85, 8192
s_nop 0
buffer_load_dwordx4 v11, s[52:55], s95 offen offset:0 lds
buffer_load_dwordx4 v12, s[52:55], s95 offen offset:1024 lds
v_mfma_f32_32x32x16_bf16 v[208:223], a[76:79], a[96:99], v[208:223]
buffer_load_dwordx4 v13, s[52:55], s95 offen offset:2048 lds
buffer_load_dwordx4 v14, s[52:55], s95 offen offset:3072 lds
s_waitcnt vmcnt(8)
ds_read_b64_tr_b16 a[64:65], v224 offset:0
ds_read_b64_tr_b16 a[66:67], v224 offset:2048
ds_read_b64_tr_b16 a[68:69], v225 offset:0
ds_read_b64_tr_b16 a[70:71], v225 offset:2048
ds_read_b64_tr_b16 a[72:73], v226 offset:0
ds_read_b64_tr_b16 a[74:75], v226 offset:2048
ds_read_b64_tr_b16 a[76:77], v227 offset:0
ds_read_b64_tr_b16 a[78:79], v227 offset:2048
ds_read_b128 a[96:99], v228 offset:28672
v_mfma_f32_32x32x16_bf16 v[160:175], a[80:83], a[100:103], v[160:175]
v_mfma_f32_32x32x16_bf16 v[176:191], a[84:87], a[100:103], v[176:191]
v_mfma_f32_32x32x16_bf16 v[192:207], a[88:91], a[100:103], v[192:207]
s_waitcnt lgkmcnt(0)
s_add_u32 s95, s82, 507904
s_add_u32 m0, s85, 0
s_nop 0
buffer_load_dwordx4 v11, s[52:55], s95 offen offset:0 lds
buffer_load_dwordx4 v12, s[52:55], s95 offen offset:1024 lds
v_mfma_f32_32x32x16_bf16 v[208:223], a[92:95], a[100:103], v[208:223]
buffer_load_dwordx4 v13, s[52:55], s95 offen offset:2048 lds
buffer_load_dwordx4 v14, s[52:55], s95 offen offset:3072 lds
s_waitcnt vmcnt(8)
ds_read_b64_tr_b16 a[80:81], v224 offset:4096
ds_read_b64_tr_b16 a[82:83], v224 offset:6144
ds_read_b64_tr_b16 a[84:85], v225 offset:4096
ds_read_b64_tr_b16 a[86:87], v225 offset:6144
ds_read_b64_tr_b16 a[88:89], v226 offset:4096
ds_read_b64_tr_b16 a[90:91], v226 offset:6144
ds_read_b64_tr_b16 a[92:93], v227 offset:4096
ds_read_b64_tr_b16 a[94:95], v227 offset:6144
ds_read_b128 a[100:103], v228 offset:29696
v_mfma_f32_32x32x16_bf16 v[160:175], a[64:67], a[96:99], v[160:175]
v_mfma_f32_32x32x16_bf16 v[176:191], a[68:71], a[96:99], v[176:191]
v_mfma_f32_32x32x16_bf16 v[192:207], a[72:75], a[96:99], v[192:207]
s_waitcnt lgkmcnt(0)
v_mfma_f32_32x32x16_bf16 v[208:223], a[76:79], a[96:99], v[208:223]
s_waitcnt vmcnt(4)
ds_read_b64_tr_b16 a[64:65], v224 offset:8192
ds_read_b64_tr_b16 a[66:67], v224 offset:10240
ds_read_b64_tr_b16 a[68:69], v225 offset:8192
ds_read_b64_tr_b16 a[70:71], v225 offset:10240
ds_read_b64_tr_b16 a[72:73], v226 offset:8192
ds_read_b64_tr_b16 a[74:75], v226 offset:10240
ds_read_b64_tr_b16 a[76:77], v227 offset:8192
ds_read_b64_tr_b16 a[78:79], v227 offset:10240
ds_read_b128 a[96:99], v228 offset:30720
v_mfma_f32_32x32x16_bf16 v[160:175], a[80:83], a[100:103], v[160:175]
v_mfma_f32_32x32x16_bf16 v[176:191], a[84:87], a[100:103], v[176:191]
v_mfma_f32_32x32x16_bf16 v[192:207], a[88:91], a[100:103], v[192:207]
s_waitcnt lgkmcnt(0)
v_mfma_f32_32x32x16_bf16 v[208:223], a[92:95], a[100:103], v[208:223]
s_waitcnt vmcnt(0)
ds_read_b64_tr_b16 a[80:81], v224 offset:0
ds_read_b64_tr_b16 a[82:83], v224 offset:2048
ds_read_b64_tr_b16 a[84:85], v225 offset:0
ds_read_b64_tr_b16 a[86:87], v225 offset:2048
ds_read_b64_tr_b16 a[88:89], v226 offset:0
ds_read_b64_tr_b16 a[90:91], v226 offset:2048
ds_read_b64_tr_b16 a[92:93], v227 offset:0
ds_read_b64_tr_b16 a[94:95], v227 offset:2048
ds_read_b128 a[100:103], v228 offset:31744
v_mfma_f32_32x32x16_bf16 v[160:175], a[64:67], a[96:99], v[160:175]
v_mfma_f32_32x32x16_bf16 v[176:191], a[68:71], a[96:99], v[176:191]
v_mfma_f32_32x32x16_bf16 v[192:207], a[72:75], a[96:99], v[192:207]
s_waitcnt lgkmcnt(0)
v_mfma_f32_32x32x16_bf16 v[208:223], a[76:79], a[96:99], v[208:223]
v_mfma_f32_32x32x16_bf16 v[160:175], a[80:83], a[100:103], v[160:175]
v_mfma_f32_32x32x16_bf16 v[176:191], a[84:87], a[100:103], v[176:191]
v_mfma_f32_32x32x16_bf16 v[192:207], a[88:91], a[100:103], v[192:207]
v_mfma_f32_32x32x16_bf16 v[208:223], a[92:95], a[100:103], v[208:223]
s_nop 8
v_cvt_pk_bf16_f32 v32, v160, v161
v_cvt_pk_bf16_f32 v33, v162, v163
v_cvt_pk_bf16_f32 v34, v164, v165
v_cvt_pk_bf16_f32 v35, v166, v167
v_cvt_pk_bf16_f32 v36, v168, v169
v_cvt_pk_bf16_f32 v37, v170, v171
v_cvt_pk_bf16_f32 v38, v172, v173
v_cvt_pk_bf16_f32 v39, v174, v175
v_cvt_pk_bf16_f32 v40, v176, v177
v_cvt_pk_bf16_f32 v41, v178, v179
v_cvt_pk_bf16_f32 v42, v180, v181
v_cvt_pk_bf16_f32 v43, v182, v183
v_cvt_pk_bf16_f32 v44, v184, v185
v_cvt_pk_bf16_f32 v45, v186, v187
v_cvt_pk_bf16_f32 v46, v188, v189
v_cvt_pk_bf16_f32 v47, v190, v191
s_add_u32 s93, s88, 0
buffer_store_dwordx4 v[32:35], v1, s[76:79], s93 offen offset:0 sc1
buffer_store_dwordx4 v[36:39], v1, s[76:79], s93 offen offset:1024 sc1
buffer_store_dwordx4 v[40:43], v1, s[76:79], s93 offen offset:2048 sc1
buffer_store_dwordx4 v[44:47], v1, s[76:79], s93 offen offset:3072 sc1
v_cvt_pk_bf16_f32 v48, v192, v193
v_cvt_pk_bf16_f32 v49, v194, v195
v_cvt_pk_bf16_f32 v50, v196, v197
v_cvt_pk_bf16_f32 v51, v198, v199
v_cvt_pk_bf16_f32 v52, v200, v201
v_cvt_pk_bf16_f32 v53, v202, v203
v_cvt_pk_bf16_f32 v54, v204, v205
v_cvt_pk_bf16_f32 v55, v206, v207
v_cvt_pk_bf16_f32 v56, v208, v209
v_cvt_pk_bf16_f32 v57, v210, v211
v_cvt_pk_bf16_f32 v58, v212, v213
v_cvt_pk_bf16_f32 v59, v214, v215
v_cvt_pk_bf16_f32 v60, v216, v217
v_cvt_pk_bf16_f32 v61, v218, v219
v_cvt_pk_bf16_f32 v62, v220, v221
v_cvt_pk_bf16_f32 v63, v222, v223
s_add_u32 s93, s88, 4096
buffer_store_dwordx4 v[48:51], v1, s[76:79], s93 offen offset:0 sc1
buffer_store_dwordx4 v[52:55], v1, s[76:79], s93 offen offset:1024 sc1
buffer_store_dwordx4 v[56:59], v1, s[76:79], s93 offen offset:2048 sc1
buffer_store_dwordx4 v[60:63], v1, s[76:79], s93 offen offset:3072 sc1
s_lshl_b32 s24, s28, 3
s_add_u32 s24, s24, s26
s_lshl_b32 s24, s24, 7
s_add_u32 s24, s24, 30408704
s_lshl_b32 s25, s28, 20
s_lshl_b32 s92, s26, 13
s_add_u32 s25, s25, s92
s_lshl_b32 s92, s27, 10
s_add_u32 s25, s25, s92
s_lshl_b32 s98, s28, 16
s_lshl_b32 s92, s26, 8
s_add_u32 s98, s98, s92
s_lshl_b32 s92, s27, 5
s_add_u32 s98, s98, s92
v_and_b32 v19, 31, v0
v_lshlrev_b32 v19, 11, v19
v_lshrrev_b32 v20, 5, v0
v_lshl_add_u32 v19, v20, 4, v19
s_waitcnt vmcnt(0)
v_mov_b32 v224, s100
v_mov_b32 v225, s101
s_lshl_b32 s92, s27, 3
v_mov_b32 v226, s92
s_mov_b64 exec, 1
buffer_store_dwordx2 v[224:225], v226, s[76:79], s24 offen offset:0 sc1
s_mov_b64 exec, -1
v_and_b32 v98, 7, v0
v_lshlrev_b32 v98, 3, v98
buffer_load_dwordx2 v[96:97], v98, s[76:79], s24 offen offset:0 sc1
s_waitcnt vmcnt(0)
s_mov_b32 s93, 0
L_pollRA:
v_cmp_ne_u64 vcc, s[100:101], v[96:97]
s_nop 1
s_cmp_eq_u64 vcc, 0
s_cbranch_scc1 L_polledRA
s_add_u32 s93, s93, 1
s_cmp_ge_u32 s93, 400000
s_cbranch_scc1 L_polledRA
s_sleep 4
buffer_load_dwordx2 v[96:97], v98, s[76:79], s24 offen offset:0 sc1
s_waitcnt vmcnt(0)
s_branch L_pollRA
L_polledRA:
s_add_u32 s92, s25, 0
buffer_load_dwordx4 v[100:103], v1, s[76:79], s92 offen sc1
s_add_u32 s92, s25, 65536
buffer_load_dwordx4 v[104:107], v1, s[76:79], s92 offen sc1
s_add_u32 s92, s25, 131072
buffer_load_dwordx4 v[108:111], v1, s[76:79], s92 offen sc1
s_add_u32 s92, s25, 196608
buffer_load_dwordx4 v[112:115], v1, s[76:79], s92 offen sc1
s_add_u32 s92, s25, 262144
buffer_load_dwordx4 v[116:119], v1, s[76:79], s92 offen sc1
s_add_u32 s92, s25, 327680
buffer_load_dwordx4 v[120:123], v1, s[76:79], s92 offen sc1
s_add_u32 s92, s25, 393216
buffer_load_dwordx4 v[124:127], v1, s[76:79], s92 offen sc1
s_add_u32 s92, s25, 458752
buffer_load_dwordx4 v[128:131], v1, s[76:79], s92 offen sc1
s_waitcnt vmcnt(7)
v_lshlrev_b32 v160, 16, v100
v_and_b32 v161, 0xffff0000, v100
v_lshlrev_b32 v162, 16, v101
v_and_b32 v163, 0xffff0000, v101
v_lshlrev_b32 v164, 16, v102
v_and_b32 v165, 0xffff0000, v102
v_lshlrev_b32 v166, 16, v103
v_and_b32 v167, 0xffff0000, v103
s_waitcnt vmcnt(6)
v_lshlrev_b32 v168, 16, v104
v_and_b32 v169, 0xffff0000, v104
v_add_f32 v160, v160, v168
v_add_f32 v161, v161, v169
v_lshlrev_b32 v168, 16, v105
v_and_b32 v169, 0xffff0000, v105
v_add_f32 v162, v162, v168
v_add_f32 v163, v163, v169
v_lshlrev_b32 v168, 16, v106
v_and_b32 v169, 0xffff0000, v106
v_add_f32 v164, v164, v168
v_add_f32 v165, v165, v169
v_lshlrev_b32 v168, 16, v107
v_and_b32 v169, 0xffff0000, v107
v_add_f32 v166, v166, v168
v_add_f32 v167, v167, v169
s_waitcnt vmcnt(5)
v_lshlrev_b32 v168, 16, v108
v_and_b32 v169, 0xffff0000, v108
v_add_f32 v160, v160, v168
v_add_f32 v161, v161, v169
v_lshlrev_b32 v168, 16, v109
v_and_b32 v169, 0xffff0000, v109
v_add_f32 v162, v162, v168
v_add_f32 v163, v163, v169
v_lshlrev_b32 v168, 16, v110
v_and_b32 v169, 0xffff0000, v110
v_add_f32 v164, v164, v168
v_add_f32 v165, v165, v169
v_lshlrev_b32 v168, 16, v111
v_and_b32 v169, 0xffff0000, v111
v_add_f32 v166, v166, v168
v_add_f32 v167, v167, v169
s_waitcnt vmcnt(4)
v_lshlrev_b32 v168, 16, v112
v_and_b32 v169, 0xffff0000, v112
v_add_f32 v160, v160, v168
v_add_f32 v161, v161, v169
v_lshlrev_b32 v168, 16, v113
v_and_b32 v169, 0xffff0000, v113
v_add_f32 v162, v162, v168
v_add_f32 v163, v163, v169
v_lshlrev_b32 v168, 16, v114
v_and_b32 v169, 0xffff0000, v114
v_add_f32 v164, v164, v168
v_add_f32 v165, v165, v169
v_lshlrev_b32 v168, 16, v115
v_and_b32 v169, 0xffff0000, v115
v_add_f32 v166, v166, v168
v_add_f32 v167, v167, v169
s_waitcnt vmcnt(3)
v_lshlrev_b32 v168, 16, v116
v_and_b32 v169, 0xffff0000, v116
v_add_f32 v160, v160, v168
v_add_f32 v161, v161, v169
v_lshlrev_b32 v168, 16, v117
v_and_b32 v169, 0xffff0000, v117
v_add_f32 v162, v162, v168
v_add_f32 v163, v163, v169
v_lshlrev_b32 v168, 16, v118
v_and_b32 v169, 0xffff0000, v118
v_add_f32 v164, v164, v168
v_add_f32 v165, v165, v169
v_lshlrev_b32 v168, 16, v119
v_and_b32 v169, 0xffff0000, v119
v_add_f32 v166, v166, v168
v_add_f32 v167, v167, v169
s_waitcnt vmcnt(2)
v_lshlrev_b32 v168, 16, v120
v_and_b32 v169, 0xffff0000, v120
v_add_f32 v160, v160, v168
v_add_f32 v161, v161, v169
v_lshlrev_b32 v168, 16, v121
v_and_b32 v169, 0xffff0000, v121
v_add_f32 v162, v162, v168
v_add_f32 v163, v163, v169
v_lshlrev_b32 v168, 16, v122
v_and_b32 v169, 0xffff0000, v122
v_add_f32 v164, v164, v168
v_add_f32 v165, v165, v169
v_lshlrev_b32 v168, 16, v123
v_and_b32 v169, 0xffff0000, v123
v_add_f32 v166, v166, v168
v_add_f32 v167, v167, v169
s_waitcnt vmcnt(1)
v_lshlrev_b32 v168, 16, v124
v_and_b32 v169, 0xffff0000, v124
v_add_f32 v160, v160, v168
v_add_f32 v161, v161, v169
v_lshlrev_b32 v168, 16, v125
v_and_b32 v169, 0xffff0000, v125
v_add_f32 v162, v162, v168
v_add_f32 v163, v163, v169
v_lshlrev_b32 v168, 16, v126
v_and_b32 v169, 0xffff0000, v126
v_add_f32 v164, v164, v168
v_add_f32 v165, v165, v169
v_lshlrev_b32 v168, 16, v127
v_and_b32 v169, 0xffff0000, v127
v_add_f32 v166, v166, v168
v_add_f32 v167, v167, v169
s_waitcnt vmcnt(0)
v_lshlrev_b32 v168, 16, v128
v_and_b32 v169, 0xffff0000, v128
v_add_f32 v160, v160, v168
v_add_f32 v161, v161, v169
v_lshlrev_b32 v168, 16, v129
v_and_b32 v169, 0xffff0000, v129
v_add_f32 v162, v162, v168
v_add_f32 v163, v163, v169
v_lshlrev_b32 v168, 16, v130
v_and_b32 v169, 0xffff0000, v130
v_add_f32 v164, v164, v168
v_add_f32 v165, v165, v169
v_lshlrev_b32 v168, 16, v131
v_and_b32 v169, 0xffff0000, v131
v_add_f32 v166, v166, v168
v_add_f32 v167, v167, v169
v_cvt_pk_bf16_f32 v172, v160, v161
v_cvt_pk_bf16_f32 v173, v162, v163
v_cvt_pk_bf16_f32 v174, v164, v165
v_cvt_pk_bf16_f32 v175, v166, v167
s_add_u32 s92, s98, 0
buffer_store_dwordx4 v[172:175], v19, s[20:23], s92 offen
L_pend0:
s_endpgm
L_code_end:
.section .rodata,"a"
.p2align 6
.amdhsa_kernel concat_heads__gqa_block_cached__mha_block_cached__near_ridge_kernel
  .amdhsa_next_free_vgpr 512
  .amdhsa_next_free_sgpr 102
  .amdhsa_accum_offset 256
  .amdhsa_group_segment_fixed_size 0
  .amdhsa_kernarg_size 104
  .amdhsa_user_sgpr_count 2
  .amdhsa_user_sgpr_kernarg_segment_ptr 1
  .amdhsa_system_sgpr_workgroup_id_x 1
.end_amdhsa_kernel
```
